```python
import torch

def _softmax(x, axis=-1):
    return torch.softmax(x, dim=axis)

def _gelu(x):
    return torch.nn.functional.gelu(x, approximate='tanh')

def _silu(x):
    return torch.nn.functional.silu(x)

def _sigmoid(x):
    return torch.sigmoid(x)

def _layernorm(x, axis=-1, eps=1e-05):
    m = x.mean(dim=axis, keepdim=True)
    v = x.var(dim=axis, keepdim=True, unbiased=False)
    return (x - m) / torch.sqrt(v + eps)

def _scatter_add(tgt, idx, src, axis=0):
    return tgt.clone().index_add_(axis, idx, src)

def _segment_sum(src, seg, n):
    out = torch.zeros((n,) + src.shape[1:], dtype=src.dtype)
    return out.index_add_(0, seg, src)

def _pad(x, pw):
    flat = tuple((v for pair in reversed(pw) for v in pair))
    return torch.nn.functional.pad(x, flat)
kernel_name = 'adaLN_cond__memory_aug_recurrent_mem_tr__glu_gated_bilinear__prompt'

def setup_inputs():

    _w = lambda a: (lambda t: t.to(torch.bfloat16) if t.is_floating_point() else t)(torch.as_tensor(a))

    def _A_setup():
        B, S, Dm = (1, 2048, 576)
        H, Dh = (32, 128)
        M, seg = (8, 32)
        seg = min(seg, S)
        S = S // seg * seg
        return {'x': _w((lambda *s: torch.randn(*s, dtype=torch.bfloat16) * 0.05)(B, S, Dm)), 'mem0': _w((lambda *s: torch.randn(*s, dtype=torch.bfloat16) * 0.8)(B, M, Dm)), 'Wq': _w((lambda *s: torch.randn(*s, dtype=torch.bfloat16) * 1.6)(Dm, H, Dh) * Dm ** (-0.5)), 'Wk': _w((lambda *s: torch.randn(*s, dtype=torch.bfloat16) * 1.6)(Dm, H, Dh) * Dm ** (-0.5)), 'Wv': _w((lambda *s: torch.randn(*s, dtype=torch.bfloat16) * 0.8)(Dm, H, Dh) * Dm ** (-0.5)), 'Wo': _w((lambda *s: torch.randn(*s, dtype=torch.bfloat16) * 0.8)(H, Dh, Dm) * (H * Dh) ** (-0.5)), 'seg_len': seg}
    _A_in = _A_setup()

    def _B_setup():
        B, S, D, F = (1, 2048, 576, 4608)
        return {'x': _w((lambda *s: torch.randn(*s, dtype=torch.bfloat16) * 0.05)(B, S, D)), 'w_gate': _w((lambda *s: torch.randn(*s, dtype=torch.bfloat16) * 0.8)(D, F) * D ** (-0.5)), 'w_up': _w((lambda *s: torch.randn(*s, dtype=torch.bfloat16) * 0.8)(D, F) * D ** (-0.5)), 'w_down': _w((lambda *s: torch.randn(*s, dtype=torch.bfloat16) * 0.8)(F, D) * F ** (-0.5))}
    _B_in = _B_setup()
    return {'A_x': _A_in['x'], 'A_mem0': _A_in['mem0'], 'A_Wq': _A_in['Wq'], 'A_Wk': _A_in['Wk'], 'A_Wv': _A_in['Wv'], 'A_Wo': _A_in['Wo'], 'A_seg_len': _A_in['seg_len'], 'B_x': _B_in['x'], 'B_w_gate': _B_in['w_gate'], 'B_w_up': _B_in['w_up'], 'B_w_down': _B_in['w_down'], 'c': _w((lambda *s: torch.randn(*s, dtype=torch.bfloat16) * 0.1)(1, 576) * 8.0), 'w_mod': _w((lambda *s: torch.randn(*s, dtype=torch.bfloat16) * 0.1)(576, 6 * 576) * 576 ** (-0.5) * 8.0)}

def reference(A_x, A_mem0, A_Wq, A_Wk, A_Wv, A_Wo, A_seg_len, B_x, B_w_gate, B_w_up, B_w_down, c, w_mod):

    def _A_ref(x, mem0, Wq, Wk, Wv, Wo, seg_len):
        B, S, Dm = x.shape
        H, Dh = (Wq.shape[1], Wq.shape[2])
        M = mem0.shape[1]
        scale = Dh ** (-0.5)
        n_seg = S // seg_len
        L = M + seg_len
        idx = torch.arange(L)
        mask = (idx[:, None] < M) | (idx[:, None] >= idx[None, :])
        mem = mem0
        outs = []
        for s in range(n_seg):
            xs = x[:, s * seg_len:(s + 1) * seg_len, :].clone()
            h = torch.concatenate([mem, xs], axis=1)
            q = torch.einsum('btd,dhe->bhte', h, Wq)
            k = torch.einsum('btd,dhe->bhte', h, Wk)
            v = torch.einsum('btd,dhe->bhte', h, Wv)
            scores = torch.einsum('bhqe,bhke->bhqk', q, k) * scale
            scores = torch.where(mask[None, None], scores, -1000000000.0)
            p = _softmax(scores, axis=-1)
            o = torch.einsum('bhqk,bhke->bhqe', p, v)
            o = torch.einsum('bhte,hed->btd', o, Wo)
            mem = o[:, :M, :].clone()
            outs.append(o[:, M:, :])
        return torch.concatenate(outs, axis=1)

    def _B_ref(x, w_gate, w_up, w_down):
        g = torch.einsum('bsd,df->bsf', x, w_gate)
        u = torch.einsum('bsd,df->bsf', x, w_up)
        h = g * u
        return torch.einsum('bsf,fd->bsd', h, w_down)
    x = A_x
    mod = (_silu(c) @ w_mod).reshape(c.shape[0], 6, 1, -1)
    sa, ca, ga, sb, cb, gb = (mod[:, 0].clone(), mod[:, 1].clone(), mod[:, 2].clone(), mod[:, 3].clone(), mod[:, 4].clone(), mod[:, 5].clone())
    h = _layernorm(x, axis=-1) * (1 + ca) + sa
    x = x + ga * _A_ref(h, A_mem0, A_Wq, A_Wk, A_Wv, A_Wo, A_seg_len)
    h = _layernorm(x, axis=-1) * (1 + cb) + sb
    x = x + gb * _B_ref(h, B_w_gate, B_w_up, B_w_down)
    return x
```

```asm
; @launch grid=(256,1,1) block=(256,1,1) lds=163840
.amdgcn_target "amdgcn-amd-amdhsa--gfx950"
.text
.globl adaLN_cond__memory_aug_recurrent_mem_tr__glu_gated_bilinear__prompt_kernel
.p2align 8
.type adaLN_cond__memory_aug_recurrent_mem_tr__glu_gated_bilinear__prompt_kernel,@function
adaLN_cond__memory_aug_recurrent_mem_tr__glu_gated_bilinear__prompt_kernel:
    s_cmp_ge_u32 s2, 256
    s_cbranch_scc1 L_end
    s_load_dwordx2 s[4:5], s[0:1], 120
    s_load_dwordx2 s[8:9], s[0:1], 16
    s_load_dwordx2 s[12:13], s[0:1], 24
    s_load_dwordx2 s[16:17], s[0:1], 32
    s_load_dwordx2 s[20:21], s[0:1], 40
    s_load_dwordx2 s[24:25], s[0:1], 8
    s_load_dwordx2 s[28:29], s[0:1], 112
    s_getreg_b32 s3, hwreg(HW_REG_XCC_ID)
    s_and_b32 s3, s3, 15
    v_lshrrev_b32 v1, 6, v0
    v_and_b32 v0, 63, v0
    v_readfirstlane_b32 s33, v1
    s_waitcnt lgkmcnt(0)
    s_and_b32 s5, s5, 0xffff
    s_mov_b32 s6, 268435456
    s_mov_b32 s7, 0x20000
    s_and_b32 s9, s9, 0xffff
    s_mov_b32 s10, 4718592
    s_mov_b32 s11, 0x20000
    s_and_b32 s13, s13, 0xffff
    s_mov_b32 s14, 4718592
    s_mov_b32 s15, 0x20000
    s_and_b32 s17, s17, 0xffff
    s_mov_b32 s18, 4718592
    s_mov_b32 s19, 0x20000
    s_and_b32 s21, s21, 0xffff
    s_mov_b32 s22, 4718592
    s_mov_b32 s23, 0x20000
    s_and_b32 s25, s25, 0xffff
    s_mov_b32 s26, 9216
    s_mov_b32 s27, 0x20000
    s_and_b32 s29, s29, 0xffff
    s_mov_b32 s30, 256
    s_mov_b32 s31, 0x20000
    v_mov_b32 v2, 0
    s_cmp_lg_u32 s33, 0
    s_cbranch_scc1 L_norank
    s_and_b32 s60, s3, 7
    s_mov_b32 s62, 8
    s_mov_b64 exec, 1
L_claim:
    s_lshl_b32 s61, s60, 5
    v_mov_b32 v1, 1
    buffer_atomic_add v1, off, s[28:31], s61 offset:0 sc0
    s_waitcnt vmcnt(0)
    v_readfirstlane_b32 s61, v1
    s_nop 3
    s_cmp_lt_u32 s61, 32
    s_cbranch_scc1 L_got
    s_add_u32 s60, s60, 1
    s_and_b32 s60, s60, 7
    s_sub_u32 s62, s62, 1
    s_cmp_lg_u32 s62, 0
    s_cbranch_scc1 L_claim
    s_mov_b32 s60, 8
L_got:
    s_lshl_b32 s60, s60, 5
    s_add_u32 s60, s60, s61
    v_mov_b32 v1, s60
    ds_write_b32 v2, v1
    s_mov_b64 exec, -1
L_norank:
    s_waitcnt lgkmcnt(0)
    s_barrier
    ds_read_b32 v1, v2
    s_waitcnt lgkmcnt(0)
    v_readfirstlane_b32 s32, v1
    s_barrier
    s_cmp_ge_u32 s32, 256
    s_cbranch_scc1 L_end
    s_cmp_ge_u32 s32, 32
    s_cbranch_scc1 L_worker
    v_mov_b32 v71, v0
    v_lshrrev_b32 v65, 4, v71
    v_lshlrev_b32 v64, 2, v65
    v_sub_u32 v64, v71, v64
    v_and_b32 v64, 15, v64
    v_lshlrev_b32 v64, 4, v64
    v_lshl_add_u32 v56, v65, 13, v64
    s_lshl_b32 s62, s32, 8
    s_lshl_b32 s63, s33, 17
    s_add_u32 s62, s62, s63
    v_add_u32 v56, s62, v56
    v_lshrrev_b32 v64, 3, v71
    v_mul_u32_u24 v57, 1152, v64
    v_and_b32 v64, 7, v71
    v_lshl_add_u32 v57, v64, 4, v57
    s_mul_i32 s62, s32, 147456
    s_mul_i32 s63, s33, 36864
    s_add_u32 s62, s62, s63
    v_add_u32 v57, s62, v57
    s_mul_i32 s99, s33, 34816
    s_add_u32 m0, s99, 38912
    s_mov_b32 s62, 0
    buffer_load_dwordx4 v56, s[8:11], s62 offen lds
    s_add_u32 m0, s99, 39936
    s_mov_b32 s62, 32768
    buffer_load_dwordx4 v56, s[8:11], s62 offen lds
    s_add_u32 m0, s99, 40960
    s_mov_b32 s62, 65536
    buffer_load_dwordx4 v56, s[8:11], s62 offen lds
    s_add_u32 m0, s99, 41984
    s_mov_b32 s62, 98304
    buffer_load_dwordx4 v56, s[8:11], s62 offen lds
    s_add_u32 m0, s99, 43008
    s_mov_b32 s62, 0
    buffer_load_dwordx4 v56, s[12:15], s62 offen lds
    s_add_u32 m0, s99, 44032
    s_mov_b32 s62, 32768
    buffer_load_dwordx4 v56, s[12:15], s62 offen lds
    s_add_u32 m0, s99, 45056
    s_mov_b32 s62, 65536
    buffer_load_dwordx4 v56, s[12:15], s62 offen lds
    s_add_u32 m0, s99, 46080
    s_mov_b32 s62, 98304
    buffer_load_dwordx4 v56, s[12:15], s62 offen lds
    s_add_u32 m0, s99, 47104
    s_mov_b32 s62, 0
    buffer_load_dwordx4 v57, s[20:23], s62 offen lds
    s_add_u32 m0, s99, 48128
    s_mov_b32 s62, 9216
    buffer_load_dwordx4 v57, s[20:23], s62 offen lds
    s_add_u32 m0, s99, 49152
    s_mov_b32 s62, 18432
    buffer_load_dwordx4 v57, s[20:23], s62 offen lds
    s_add_u32 m0, s99, 50176
    s_mov_b32 s62, 27648
    buffer_load_dwordx4 v57, s[20:23], s62 offen lds
    s_add_u32 m0, s99, 51200
    s_mov_b32 s62, 524288
    buffer_load_dwordx4 v56, s[8:11], s62 offen lds
    s_add_u32 m0, s99, 52224
    s_mov_b32 s62, 557056
    buffer_load_dwordx4 v56, s[8:11], s62 offen lds
    s_add_u32 m0, s99, 53248
    s_mov_b32 s62, 589824
    buffer_load_dwordx4 v56, s[8:11], s62 offen lds
    s_add_u32 m0, s99, 54272
    s_mov_b32 s62, 622592
    buffer_load_dwordx4 v56, s[8:11], s62 offen lds
    s_lshl_b32 s60, s33, 5
    s_add_u32 s35, s60, s32
    s_cmp_lt_u32 s35, 72
    s_cselect_b32 s35, s35, -1
    v_lshlrev_b32 v0, 4, v71
    v_and_b32 v64, 1, v71
    v_mul_u32_u24 v64, 0xaaaa, v64
    v_add_u32 v1, 0x4444, v64
    s_mul_i32 s60, s33, 34816
    s_add_u32 s60, s60, 24576
    v_add_u32 v2, s60, v0
    s_add_u32 s50, s60, 32768
    s_lshl_b32 s51, s33, 11
    s_add_u32 s51, s51, 9216
    v_lshrrev_b32 v65, 4, v71
    v_bfe_u32 v66, v71, 2, 2
    v_and_b32 v67, 3, v71
    v_and_b32 v64, 1, v66
    v_mul_u32_u24 v3, 1056, v64
    v_lshrrev_b32 v64, 1, v66
    v_lshl_add_u32 v3, v64, 8, v3
    v_lshl_add_u32 v3, v65, 6, v3
    v_lshl_add_u32 v3, v67, 2, v3
    s_lshr_b32 s60, s33, 1
    s_and_b32 s61, s33, 1
    s_mul_i32 s62, s60, 2112
    s_lshl_b32 s63, s61, 9
    s_add_u32 s62, s62, s63
    s_add_u32 s62, s62, 17408
    v_add_u32 v3, s62, v3
    v_and_b32 v64, 1, v67
    v_lshl_add_u32 v64, v66, 1, v64
    v_lshlrev_b32 v68, 5, v64
    v_lshl_add_u32 v68, v65, 8, v68
    s_lshl_b32 s62, s60, 10
    s_lshl_b32 s63, s61, 4
    s_add_u32 s62, s62, s63
    s_add_u32 s62, s62, 21632
    v_add_u32 v68, s62, v68
    v_lshl_add_u32 v69, v65, 3, v64
    v_lshlrev_b32 v69, 4, v69
    v_add_u32 v69, 23680, v69
    v_cmp_le_u32 vcc, 2, v67
    s_nop 1
    v_cndmask_b32 v4, v69, v68, vcc
    v_lshrrev_b32 v64, 5, v71
    v_lshlrev_b32 v5, 12, v64
    v_and_b32 v64, 31, v71
    v_lshl_add_u32 v5, v64, 2, v5
    v_lshlrev_b32 v68, 6, v66
    v_lshl_add_u32 v68, v67, 3, v68
    v_lshl_add_u32 v68, v65, 5, v68
    s_lshl_b32 s62, s35, 7
    s_and_b32 s62, s62, 0x3fff
    v_add_u32 v68, s62, v68
    v_and_b32 v64, 0x28, v71
    v_mov_b32 v69, 0x40000000
    v_cmp_eq_u32 vcc, 0, v64
    s_nop 1
    v_cndmask_b32 v6, v69, v68, vcc
    s_mov_b32 s100, 0x11111111
    s_mov_b32 s101, 0x11111111
    v_and_b32 v64, 1, v66
    v_lshlrev_b32 v64, 4, v64
    v_mov_b32 v68, 0x3f80
    v_lshlrev_b32 v7, v64, v68
    s_mov_b32 s52, 0x110011
    s_mov_b32 s53, 0x110011
    s_mov_b32 s54, 0x220022
    s_mov_b32 s55, 0x220022
    s_mov_b32 s56, 0x440044
    s_mov_b32 s57, 0x440044
    s_mov_b32 s58, 0x880088
    s_mov_b32 s59, 0x880088
    s_lshl_b32 s62, s33, 10
    v_add_u32 v8, s62, v0
    v_xor_b32 v9, 0x400, v8
    s_and_b32 s62, s62, 0x800
    s_xor_b32 s62, s62, 0x800
    v_add_u32 v10, s62, v0
    s_mov_b32 s36, 0
    s_mov_b32 s47, 0
    s_mov_b32 s37, 2000000
    s_lshl_b32 s63, s32, 7
    s_add_u32 s63, s63, 62914560
    s_lshl_b32 s62, s33, 13
    s_add_u32 s38, s62, s63
    s_lshl_b32 s62, s35, 12
    s_add_u32 s41, s62, 62914560
    s_cmp_eq_u32 s35, -1
    s_cselect_b32 s41, 0x40000000, s41
    s_cselect_b32 s62, 0x40000000, 0
    v_or_b32 v6, s62, v6
    s_mov_b32 s42, 63963136
    s_mov_b32 s43, 63979520
    s_mov_b32 s44, 63995904
    s_lshl_b32 s45, s32, 14
    s_lshl_b32 s62, s33, 11
    s_add_u32 s45, s45, s62
    s_add_u32 s97, s45, 8192
    s_lshl_b32 s98, s32, 14
    s_add_u32 s98, s98, 524288
    s_cmp_lt_u32 s33, 3
    s_cselect_b32 s98, 0x40000000, s98
    s_lshl_b32 s46, s32, 12
    s_lshl_b32 s62, s33, 10
    s_add_u32 s46, s46, s62
    s_add_u32 s46, s46, 50331648
    s_lshl_b32 s62, s32, 2
    s_add_u32 s62, s62, s33
    s_mul_i32 s48, s62, 36864
    s_add_u32 s48, s48, 65011712
    s_add_u32 s96, s48, 32768
    s_mov_b32 s49, 0x3e0293ee
    s_lshl_b32 s62, s33, 2
    v_add_u32 v54, s62, v67
    s_lshl_b32 s62, s60, 3
    s_add_u32 s62, s62, s61
    v_lshl_add_u32 v55, v67, 1, s62
    v_and_b32 v68, 1, v65
    v_lshlrev_b32 v68, 2, v68
    v_lshrrev_b32 v69, 1, v66
    v_lshl_add_u32 v68, v69, 3, v68
    v_and_b32 v69, 1, v66
    v_add_u32 v68, v68, v69
    v_lshrrev_b32 v64, 1, v65
    v_lshl_add_u32 v60, v64, 4, v68
    v_lshlrev_b32 v60, 7, v60
    v_lshl_add_u32 v60, v67, 3, v60
    s_lshl_b32 s62, s33, 5
    s_add_u32 s62, s62, 38912
    v_add_u32 v60, s62, v60
    v_mul_u32_u24 v64, 34816, v64
    v_lshl_add_u32 v64, v68, 8, v64
    v_add_u32 v64, 38912, v64
    v_lshl_add_u32 v54, v69, 2, v54
    v_and_b32 v54, 15, v54
    v_lshl_add_u32 v54, v54, 4, v64
    v_lshl_add_u32 v55, v69, 2, v55
    v_and_b32 v55, 15, v55
    v_lshl_add_u32 v55, v55, 4, v64
    v_lshl_add_u32 v68, v66, 1, v65
    v_mul_u32_u24 v68, 1152, v68
    v_lshl_add_u32 v68, v67, 3, v68
    s_and_b32 s62, s35, 1
    s_mul_i32 s62, s62, 4608
    s_bfe_u32 s63, s35, 0x60001
    s_lshl_b32 s63, s63, 5
    s_add_u32 s62, s62, s63
    buffer_load_dwordx2 v[52:53], v68, s[24:27], s62 offen
    v_mov_b32 v64, -1
    v_mov_b32 v65, -1
    v_mov_b32 v66, -1
    v_mov_b32 v67, -1
    buffer_store_dwordx4 v[64:67], v0, s[4:7], s41 offen offset:0 sc1
    buffer_store_dwordx4 v[64:67], v0, s[4:7], s41 offen offset:1024 sc1
    buffer_store_dwordx4 v[64:67], v0, s[4:7], s41 offen offset:2048 sc1
    buffer_store_dwordx4 v[64:67], v0, s[4:7], s41 offen offset:3072 sc1
    buffer_store_dwordx2 v[64:65], v6, s[4:7], s43 offen sc1
    buffer_store_dwordx2 v[64:65], v6, s[4:7], s44 offen sc1
    s_cmp_eq_u32 s33, 1
    s_cbranch_scc1 L_cls1_3
    s_cmp_eq_u32 s33, 2
    s_cbranch_scc1 L_cls2_4
    s_cmp_eq_u32 s33, 3
    s_cbranch_scc1 L_cls3_5
L_cls0_2:
    v_add_u32 v63, 34816, v60
    v_add_u32 v69, 69632, v60
    v_add_u32 v70, 104448, v60
    v_mov_b32 v58, v54
    v_xor_b32 v59, 0x80, v54
    v_add_u32 v61, 69632, v58
    v_add_u32 v62, 69632, v59
    s_waitcnt vmcnt(19)
    s_barrier
    s_add_u32 m0, s99, 55296
    s_mov_b32 s62, 524288
    buffer_load_dwordx4 v56, s[12:15], s62 offen lds
    s_add_u32 m0, s99, 56320
    s_mov_b32 s62, 557056
    buffer_load_dwordx4 v56, s[12:15], s62 offen lds
    s_add_u32 m0, s99, 57344
    s_mov_b32 s62, 589824
    buffer_load_dwordx4 v56, s[12:15], s62 offen lds
    s_add_u32 m0, s99, 58368
    s_mov_b32 s62, 622592
    buffer_load_dwordx4 v56, s[12:15], s62 offen lds
    ds_read_b64_tr_b16 a[40:41], v58 offset:0
    ds_read_b64_tr_b16 a[42:43], v59 offset:512
    ds_read_b64_tr_b16 a[44:45], v61 offset:0
    ds_read_b64_tr_b16 a[46:47], v62 offset:512
    ds_read_b64_tr_b16 v[12:13], v58 offset:8
    ds_read_b64_tr_b16 v[14:15], v59 offset:520
    ds_read_b64_tr_b16 v[16:17], v61 offset:8
    ds_read_b64_tr_b16 v[18:19], v62 offset:520
    s_waitcnt lgkmcnt(0)
    ds_write_b128 v2, v[12:15] offset:0
    ds_write_b128 v2, v[16:19] offset:1024
    s_waitcnt vmcnt(19)
    s_barrier
    s_add_u32 m0, s99, 38912
    s_mov_b32 s62, 128
    buffer_load_dwordx4 v57, s[20:23], s62 offen lds
    s_add_u32 m0, s99, 39936
    s_mov_b32 s62, 9344
    buffer_load_dwordx4 v57, s[20:23], s62 offen lds
    s_add_u32 m0, s99, 40960
    s_mov_b32 s62, 18560
    buffer_load_dwordx4 v57, s[20:23], s62 offen lds
    s_add_u32 m0, s99, 41984
    s_mov_b32 s62, 27776
    buffer_load_dwordx4 v57, s[20:23], s62 offen lds
    ds_read_b64_tr_b16 v[20:21], v58 offset:4096
    ds_read_b64_tr_b16 v[22:23], v59 offset:4608
    ds_read_b64_tr_b16 v[24:25], v61 offset:4096
    ds_read_b64_tr_b16 v[26:27], v62 offset:4608
    ds_read_b64_tr_b16 v[72:73], v58 offset:4104
    ds_read_b64_tr_b16 v[74:75], v59 offset:4616
    ds_read_b64_tr_b16 v[76:77], v61 offset:4104
    ds_read_b64_tr_b16 v[78:79], v62 offset:4616
    s_waitcnt lgkmcnt(0)
    ds_write_b128 v2, v[20:23] offset:10240
    ds_write_b128 v2, v[24:27] offset:11264
    s_waitcnt vmcnt(19)
    s_barrier
    s_add_u32 m0, s99, 43008
    s_mov_b32 s62, 1048576
    buffer_load_dwordx4 v56, s[8:11], s62 offen lds
    s_add_u32 m0, s99, 44032
    s_mov_b32 s62, 1081344
    buffer_load_dwordx4 v56, s[8:11], s62 offen lds
    s_add_u32 m0, s99, 45056
    s_mov_b32 s62, 1114112
    buffer_load_dwordx4 v56, s[8:11], s62 offen lds
    s_add_u32 m0, s99, 46080
    s_mov_b32 s62, 1146880
    buffer_load_dwordx4 v56, s[8:11], s62 offen lds
    ds_read_b64_tr_b16 a[48:49], v60 offset:8192
    ds_read_b64_tr_b16 a[50:51], v60 offset:8448
    ds_read_b64_tr_b16 a[52:53], v63 offset:8192
    ds_read_b64_tr_b16 a[54:55], v63 offset:8448
    ds_read_b64_tr_b16 a[72:73], v69 offset:8192
    ds_read_b64_tr_b16 a[74:75], v69 offset:8448
    ds_read_b64_tr_b16 a[76:77], v70 offset:8192
    ds_read_b64_tr_b16 a[78:79], v70 offset:8448
    s_waitcnt lgkmcnt(0)
    s_waitcnt vmcnt(19)
    s_barrier
    s_add_u32 m0, s99, 47104
    s_mov_b32 s62, 1048576
    buffer_load_dwordx4 v56, s[12:15], s62 offen lds
    s_add_u32 m0, s99, 48128
    s_mov_b32 s62, 1081344
    buffer_load_dwordx4 v56, s[12:15], s62 offen lds
    s_add_u32 m0, s99, 49152
    s_mov_b32 s62, 1114112
    buffer_load_dwordx4 v56, s[12:15], s62 offen lds
    s_add_u32 m0, s99, 50176
    s_mov_b32 s62, 1146880
    buffer_load_dwordx4 v56, s[12:15], s62 offen lds
    ds_read_b64_tr_b16 v[80:81], v58 offset:12288
    ds_read_b64_tr_b16 v[82:83], v59 offset:12800
    ds_read_b64_tr_b16 v[84:85], v61 offset:12288
    ds_read_b64_tr_b16 v[86:87], v62 offset:12800
    ds_read_b64_tr_b16 v[88:89], v58 offset:12296
    ds_read_b64_tr_b16 v[90:91], v59 offset:12808
    ds_read_b64_tr_b16 v[92:93], v61 offset:12296
    ds_read_b64_tr_b16 v[94:95], v62 offset:12808
    s_waitcnt lgkmcnt(0)
    s_waitcnt vmcnt(12)
    s_barrier
    s_add_u32 m0, s99, 51200
    s_mov_b32 s62, 1572864
    buffer_load_dwordx4 v56, s[8:11], s62 offen lds
    s_add_u32 m0, s99, 52224
    s_mov_b32 s62, 1605632
    buffer_load_dwordx4 v56, s[8:11], s62 offen lds
    s_add_u32 m0, s99, 53248
    s_mov_b32 s62, 1638400
    buffer_load_dwordx4 v56, s[8:11], s62 offen lds
    s_add_u32 m0, s99, 54272
    s_mov_b32 s62, 1671168
    buffer_load_dwordx4 v56, s[8:11], s62 offen lds
    ds_read_b64_tr_b16 v[96:97], v58 offset:16384
    ds_read_b64_tr_b16 v[98:99], v59 offset:16896
    ds_read_b64_tr_b16 v[100:101], v61 offset:16384
    ds_read_b64_tr_b16 v[102:103], v62 offset:16896
    ds_read_b64_tr_b16 v[104:105], v58 offset:16392
    ds_read_b64_tr_b16 v[106:107], v59 offset:16904
    ds_read_b64_tr_b16 v[108:109], v61 offset:16392
    ds_read_b64_tr_b16 v[110:111], v62 offset:16904
    s_waitcnt lgkmcnt(0)
    s_waitcnt vmcnt(12)
    s_barrier
    s_add_u32 m0, s99, 55296
    s_mov_b32 s62, 256
    buffer_load_dwordx4 v57, s[20:23], s62 offen lds
    s_add_u32 m0, s99, 56320
    s_mov_b32 s62, 9472
    buffer_load_dwordx4 v57, s[20:23], s62 offen lds
    s_add_u32 m0, s99, 57344
    s_mov_b32 s62, 18688
    buffer_load_dwordx4 v57, s[20:23], s62 offen lds
    s_add_u32 m0, s99, 58368
    s_mov_b32 s62, 27904
    buffer_load_dwordx4 v57, s[20:23], s62 offen lds
    buffer_store_dwordx2 v[52:53], v6, s[4:7], s42 offen sc1
    ds_read_b64_tr_b16 a[160:161], v60 offset:0
    ds_read_b64_tr_b16 a[162:163], v60 offset:256
    ds_read_b64_tr_b16 a[164:165], v63 offset:0
    ds_read_b64_tr_b16 a[166:167], v63 offset:256
    ds_read_b64_tr_b16 a[168:169], v69 offset:0
    ds_read_b64_tr_b16 a[170:171], v69 offset:256
    ds_read_b64_tr_b16 a[172:173], v70 offset:0
    ds_read_b64_tr_b16 a[174:175], v70 offset:256
    s_waitcnt lgkmcnt(0)
    s_waitcnt vmcnt(13)
    s_barrier
    s_add_u32 m0, s99, 38912
    s_mov_b32 s62, 1572864
    buffer_load_dwordx4 v56, s[12:15], s62 offen lds
    s_add_u32 m0, s99, 39936
    s_mov_b32 s62, 1605632
    buffer_load_dwordx4 v56, s[12:15], s62 offen lds
    s_add_u32 m0, s99, 40960
    s_mov_b32 s62, 1638400
    buffer_load_dwordx4 v56, s[12:15], s62 offen lds
    s_add_u32 m0, s99, 41984
    s_mov_b32 s62, 1671168
    buffer_load_dwordx4 v56, s[12:15], s62 offen lds
    ds_read_b64_tr_b16 v[12:13], v58 offset:4096
    ds_read_b64_tr_b16 v[14:15], v59 offset:4608
    ds_read_b64_tr_b16 v[16:17], v61 offset:4096
    ds_read_b64_tr_b16 v[18:19], v62 offset:4608
    ds_read_b64_tr_b16 v[20:21], v58 offset:4104
    ds_read_b64_tr_b16 v[22:23], v59 offset:4616
    ds_read_b64_tr_b16 v[24:25], v61 offset:4104
    ds_read_b64_tr_b16 v[26:27], v62 offset:4616
    s_waitcnt lgkmcnt(0)
    ds_write_b128 v2, v[12:15] offset:2048
    ds_write_b128 v2, v[16:19] offset:3072
    ds_write_b128 v2, v[20:23] offset:12288
    ds_write_b128 v2, v[24:27] offset:13312
    s_waitcnt vmcnt(13)
    s_barrier
    s_add_u32 m0, s99, 43008
    s_mov_b32 s62, 2097152
    buffer_load_dwordx4 v56, s[8:11], s62 offen lds
    s_add_u32 m0, s99, 44032
    s_mov_b32 s62, 2129920
    buffer_load_dwordx4 v56, s[8:11], s62 offen lds
    s_add_u32 m0, s99, 45056
    s_mov_b32 s62, 2162688
    buffer_load_dwordx4 v56, s[8:11], s62 offen lds
    s_add_u32 m0, s99, 46080
    s_mov_b32 s62, 2195456
    buffer_load_dwordx4 v56, s[8:11], s62 offen lds
    ds_read_b64_tr_b16 v[112:113], v58 offset:8192
    ds_read_b64_tr_b16 v[114:115], v59 offset:8704
    ds_read_b64_tr_b16 v[116:117], v61 offset:8192
    ds_read_b64_tr_b16 v[118:119], v62 offset:8704
    ds_read_b64_tr_b16 v[120:121], v58 offset:8200
    ds_read_b64_tr_b16 v[122:123], v59 offset:8712
    ds_read_b64_tr_b16 v[124:125], v61 offset:8200
    ds_read_b64_tr_b16 v[126:127], v62 offset:8712
    s_waitcnt lgkmcnt(0)
    s_waitcnt vmcnt(13)
    s_barrier
    s_add_u32 m0, s99, 47104
    s_mov_b32 s62, 384
    buffer_load_dwordx4 v57, s[20:23], s62 offen lds
    s_add_u32 m0, s99, 48128
    s_mov_b32 s62, 9600
    buffer_load_dwordx4 v57, s[20:23], s62 offen lds
    s_add_u32 m0, s99, 49152
    s_mov_b32 s62, 18816
    buffer_load_dwordx4 v57, s[20:23], s62 offen lds
    s_add_u32 m0, s99, 50176
    s_mov_b32 s62, 28032
    buffer_load_dwordx4 v57, s[20:23], s62 offen lds
    ds_read_b64_tr_b16 v[128:129], v58 offset:12288
    ds_read_b64_tr_b16 v[130:131], v59 offset:12800
    ds_read_b64_tr_b16 v[132:133], v61 offset:12288
    ds_read_b64_tr_b16 v[134:135], v62 offset:12800
    ds_read_b64_tr_b16 v[136:137], v58 offset:12296
    ds_read_b64_tr_b16 v[138:139], v59 offset:12808
    ds_read_b64_tr_b16 v[140:141], v61 offset:12296
    ds_read_b64_tr_b16 v[142:143], v62 offset:12808
    s_waitcnt lgkmcnt(0)
    s_waitcnt vmcnt(13)
    s_barrier
    s_add_u32 m0, s99, 51200
    s_mov_b32 s62, 2097152
    buffer_load_dwordx4 v56, s[12:15], s62 offen lds
    s_add_u32 m0, s99, 52224
    s_mov_b32 s62, 2129920
    buffer_load_dwordx4 v56, s[12:15], s62 offen lds
    s_add_u32 m0, s99, 53248
    s_mov_b32 s62, 2162688
    buffer_load_dwordx4 v56, s[12:15], s62 offen lds
    s_add_u32 m0, s99, 54272
    s_mov_b32 s62, 2195456
    buffer_load_dwordx4 v56, s[12:15], s62 offen lds
    ds_read_b64_tr_b16 a[176:177], v60 offset:16384
    ds_read_b64_tr_b16 a[178:179], v60 offset:16640
    ds_read_b64_tr_b16 a[180:181], v63 offset:16384
    ds_read_b64_tr_b16 a[182:183], v63 offset:16640
    ds_read_b64_tr_b16 a[184:185], v69 offset:16384
    ds_read_b64_tr_b16 a[186:187], v69 offset:16640
    ds_read_b64_tr_b16 a[188:189], v70 offset:16384
    ds_read_b64_tr_b16 a[190:191], v70 offset:16640
    s_waitcnt lgkmcnt(0)
    s_waitcnt vmcnt(12)
    s_barrier
    s_add_u32 m0, s99, 55296
    s_mov_b32 s62, 2621440
    buffer_load_dwordx4 v56, s[8:11], s62 offen lds
    s_add_u32 m0, s99, 56320
    s_mov_b32 s62, 2654208
    buffer_load_dwordx4 v56, s[8:11], s62 offen lds
    s_add_u32 m0, s99, 57344
    s_mov_b32 s62, 2686976
    buffer_load_dwordx4 v56, s[8:11], s62 offen lds
    s_add_u32 m0, s99, 58368
    s_mov_b32 s62, 2719744
    buffer_load_dwordx4 v56, s[8:11], s62 offen lds
    ds_read_b64_tr_b16 v[144:145], v58 offset:0
    ds_read_b64_tr_b16 v[146:147], v59 offset:512
    ds_read_b64_tr_b16 v[148:149], v61 offset:0
    ds_read_b64_tr_b16 v[150:151], v62 offset:512
    ds_read_b64_tr_b16 v[152:153], v58 offset:8
    ds_read_b64_tr_b16 v[154:155], v59 offset:520
    ds_read_b64_tr_b16 v[156:157], v61 offset:8
    ds_read_b64_tr_b16 v[158:159], v62 offset:520
    s_waitcnt lgkmcnt(0)
    s_waitcnt vmcnt(12)
    s_barrier
    s_add_u32 m0, s99, 38912
    s_mov_b32 s62, 2621440
    buffer_load_dwordx4 v56, s[12:15], s62 offen lds
    s_add_u32 m0, s99, 39936
    s_mov_b32 s62, 2654208
    buffer_load_dwordx4 v56, s[12:15], s62 offen lds
    s_add_u32 m0, s99, 40960
    s_mov_b32 s62, 2686976
    buffer_load_dwordx4 v56, s[12:15], s62 offen lds
    s_add_u32 m0, s99, 41984
    s_mov_b32 s62, 2719744
    buffer_load_dwordx4 v56, s[12:15], s62 offen lds
    ds_read_b64_tr_b16 v[12:13], v58 offset:4096
    ds_read_b64_tr_b16 v[14:15], v59 offset:4608
    ds_read_b64_tr_b16 v[16:17], v61 offset:4096
    ds_read_b64_tr_b16 v[18:19], v62 offset:4608
    ds_read_b64_tr_b16 v[36:37], v58 offset:4104
    ds_read_b64_tr_b16 v[38:39], v59 offset:4616
    ds_read_b64_tr_b16 v[40:41], v61 offset:4104
    ds_read_b64_tr_b16 v[42:43], v62 offset:4616
    s_waitcnt lgkmcnt(0)
    ds_write_b128 v2, v[12:15] offset:4096
    ds_write_b128 v2, v[16:19] offset:5120
    s_waitcnt vmcnt(12)
    s_barrier
    s_add_u32 m0, s99, 43008
    s_mov_b32 s62, 512
    buffer_load_dwordx4 v57, s[20:23], s62 offen lds
    s_add_u32 m0, s99, 44032
    s_mov_b32 s62, 9728
    buffer_load_dwordx4 v57, s[20:23], s62 offen lds
    s_add_u32 m0, s99, 45056
    s_mov_b32 s62, 18944
    buffer_load_dwordx4 v57, s[20:23], s62 offen lds
    s_add_u32 m0, s99, 46080
    s_mov_b32 s62, 28160
    buffer_load_dwordx4 v57, s[20:23], s62 offen lds
    ds_read_b64_tr_b16 a[192:193], v60 offset:8192
    ds_read_b64_tr_b16 a[194:195], v60 offset:8448
    ds_read_b64_tr_b16 a[196:197], v63 offset:8192
    ds_read_b64_tr_b16 a[198:199], v63 offset:8448
    ds_read_b64_tr_b16 a[200:201], v69 offset:8192
    ds_read_b64_tr_b16 a[202:203], v69 offset:8448
    ds_read_b64_tr_b16 a[204:205], v70 offset:8192
    ds_read_b64_tr_b16 a[206:207], v70 offset:8448
    s_waitcnt lgkmcnt(0)
    s_waitcnt vmcnt(12)
    s_barrier
    s_add_u32 m0, s99, 47104
    s_mov_b32 s62, 3145728
    buffer_load_dwordx4 v56, s[8:11], s62 offen lds
    s_add_u32 m0, s99, 48128
    s_mov_b32 s62, 3178496
    buffer_load_dwordx4 v56, s[8:11], s62 offen lds
    s_add_u32 m0, s99, 49152
    s_mov_b32 s62, 3211264
    buffer_load_dwordx4 v56, s[8:11], s62 offen lds
    s_add_u32 m0, s99, 50176
    s_mov_b32 s62, 3244032
    buffer_load_dwordx4 v56, s[8:11], s62 offen lds
    ds_read_b64_tr_b16 v[160:161], v58 offset:12288
    ds_read_b64_tr_b16 v[162:163], v59 offset:12800
    ds_read_b64_tr_b16 v[164:165], v61 offset:12288
    ds_read_b64_tr_b16 v[166:167], v62 offset:12800
    ds_read_b64_tr_b16 v[168:169], v58 offset:12296
    ds_read_b64_tr_b16 v[170:171], v59 offset:12808
    ds_read_b64_tr_b16 v[172:173], v61 offset:12296
    ds_read_b64_tr_b16 v[174:175], v62 offset:12808
    s_waitcnt lgkmcnt(0)
    s_waitcnt vmcnt(12)
    s_barrier
    s_add_u32 m0, s99, 51200
    s_mov_b32 s62, 3145728
    buffer_load_dwordx4 v56, s[12:15], s62 offen lds
    s_add_u32 m0, s99, 52224
    s_mov_b32 s62, 3178496
    buffer_load_dwordx4 v56, s[12:15], s62 offen lds
    s_add_u32 m0, s99, 53248
    s_mov_b32 s62, 3211264
    buffer_load_dwordx4 v56, s[12:15], s62 offen lds
    s_add_u32 m0, s99, 54272
    s_mov_b32 s62, 3244032
    buffer_load_dwordx4 v56, s[12:15], s62 offen lds
    ds_read_b64_tr_b16 v[176:177], v58 offset:16384
    ds_read_b64_tr_b16 v[178:179], v59 offset:16896
    ds_read_b64_tr_b16 v[180:181], v61 offset:16384
    ds_read_b64_tr_b16 v[182:183], v62 offset:16896
    ds_read_b64_tr_b16 v[184:185], v58 offset:16392
    ds_read_b64_tr_b16 v[186:187], v59 offset:16904
    ds_read_b64_tr_b16 v[188:189], v61 offset:16392
    ds_read_b64_tr_b16 v[190:191], v62 offset:16904
    s_waitcnt lgkmcnt(0)
    s_waitcnt vmcnt(12)
    s_barrier
    s_add_u32 m0, s99, 55296
    s_mov_b32 s62, 640
    buffer_load_dwordx4 v57, s[20:23], s62 offen lds
    s_add_u32 m0, s99, 56320
    s_mov_b32 s62, 9856
    buffer_load_dwordx4 v57, s[20:23], s62 offen lds
    s_add_u32 m0, s99, 57344
    s_mov_b32 s62, 19072
    buffer_load_dwordx4 v57, s[20:23], s62 offen lds
    s_add_u32 m0, s99, 58368
    s_mov_b32 s62, 28288
    buffer_load_dwordx4 v57, s[20:23], s62 offen lds
    ds_read_b64_tr_b16 v[192:193], v58 offset:0
    ds_read_b64_tr_b16 v[194:195], v59 offset:512
    ds_read_b64_tr_b16 v[196:197], v61 offset:0
    ds_read_b64_tr_b16 v[198:199], v62 offset:512
    ds_read_b64_tr_b16 v[200:201], v58 offset:8
    ds_read_b64_tr_b16 v[202:203], v59 offset:520
    ds_read_b64_tr_b16 v[204:205], v61 offset:8
    ds_read_b64_tr_b16 v[206:207], v62 offset:520
    s_waitcnt lgkmcnt(0)
    s_waitcnt vmcnt(12)
    s_barrier
    s_add_u32 m0, s99, 38912
    s_mov_b32 s62, 3670016
    buffer_load_dwordx4 v56, s[8:11], s62 offen lds
    s_add_u32 m0, s99, 39936
    s_mov_b32 s62, 3702784
    buffer_load_dwordx4 v56, s[8:11], s62 offen lds
    s_add_u32 m0, s99, 40960
    s_mov_b32 s62, 3735552
    buffer_load_dwordx4 v56, s[8:11], s62 offen lds
    s_add_u32 m0, s99, 41984
    s_mov_b32 s62, 3768320
    buffer_load_dwordx4 v56, s[8:11], s62 offen lds
    ds_read_b64_tr_b16 a[56:57], v60 offset:4096
    ds_read_b64_tr_b16 a[58:59], v60 offset:4352
    ds_read_b64_tr_b16 a[60:61], v63 offset:4096
    ds_read_b64_tr_b16 a[62:63], v63 offset:4352
    ds_read_b64_tr_b16 a[80:81], v69 offset:4096
    ds_read_b64_tr_b16 a[82:83], v69 offset:4352
    ds_read_b64_tr_b16 a[84:85], v70 offset:4096
    ds_read_b64_tr_b16 a[86:87], v70 offset:4352
    s_waitcnt lgkmcnt(0)
    s_waitcnt vmcnt(12)
    s_barrier
    s_add_u32 m0, s99, 43008
    s_mov_b32 s62, 3670016
    buffer_load_dwordx4 v56, s[12:15], s62 offen lds
    s_add_u32 m0, s99, 44032
    s_mov_b32 s62, 3702784
    buffer_load_dwordx4 v56, s[12:15], s62 offen lds
    s_add_u32 m0, s99, 45056
    s_mov_b32 s62, 3735552
    buffer_load_dwordx4 v56, s[12:15], s62 offen lds
    s_add_u32 m0, s99, 46080
    s_mov_b32 s62, 3768320
    buffer_load_dwordx4 v56, s[12:15], s62 offen lds
    ds_read_b64_tr_b16 v[20:21], v58 offset:8192
    ds_read_b64_tr_b16 v[22:23], v59 offset:8704
    ds_read_b64_tr_b16 v[24:25], v61 offset:8192
    ds_read_b64_tr_b16 v[26:27], v62 offset:8704
    ds_read_b64_tr_b16 v[44:45], v58 offset:8200
    ds_read_b64_tr_b16 v[46:47], v59 offset:8712
    ds_read_b64_tr_b16 v[48:49], v61 offset:8200
    ds_read_b64_tr_b16 v[50:51], v62 offset:8712
    s_waitcnt lgkmcnt(0)
    ds_write_b128 v2, v[20:23] offset:6144
    ds_write_b128 v2, v[24:27] offset:7168
    s_waitcnt vmcnt(12)
    s_barrier
    s_add_u32 m0, s99, 47104
    s_mov_b32 s62, 4194304
    buffer_load_dwordx4 v56, s[8:11], s62 offen lds
    s_add_u32 m0, s99, 48128
    s_mov_b32 s62, 4227072
    buffer_load_dwordx4 v56, s[8:11], s62 offen lds
    s_add_u32 m0, s99, 49152
    s_mov_b32 s62, 4259840
    buffer_load_dwordx4 v56, s[8:11], s62 offen lds
    s_add_u32 m0, s99, 50176
    s_mov_b32 s62, 4292608
    buffer_load_dwordx4 v56, s[8:11], s62 offen lds
    ds_read_b64_tr_b16 v[208:209], v58 offset:12288
    ds_read_b64_tr_b16 v[210:211], v59 offset:12800
    ds_read_b64_tr_b16 v[212:213], v61 offset:12288
    ds_read_b64_tr_b16 v[214:215], v62 offset:12800
    ds_read_b64_tr_b16 v[216:217], v58 offset:12296
    ds_read_b64_tr_b16 v[218:219], v59 offset:12808
    ds_read_b64_tr_b16 v[220:221], v61 offset:12296
    ds_read_b64_tr_b16 v[222:223], v62 offset:12808
    s_waitcnt lgkmcnt(0)
    s_waitcnt vmcnt(12)
    s_barrier
    s_add_u32 m0, s99, 51200
    s_mov_b32 s62, 768
    buffer_load_dwordx4 v57, s[20:23], s62 offen lds
    s_add_u32 m0, s99, 52224
    s_mov_b32 s62, 9984
    buffer_load_dwordx4 v57, s[20:23], s62 offen lds
    s_add_u32 m0, s99, 53248
    s_mov_b32 s62, 19200
    buffer_load_dwordx4 v57, s[20:23], s62 offen lds
    s_add_u32 m0, s99, 54272
    s_mov_b32 s62, 28416
    buffer_load_dwordx4 v57, s[20:23], s62 offen lds
    ds_read_b64_tr_b16 a[208:209], v60 offset:16384
    ds_read_b64_tr_b16 a[210:211], v60 offset:16640
    ds_read_b64_tr_b16 a[212:213], v63 offset:16384
    ds_read_b64_tr_b16 a[214:215], v63 offset:16640
    ds_read_b64_tr_b16 a[216:217], v69 offset:16384
    ds_read_b64_tr_b16 a[218:219], v69 offset:16640
    ds_read_b64_tr_b16 a[220:221], v70 offset:16384
    ds_read_b64_tr_b16 a[222:223], v70 offset:16640
    s_waitcnt lgkmcnt(0)
    s_waitcnt vmcnt(12)
    s_barrier
    s_add_u32 m0, s99, 55296
    s_mov_b32 s62, 4194304
    buffer_load_dwordx4 v56, s[12:15], s62 offen lds
    s_add_u32 m0, s99, 56320
    s_mov_b32 s62, 4227072
    buffer_load_dwordx4 v56, s[12:15], s62 offen lds
    s_add_u32 m0, s99, 57344
    s_mov_b32 s62, 4259840
    buffer_load_dwordx4 v56, s[12:15], s62 offen lds
    s_add_u32 m0, s99, 58368
    s_mov_b32 s62, 4292608
    buffer_load_dwordx4 v56, s[12:15], s62 offen lds
    s_mov_b64 exec, 1
    s_lshl_b32 s62, 1, s3
    s_lshl_b32 s62, s62, 8
    v_mov_b32 v52, s62
    v_mov_b32 v53, 1
    buffer_atomic_or v52, off, s[28:31], 0 offset:16
    buffer_atomic_add v53, off, s[28:31], 0 offset:16
    s_mov_b64 exec, -1
    ds_read_b64_tr_b16 v[224:225], v58 offset:0
    ds_read_b64_tr_b16 v[226:227], v59 offset:512
    ds_read_b64_tr_b16 v[228:229], v61 offset:0
    ds_read_b64_tr_b16 v[230:231], v62 offset:512
    ds_read_b64_tr_b16 v[232:233], v58 offset:8
    ds_read_b64_tr_b16 v[234:235], v59 offset:520
    ds_read_b64_tr_b16 v[236:237], v61 offset:8
    ds_read_b64_tr_b16 v[238:239], v62 offset:520
    s_waitcnt lgkmcnt(0)
    s_waitcnt vmcnt(14)
    s_barrier
    s_add_u32 m0, s99, 38912
    s_mov_b32 s62, 2097152
    buffer_load_dwordx4 v56, s[16:19], s62 offen lds
    s_add_u32 m0, s99, 39936
    s_mov_b32 s62, 2129920
    buffer_load_dwordx4 v56, s[16:19], s62 offen lds
    s_add_u32 m0, s99, 40960
    s_mov_b32 s62, 2162688
    buffer_load_dwordx4 v56, s[16:19], s62 offen lds
    s_add_u32 m0, s99, 41984
    s_mov_b32 s62, 2195456
    buffer_load_dwordx4 v56, s[16:19], s62 offen lds
    ds_read_b64_tr_b16 v[240:241], v58 offset:4096
    ds_read_b64_tr_b16 v[242:243], v59 offset:4608
    ds_read_b64_tr_b16 v[244:245], v61 offset:4096
    ds_read_b64_tr_b16 v[246:247], v62 offset:4608
    ds_read_b64_tr_b16 v[12:13], v58 offset:4104
    ds_read_b64_tr_b16 v[14:15], v59 offset:4616
    ds_read_b64_tr_b16 v[16:17], v61 offset:4104
    ds_read_b64_tr_b16 v[18:19], v62 offset:4616
    s_waitcnt lgkmcnt(0)
    ds_write_b128 v2, v[12:15] offset:8192
    ds_write_b128 v2, v[16:19] offset:9216
    s_waitcnt vmcnt(14)
    s_barrier
    s_add_u32 m0, s99, 43008
    s_mov_b32 s62, 896
    buffer_load_dwordx4 v57, s[20:23], s62 offen lds
    s_add_u32 m0, s99, 44032
    s_mov_b32 s62, 10112
    buffer_load_dwordx4 v57, s[20:23], s62 offen lds
    s_add_u32 m0, s99, 45056
    s_mov_b32 s62, 19328
    buffer_load_dwordx4 v57, s[20:23], s62 offen lds
    s_add_u32 m0, s99, 46080
    s_mov_b32 s62, 28544
    buffer_load_dwordx4 v57, s[20:23], s62 offen lds
    ds_read_b64_tr_b16 v[248:249], v58 offset:8192
    ds_read_b64_tr_b16 v[250:251], v59 offset:8704
    ds_read_b64_tr_b16 v[252:253], v61 offset:8192
    ds_read_b64_tr_b16 v[254:255], v62 offset:8704
    ds_read_b64_tr_b16 a[0:1], v58 offset:8200
    ds_read_b64_tr_b16 a[2:3], v59 offset:8712
    ds_read_b64_tr_b16 a[4:5], v61 offset:8200
    ds_read_b64_tr_b16 a[6:7], v62 offset:8712
    s_waitcnt lgkmcnt(0)
    s_waitcnt vmcnt(14)
    s_barrier
    s_add_u32 m0, s99, 47104
    s_mov_b32 s62, 2621440
    buffer_load_dwordx4 v56, s[16:19], s62 offen lds
    s_add_u32 m0, s99, 48128
    s_mov_b32 s62, 2654208
    buffer_load_dwordx4 v56, s[16:19], s62 offen lds
    s_add_u32 m0, s99, 49152
    s_mov_b32 s62, 2686976
    buffer_load_dwordx4 v56, s[16:19], s62 offen lds
    s_add_u32 m0, s99, 50176
    s_mov_b32 s62, 2719744
    buffer_load_dwordx4 v56, s[16:19], s62 offen lds
    ds_read_b64_tr_b16 a[224:225], v60 offset:12288
    ds_read_b64_tr_b16 a[226:227], v60 offset:12544
    ds_read_b64_tr_b16 a[228:229], v63 offset:12288
    ds_read_b64_tr_b16 a[230:231], v63 offset:12544
    ds_read_b64_tr_b16 a[232:233], v69 offset:12288
    ds_read_b64_tr_b16 a[234:235], v69 offset:12544
    ds_read_b64_tr_b16 a[236:237], v70 offset:12288
    ds_read_b64_tr_b16 a[238:239], v70 offset:12544
    s_waitcnt lgkmcnt(0)
    s_waitcnt vmcnt(14)
    s_barrier
    s_add_u32 m0, s99, 51200
    s_mov_b32 s62, 3145728
    buffer_load_dwordx4 v56, s[16:19], s62 offen lds
    s_add_u32 m0, s99, 52224
    s_mov_b32 s62, 3178496
    buffer_load_dwordx4 v56, s[16:19], s62 offen lds
    s_add_u32 m0, s99, 53248
    s_mov_b32 s62, 3211264
    buffer_load_dwordx4 v56, s[16:19], s62 offen lds
    s_add_u32 m0, s99, 54272
    s_mov_b32 s62, 3244032
    buffer_load_dwordx4 v56, s[16:19], s62 offen lds
    buffer_load_dword v64, off, s[28:31], 0 offset:144 sc1
    ds_read_b64_tr_b16 a[8:9], v58 offset:16384
    ds_read_b64_tr_b16 a[10:11], v59 offset:16896
    ds_read_b64_tr_b16 a[12:13], v61 offset:16384
    ds_read_b64_tr_b16 a[14:15], v62 offset:16896
    ds_read_b64_tr_b16 a[16:17], v58 offset:16392
    ds_read_b64_tr_b16 a[18:19], v59 offset:16904
    ds_read_b64_tr_b16 a[20:21], v61 offset:16392
    ds_read_b64_tr_b16 a[22:23], v62 offset:16904
    s_waitcnt lgkmcnt(0)
    v_mov_b32 v58, v55
    v_xor_b32 v59, 0x80, v55
    v_add_u32 v61, 69632, v58
    v_add_u32 v62, 69632, v59
    s_waitcnt vmcnt(13)
    s_barrier
    s_add_u32 m0, s99, 55296
    s_mov_b32 s62, 3670016
    buffer_load_dwordx4 v56, s[16:19], s62 offen lds
    s_add_u32 m0, s99, 56320
    s_mov_b32 s62, 3702784
    buffer_load_dwordx4 v56, s[16:19], s62 offen lds
    s_add_u32 m0, s99, 57344
    s_mov_b32 s62, 3735552
    buffer_load_dwordx4 v56, s[16:19], s62 offen lds
    s_add_u32 m0, s99, 58368
    s_mov_b32 s62, 3768320
    buffer_load_dwordx4 v56, s[16:19], s62 offen lds
    ds_read_b64_tr_b16 a[88:89], v58 offset:0
    ds_read_b64_tr_b16 a[90:91], v59 offset:512
    ds_read_b64_tr_b16 a[92:93], v61 offset:0
    ds_read_b64_tr_b16 a[94:95], v62 offset:512
    ds_read_b64_tr_b16 a[96:97], v58 offset:8
    ds_read_b64_tr_b16 a[98:99], v59 offset:520
    ds_read_b64_tr_b16 a[100:101], v61 offset:8
    ds_read_b64_tr_b16 a[102:103], v62 offset:520
    s_waitcnt lgkmcnt(0)
    s_waitcnt vmcnt(13)
    s_barrier
    s_add_u32 m0, s99, 38912
    s_mov_b32 s62, 1024
    buffer_load_dwordx4 v57, s[20:23], s62 offen lds
    s_add_u32 m0, s99, 39936
    s_mov_b32 s62, 10240
    buffer_load_dwordx4 v57, s[20:23], s62 offen lds
    s_add_u32 m0, s99, 40960
    s_mov_b32 s62, 19456
    buffer_load_dwordx4 v57, s[20:23], s62 offen lds
    s_add_u32 m0, s99, 41984
    s_mov_b32 s62, 28672
    buffer_load_dwordx4 v57, s[20:23], s62 offen lds
    ds_read_b64_tr_b16 a[240:241], v60 offset:4096
    ds_read_b64_tr_b16 a[242:243], v60 offset:4352
    ds_read_b64_tr_b16 a[244:245], v63 offset:4096
    ds_read_b64_tr_b16 a[246:247], v63 offset:4352
    ds_read_b64_tr_b16 a[248:249], v69 offset:4096
    ds_read_b64_tr_b16 a[250:251], v69 offset:4352
    ds_read_b64_tr_b16 a[252:253], v70 offset:4096
    ds_read_b64_tr_b16 a[254:255], v70 offset:4352
    s_waitcnt lgkmcnt(0)
    s_waitcnt vmcnt(13)
    s_barrier
    s_add_u32 m0, s99, 43008
    s_mov_b32 s62, 4194304
    buffer_load_dwordx4 v56, s[16:19], s62 offen lds
    s_add_u32 m0, s99, 44032
    s_mov_b32 s62, 4227072
    buffer_load_dwordx4 v56, s[16:19], s62 offen lds
    s_add_u32 m0, s99, 45056
    s_mov_b32 s62, 4259840
    buffer_load_dwordx4 v56, s[16:19], s62 offen lds
    s_add_u32 m0, s99, 46080
    s_mov_b32 s62, 4292608
    buffer_load_dwordx4 v56, s[16:19], s62 offen lds
    ds_read_b64_tr_b16 a[104:105], v58 offset:8192
    ds_read_b64_tr_b16 a[106:107], v59 offset:8704
    ds_read_b64_tr_b16 a[108:109], v61 offset:8192
    ds_read_b64_tr_b16 a[110:111], v62 offset:8704
    ds_read_b64_tr_b16 v[20:21], v58 offset:8200
    ds_read_b64_tr_b16 v[22:23], v59 offset:8712
    ds_read_b64_tr_b16 v[24:25], v61 offset:8200
    ds_read_b64_tr_b16 v[26:27], v62 offset:8712
    s_waitcnt lgkmcnt(0)
    buffer_store_dwordx4 v[20:23], v0, s[4:7], s96 offen offset:0
    buffer_store_dwordx4 v[24:27], v0, s[4:7], s96 offen offset:1024
    s_waitcnt vmcnt(15)
    s_barrier
    s_add_u32 m0, s99, 47104
    s_mov_b32 s62, 0
    buffer_load_dwordx4 v56, s[16:19], s62 offen lds
    s_add_u32 m0, s99, 48128
    s_mov_b32 s62, 32768
    buffer_load_dwordx4 v56, s[16:19], s62 offen lds
    s_add_u32 m0, s99, 49152
    s_mov_b32 s62, 65536
    buffer_load_dwordx4 v56, s[16:19], s62 offen lds
    s_add_u32 m0, s99, 50176
    s_mov_b32 s62, 98304
    buffer_load_dwordx4 v56, s[16:19], s62 offen lds
    ds_read_b64_tr_b16 a[112:113], v58 offset:12288
    ds_read_b64_tr_b16 a[114:115], v59 offset:12800
    ds_read_b64_tr_b16 a[116:117], v61 offset:12288
    ds_read_b64_tr_b16 a[118:119], v62 offset:12800
    ds_read_b64_tr_b16 a[120:121], v58 offset:12296
    ds_read_b64_tr_b16 a[122:123], v59 offset:12808
    ds_read_b64_tr_b16 a[124:125], v61 offset:12296
    ds_read_b64_tr_b16 a[126:127], v62 offset:12808
    s_waitcnt lgkmcnt(0)
    s_waitcnt vmcnt(14)
    s_barrier
    s_add_u32 m0, s99, 51200
    s_mov_b32 s62, 524288
    buffer_load_dwordx4 v56, s[16:19], s62 offen lds
    s_add_u32 m0, s99, 52224
    s_mov_b32 s62, 557056
    buffer_load_dwordx4 v56, s[16:19], s62 offen lds
    s_add_u32 m0, s99, 53248
    s_mov_b32 s62, 589824
    buffer_load_dwordx4 v56, s[16:19], s62 offen lds
    s_add_u32 m0, s99, 54272
    s_mov_b32 s62, 622592
    buffer_load_dwordx4 v56, s[16:19], s62 offen lds
    ds_read_b64_tr_b16 a[128:129], v58 offset:16384
    ds_read_b64_tr_b16 a[130:131], v59 offset:16896
    ds_read_b64_tr_b16 a[132:133], v61 offset:16384
    ds_read_b64_tr_b16 a[134:135], v62 offset:16896
    ds_read_b64_tr_b16 a[136:137], v58 offset:16392
    ds_read_b64_tr_b16 a[138:139], v59 offset:16904
    ds_read_b64_tr_b16 a[140:141], v61 offset:16392
    ds_read_b64_tr_b16 a[142:143], v62 offset:16904
    s_waitcnt lgkmcnt(0)
    s_waitcnt vmcnt(14)
    s_barrier
    s_add_u32 m0, s99, 55296
    s_mov_b32 s62, 1048576
    buffer_load_dwordx4 v56, s[16:19], s62 offen lds
    s_add_u32 m0, s99, 56320
    s_mov_b32 s62, 1081344
    buffer_load_dwordx4 v56, s[16:19], s62 offen lds
    s_add_u32 m0, s99, 57344
    s_mov_b32 s62, 1114112
    buffer_load_dwordx4 v56, s[16:19], s62 offen lds
    s_add_u32 m0, s99, 58368
    s_mov_b32 s62, 1146880
    buffer_load_dwordx4 v56, s[16:19], s62 offen lds
    ds_read_b64_tr_b16 a[64:65], v60 offset:0
    ds_read_b64_tr_b16 a[66:67], v60 offset:256
    ds_read_b64_tr_b16 a[68:69], v63 offset:0
    ds_read_b64_tr_b16 a[70:71], v63 offset:256
    ds_read_b64_tr_b16 v[28:29], v69 offset:0
    ds_read_b64_tr_b16 v[30:31], v69 offset:256
    ds_read_b64_tr_b16 v[32:33], v70 offset:0
    ds_read_b64_tr_b16 v[34:35], v70 offset:256
    s_waitcnt lgkmcnt(0)
    s_waitcnt vmcnt(14)
    s_barrier
    s_add_u32 m0, s99, 38912
    s_mov_b32 s62, 1572864
    buffer_load_dwordx4 v56, s[16:19], s62 offen lds
    s_add_u32 m0, s99, 39936
    s_mov_b32 s62, 1605632
    buffer_load_dwordx4 v56, s[16:19], s62 offen lds
    s_add_u32 m0, s99, 40960
    s_mov_b32 s62, 1638400
    buffer_load_dwordx4 v56, s[16:19], s62 offen lds
    s_add_u32 m0, s99, 41984
    s_mov_b32 s62, 1671168
    buffer_load_dwordx4 v56, s[16:19], s62 offen lds
    ds_read_b64_tr_b16 a[144:145], v58 offset:4096
    ds_read_b64_tr_b16 a[146:147], v59 offset:4608
    ds_read_b64_tr_b16 a[148:149], v61 offset:4096
    ds_read_b64_tr_b16 a[150:151], v62 offset:4608
    ds_read_b64_tr_b16 a[152:153], v58 offset:4104
    ds_read_b64_tr_b16 a[154:155], v59 offset:4616
    ds_read_b64_tr_b16 a[156:157], v61 offset:4104
    ds_read_b64_tr_b16 a[158:159], v62 offset:4616
    s_waitcnt lgkmcnt(0)
    s_waitcnt vmcnt(12)
    s_barrier
    ds_write_b128 v2, a[40:43] offset:18432
    ds_write_b128 v2, a[44:47] offset:19456
    ds_write_b128 v2, a[48:51] offset:20480
    ds_write_b128 v2, a[52:55] offset:21504
    ds_read_b64_tr_b16 a[24:25], v58 offset:8192
    ds_read_b64_tr_b16 a[26:27], v59 offset:8704
    ds_read_b64_tr_b16 a[28:29], v61 offset:8192
    ds_read_b64_tr_b16 a[30:31], v62 offset:8704
    ds_read_b64_tr_b16 a[32:33], v58 offset:8200
    ds_read_b64_tr_b16 a[34:35], v59 offset:8712
    ds_read_b64_tr_b16 a[36:37], v61 offset:8200
    ds_read_b64_tr_b16 a[38:39], v62 offset:8712
    s_waitcnt lgkmcnt(0)
    s_waitcnt vmcnt(8)
    s_barrier
    ds_write_b128 v2, a[56:59] offset:22528
    ds_write_b128 v2, a[60:63] offset:23552
    ds_write_b128 v2, a[64:67] offset:24576
    ds_write_b128 v2, a[68:71] offset:25600
    ds_read_b64_tr_b16 a[40:41], v58 offset:12288
    ds_read_b64_tr_b16 a[42:43], v59 offset:12800
    ds_read_b64_tr_b16 a[44:45], v61 offset:12288
    ds_read_b64_tr_b16 a[46:47], v62 offset:12800
    ds_read_b64_tr_b16 a[48:49], v58 offset:12296
    ds_read_b64_tr_b16 a[50:51], v59 offset:12808
    ds_read_b64_tr_b16 a[52:53], v61 offset:12296
    ds_read_b64_tr_b16 a[54:55], v62 offset:12808
    s_waitcnt lgkmcnt(0)
    s_waitcnt vmcnt(4)
    s_barrier
    v_lshrrev_b32 v65, 2, v0
    s_lshl_b32 s62, s32, 8
    s_add_u32 s62, s62, 81789952
    buffer_load_dword v65, v65, s[4:7], s62 offen sc1
    buffer_load_dword v66, off, s[28:31], 0 offset:16 sc1
    ds_write_b128 v2, a[72:75] offset:26624
    ds_write_b128 v2, a[76:79] offset:27648
    ds_write_b128 v2, a[80:83] offset:28672
    ds_write_b128 v2, a[84:87] offset:29696
    ds_read_b64_tr_b16 a[56:57], v58 offset:16384
    ds_read_b64_tr_b16 a[58:59], v59 offset:16896
    ds_read_b64_tr_b16 a[60:61], v61 offset:16384
    ds_read_b64_tr_b16 a[62:63], v62 offset:16896
    ds_read_b64_tr_b16 a[64:65], v58 offset:16392
    ds_read_b64_tr_b16 a[66:67], v59 offset:16904
    ds_read_b64_tr_b16 a[68:69], v61 offset:16392
    ds_read_b64_tr_b16 a[70:71], v62 offset:16904
    s_waitcnt lgkmcnt(0)
    s_waitcnt vmcnt(2)
    s_barrier
    ds_write_b128 v2, v[28:31] offset:30720
    ds_write_b128 v2, v[32:35] offset:31744
    ds_read_b64_tr_b16 a[72:73], v58 offset:0
    ds_read_b64_tr_b16 a[74:75], v59 offset:512
    ds_read_b64_tr_b16 a[76:77], v61 offset:0
    ds_read_b64_tr_b16 a[78:79], v62 offset:512
    ds_read_b64_tr_b16 a[80:81], v58 offset:8
    ds_read_b64_tr_b16 a[82:83], v59 offset:520
    ds_read_b64_tr_b16 a[84:85], v61 offset:8
    ds_read_b64_tr_b16 a[86:87], v62 offset:520
    s_waitcnt lgkmcnt(0)
    s_barrier
    ds_write_b128 v2, v[36:39] offset:14336
    ds_write_b128 v2, v[40:43] offset:15360
    ds_write_b128 v2, v[44:47] offset:16384
    ds_write_b128 v2, v[48:51] offset:17408
    s_branch L_initjoin_1
L_cls1_3:
    v_add_u32 v63, 34816, v60
    v_add_u32 v69, 69632, v60
    v_add_u32 v70, 104448, v60
    v_mov_b32 v58, v54
    v_xor_b32 v59, 0x80, v54
    v_add_u32 v61, 69632, v58
    v_add_u32 v62, 69632, v59
    s_waitcnt vmcnt(19)
    s_barrier
    s_add_u32 m0, s99, 55296
    s_mov_b32 s62, 524288
    buffer_load_dwordx4 v56, s[12:15], s62 offen lds
    s_add_u32 m0, s99, 56320
    s_mov_b32 s62, 557056
    buffer_load_dwordx4 v56, s[12:15], s62 offen lds
    s_add_u32 m0, s99, 57344
    s_mov_b32 s62, 589824
    buffer_load_dwordx4 v56, s[12:15], s62 offen lds
    s_add_u32 m0, s99, 58368
    s_mov_b32 s62, 622592
    buffer_load_dwordx4 v56, s[12:15], s62 offen lds
    ds_read_b64_tr_b16 v[80:81], v58 offset:0
    ds_read_b64_tr_b16 v[82:83], v59 offset:512
    ds_read_b64_tr_b16 v[84:85], v61 offset:0
    ds_read_b64_tr_b16 v[86:87], v62 offset:512
    ds_read_b64_tr_b16 v[88:89], v58 offset:8
    ds_read_b64_tr_b16 v[90:91], v59 offset:520
    ds_read_b64_tr_b16 v[92:93], v61 offset:8
    ds_read_b64_tr_b16 v[94:95], v62 offset:520
    s_waitcnt lgkmcnt(0)
    s_waitcnt vmcnt(19)
    s_barrier
    s_add_u32 m0, s99, 38912
    s_mov_b32 s62, 128
    buffer_load_dwordx4 v57, s[20:23], s62 offen lds
    s_add_u32 m0, s99, 39936
    s_mov_b32 s62, 9344
    buffer_load_dwordx4 v57, s[20:23], s62 offen lds
    s_add_u32 m0, s99, 40960
    s_mov_b32 s62, 18560
    buffer_load_dwordx4 v57, s[20:23], s62 offen lds
    s_add_u32 m0, s99, 41984
    s_mov_b32 s62, 27776
    buffer_load_dwordx4 v57, s[20:23], s62 offen lds
    ds_read_b64_tr_b16 v[96:97], v58 offset:4096
    ds_read_b64_tr_b16 v[98:99], v59 offset:4608
    ds_read_b64_tr_b16 v[100:101], v61 offset:4096
    ds_read_b64_tr_b16 v[102:103], v62 offset:4608
    ds_read_b64_tr_b16 v[104:105], v58 offset:4104
    ds_read_b64_tr_b16 v[106:107], v59 offset:4616
    ds_read_b64_tr_b16 v[108:109], v61 offset:4104
    ds_read_b64_tr_b16 v[110:111], v62 offset:4616
    s_waitcnt lgkmcnt(0)
    s_waitcnt vmcnt(19)
    s_barrier
    s_add_u32 m0, s99, 43008
    s_mov_b32 s62, 1048576
    buffer_load_dwordx4 v56, s[8:11], s62 offen lds
    s_add_u32 m0, s99, 44032
    s_mov_b32 s62, 1081344
    buffer_load_dwordx4 v56, s[8:11], s62 offen lds
    s_add_u32 m0, s99, 45056
    s_mov_b32 s62, 1114112
    buffer_load_dwordx4 v56, s[8:11], s62 offen lds
    s_add_u32 m0, s99, 46080
    s_mov_b32 s62, 1146880
    buffer_load_dwordx4 v56, s[8:11], s62 offen lds
    ds_read_b64_tr_b16 a[32:33], v60 offset:8192
    ds_read_b64_tr_b16 a[34:35], v60 offset:8448
    ds_read_b64_tr_b16 a[36:37], v63 offset:8192
    ds_read_b64_tr_b16 a[38:39], v63 offset:8448
    ds_read_b64_tr_b16 a[72:73], v69 offset:8192
    ds_read_b64_tr_b16 a[74:75], v69 offset:8448
    ds_read_b64_tr_b16 a[76:77], v70 offset:8192
    ds_read_b64_tr_b16 a[78:79], v70 offset:8448
    s_waitcnt lgkmcnt(0)
    s_waitcnt vmcnt(19)
    s_barrier
    s_add_u32 m0, s99, 47104
    s_mov_b32 s62, 1048576
    buffer_load_dwordx4 v56, s[12:15], s62 offen lds
    s_add_u32 m0, s99, 48128
    s_mov_b32 s62, 1081344
    buffer_load_dwordx4 v56, s[12:15], s62 offen lds
    s_add_u32 m0, s99, 49152
    s_mov_b32 s62, 1114112
    buffer_load_dwordx4 v56, s[12:15], s62 offen lds
    s_add_u32 m0, s99, 50176
    s_mov_b32 s62, 1146880
    buffer_load_dwordx4 v56, s[12:15], s62 offen lds
    ds_read_b64_tr_b16 a[24:25], v58 offset:12288
    ds_read_b64_tr_b16 a[26:27], v59 offset:12800
    ds_read_b64_tr_b16 a[28:29], v61 offset:12288
    ds_read_b64_tr_b16 a[30:31], v62 offset:12800
    ds_read_b64_tr_b16 v[12:13], v58 offset:12296
    ds_read_b64_tr_b16 v[14:15], v59 offset:12808
    ds_read_b64_tr_b16 v[16:17], v61 offset:12296
    ds_read_b64_tr_b16 v[18:19], v62 offset:12808
    s_waitcnt lgkmcnt(0)
    ds_write_b128 v2, v[12:15] offset:0
    ds_write_b128 v2, v[16:19] offset:1024
    s_waitcnt vmcnt(12)
    s_barrier
    s_add_u32 m0, s99, 51200
    s_mov_b32 s62, 1572864
    buffer_load_dwordx4 v56, s[8:11], s62 offen lds
    s_add_u32 m0, s99, 52224
    s_mov_b32 s62, 1605632
    buffer_load_dwordx4 v56, s[8:11], s62 offen lds
    s_add_u32 m0, s99, 53248
    s_mov_b32 s62, 1638400
    buffer_load_dwordx4 v56, s[8:11], s62 offen lds
    s_add_u32 m0, s99, 54272
    s_mov_b32 s62, 1671168
    buffer_load_dwordx4 v56, s[8:11], s62 offen lds
    ds_read_b64_tr_b16 v[20:21], v58 offset:16384
    ds_read_b64_tr_b16 v[22:23], v59 offset:16896
    ds_read_b64_tr_b16 v[24:25], v61 offset:16384
    ds_read_b64_tr_b16 v[26:27], v62 offset:16896
    ds_read_b64_tr_b16 v[72:73], v58 offset:16392
    ds_read_b64_tr_b16 v[74:75], v59 offset:16904
    ds_read_b64_tr_b16 v[76:77], v61 offset:16392
    ds_read_b64_tr_b16 v[78:79], v62 offset:16904
    s_waitcnt lgkmcnt(0)
    ds_write_b128 v2, v[20:23] offset:10240
    ds_write_b128 v2, v[24:27] offset:11264
    s_waitcnt vmcnt(12)
    s_barrier
    s_add_u32 m0, s99, 55296
    s_mov_b32 s62, 256
    buffer_load_dwordx4 v57, s[20:23], s62 offen lds
    s_add_u32 m0, s99, 56320
    s_mov_b32 s62, 9472
    buffer_load_dwordx4 v57, s[20:23], s62 offen lds
    s_add_u32 m0, s99, 57344
    s_mov_b32 s62, 18688
    buffer_load_dwordx4 v57, s[20:23], s62 offen lds
    s_add_u32 m0, s99, 58368
    s_mov_b32 s62, 27904
    buffer_load_dwordx4 v57, s[20:23], s62 offen lds
    buffer_store_dwordx2 v[52:53], v6, s[4:7], s42 offen sc1
    ds_read_b64_tr_b16 a[160:161], v60 offset:0
    ds_read_b64_tr_b16 a[162:163], v60 offset:256
    ds_read_b64_tr_b16 a[164:165], v63 offset:0
    ds_read_b64_tr_b16 a[166:167], v63 offset:256
    ds_read_b64_tr_b16 a[168:169], v69 offset:0
    ds_read_b64_tr_b16 a[170:171], v69 offset:256
    ds_read_b64_tr_b16 a[172:173], v70 offset:0
    ds_read_b64_tr_b16 a[174:175], v70 offset:256
    s_waitcnt lgkmcnt(0)
    s_waitcnt vmcnt(13)
    s_barrier
    s_add_u32 m0, s99, 38912
    s_mov_b32 s62, 1572864
    buffer_load_dwordx4 v56, s[12:15], s62 offen lds
    s_add_u32 m0, s99, 39936
    s_mov_b32 s62, 1605632
    buffer_load_dwordx4 v56, s[12:15], s62 offen lds
    s_add_u32 m0, s99, 40960
    s_mov_b32 s62, 1638400
    buffer_load_dwordx4 v56, s[12:15], s62 offen lds
    s_add_u32 m0, s99, 41984
    s_mov_b32 s62, 1671168
    buffer_load_dwordx4 v56, s[12:15], s62 offen lds
    ds_read_b64_tr_b16 v[12:13], v58 offset:4096
    ds_read_b64_tr_b16 v[14:15], v59 offset:4608
    ds_read_b64_tr_b16 v[16:17], v61 offset:4096
    ds_read_b64_tr_b16 v[18:19], v62 offset:4608
    ds_read_b64_tr_b16 v[20:21], v58 offset:4104
    ds_read_b64_tr_b16 v[22:23], v59 offset:4616
    ds_read_b64_tr_b16 v[24:25], v61 offset:4104
    ds_read_b64_tr_b16 v[26:27], v62 offset:4616
    s_waitcnt lgkmcnt(0)
    ds_write_b128 v2, v[12:15] offset:2048
    ds_write_b128 v2, v[16:19] offset:3072
    ds_write_b128 v2, v[20:23] offset:12288
    ds_write_b128 v2, v[24:27] offset:13312
    s_waitcnt vmcnt(13)
    s_barrier
    s_add_u32 m0, s99, 43008
    s_mov_b32 s62, 2097152
    buffer_load_dwordx4 v56, s[8:11], s62 offen lds
    s_add_u32 m0, s99, 44032
    s_mov_b32 s62, 2129920
    buffer_load_dwordx4 v56, s[8:11], s62 offen lds
    s_add_u32 m0, s99, 45056
    s_mov_b32 s62, 2162688
    buffer_load_dwordx4 v56, s[8:11], s62 offen lds
    s_add_u32 m0, s99, 46080
    s_mov_b32 s62, 2195456
    buffer_load_dwordx4 v56, s[8:11], s62 offen lds
    ds_read_b64_tr_b16 v[112:113], v58 offset:8192
    ds_read_b64_tr_b16 v[114:115], v59 offset:8704
    ds_read_b64_tr_b16 v[116:117], v61 offset:8192
    ds_read_b64_tr_b16 v[118:119], v62 offset:8704
    ds_read_b64_tr_b16 v[120:121], v58 offset:8200
    ds_read_b64_tr_b16 v[122:123], v59 offset:8712
    ds_read_b64_tr_b16 v[124:125], v61 offset:8200
    ds_read_b64_tr_b16 v[126:127], v62 offset:8712
    s_waitcnt lgkmcnt(0)
    s_waitcnt vmcnt(13)
    s_barrier
    s_add_u32 m0, s99, 47104
    s_mov_b32 s62, 384
    buffer_load_dwordx4 v57, s[20:23], s62 offen lds
    s_add_u32 m0, s99, 48128
    s_mov_b32 s62, 9600
    buffer_load_dwordx4 v57, s[20:23], s62 offen lds
    s_add_u32 m0, s99, 49152
    s_mov_b32 s62, 18816
    buffer_load_dwordx4 v57, s[20:23], s62 offen lds
    s_add_u32 m0, s99, 50176
    s_mov_b32 s62, 28032
    buffer_load_dwordx4 v57, s[20:23], s62 offen lds
    ds_read_b64_tr_b16 v[128:129], v58 offset:12288
    ds_read_b64_tr_b16 v[130:131], v59 offset:12800
    ds_read_b64_tr_b16 v[132:133], v61 offset:12288
    ds_read_b64_tr_b16 v[134:135], v62 offset:12800
    ds_read_b64_tr_b16 v[136:137], v58 offset:12296
    ds_read_b64_tr_b16 v[138:139], v59 offset:12808
    ds_read_b64_tr_b16 v[140:141], v61 offset:12296
    ds_read_b64_tr_b16 v[142:143], v62 offset:12808
    s_waitcnt lgkmcnt(0)
    s_waitcnt vmcnt(13)
    s_barrier
    s_add_u32 m0, s99, 51200
    s_mov_b32 s62, 2097152
    buffer_load_dwordx4 v56, s[12:15], s62 offen lds
    s_add_u32 m0, s99, 52224
    s_mov_b32 s62, 2129920
    buffer_load_dwordx4 v56, s[12:15], s62 offen lds
    s_add_u32 m0, s99, 53248
    s_mov_b32 s62, 2162688
    buffer_load_dwordx4 v56, s[12:15], s62 offen lds
    s_add_u32 m0, s99, 54272
    s_mov_b32 s62, 2195456
    buffer_load_dwordx4 v56, s[12:15], s62 offen lds
    ds_read_b64_tr_b16 a[176:177], v60 offset:16384
    ds_read_b64_tr_b16 a[178:179], v60 offset:16640
    ds_read_b64_tr_b16 a[180:181], v63 offset:16384
    ds_read_b64_tr_b16 a[182:183], v63 offset:16640
    ds_read_b64_tr_b16 a[184:185], v69 offset:16384
    ds_read_b64_tr_b16 a[186:187], v69 offset:16640
    ds_read_b64_tr_b16 a[188:189], v70 offset:16384
    ds_read_b64_tr_b16 a[190:191], v70 offset:16640
    s_waitcnt lgkmcnt(0)
    s_waitcnt vmcnt(12)
    s_barrier
    s_add_u32 m0, s99, 55296
    s_mov_b32 s62, 2621440
    buffer_load_dwordx4 v56, s[8:11], s62 offen lds
    s_add_u32 m0, s99, 56320
    s_mov_b32 s62, 2654208
    buffer_load_dwordx4 v56, s[8:11], s62 offen lds
    s_add_u32 m0, s99, 57344
    s_mov_b32 s62, 2686976
    buffer_load_dwordx4 v56, s[8:11], s62 offen lds
    s_add_u32 m0, s99, 58368
    s_mov_b32 s62, 2719744
    buffer_load_dwordx4 v56, s[8:11], s62 offen lds
    ds_read_b64_tr_b16 v[144:145], v58 offset:0
    ds_read_b64_tr_b16 v[146:147], v59 offset:512
    ds_read_b64_tr_b16 v[148:149], v61 offset:0
    ds_read_b64_tr_b16 v[150:151], v62 offset:512
    ds_read_b64_tr_b16 v[152:153], v58 offset:8
    ds_read_b64_tr_b16 v[154:155], v59 offset:520
    ds_read_b64_tr_b16 v[156:157], v61 offset:8
    ds_read_b64_tr_b16 v[158:159], v62 offset:520
    s_waitcnt lgkmcnt(0)
    s_waitcnt vmcnt(12)
    s_barrier
    s_add_u32 m0, s99, 38912
    s_mov_b32 s62, 2621440
    buffer_load_dwordx4 v56, s[12:15], s62 offen lds
    s_add_u32 m0, s99, 39936
    s_mov_b32 s62, 2654208
    buffer_load_dwordx4 v56, s[12:15], s62 offen lds
    s_add_u32 m0, s99, 40960
    s_mov_b32 s62, 2686976
    buffer_load_dwordx4 v56, s[12:15], s62 offen lds
    s_add_u32 m0, s99, 41984
    s_mov_b32 s62, 2719744
    buffer_load_dwordx4 v56, s[12:15], s62 offen lds
    ds_read_b64_tr_b16 v[176:177], v58 offset:4096
    ds_read_b64_tr_b16 v[178:179], v59 offset:4608
    ds_read_b64_tr_b16 v[180:181], v61 offset:4096
    ds_read_b64_tr_b16 v[182:183], v62 offset:4608
    ds_read_b64_tr_b16 v[184:185], v58 offset:4104
    ds_read_b64_tr_b16 v[186:187], v59 offset:4616
    ds_read_b64_tr_b16 v[188:189], v61 offset:4104
    ds_read_b64_tr_b16 v[190:191], v62 offset:4616
    s_waitcnt lgkmcnt(0)
    s_waitcnt vmcnt(12)
    s_barrier
    s_add_u32 m0, s99, 43008
    s_mov_b32 s62, 512
    buffer_load_dwordx4 v57, s[20:23], s62 offen lds
    s_add_u32 m0, s99, 44032
    s_mov_b32 s62, 9728
    buffer_load_dwordx4 v57, s[20:23], s62 offen lds
    s_add_u32 m0, s99, 45056
    s_mov_b32 s62, 18944
    buffer_load_dwordx4 v57, s[20:23], s62 offen lds
    s_add_u32 m0, s99, 46080
    s_mov_b32 s62, 28160
    buffer_load_dwordx4 v57, s[20:23], s62 offen lds
    ds_read_b64_tr_b16 a[192:193], v60 offset:8192
    ds_read_b64_tr_b16 a[194:195], v60 offset:8448
    ds_read_b64_tr_b16 a[196:197], v63 offset:8192
    ds_read_b64_tr_b16 a[198:199], v63 offset:8448
    ds_read_b64_tr_b16 a[200:201], v69 offset:8192
    ds_read_b64_tr_b16 a[202:203], v69 offset:8448
    ds_read_b64_tr_b16 a[204:205], v70 offset:8192
    ds_read_b64_tr_b16 a[206:207], v70 offset:8448
    s_waitcnt lgkmcnt(0)
    s_waitcnt vmcnt(12)
    s_barrier
    s_add_u32 m0, s99, 47104
    s_mov_b32 s62, 3145728
    buffer_load_dwordx4 v56, s[8:11], s62 offen lds
    s_add_u32 m0, s99, 48128
    s_mov_b32 s62, 3178496
    buffer_load_dwordx4 v56, s[8:11], s62 offen lds
    s_add_u32 m0, s99, 49152
    s_mov_b32 s62, 3211264
    buffer_load_dwordx4 v56, s[8:11], s62 offen lds
    s_add_u32 m0, s99, 50176
    s_mov_b32 s62, 3244032
    buffer_load_dwordx4 v56, s[8:11], s62 offen lds
    ds_read_b64_tr_b16 v[192:193], v58 offset:12288
    ds_read_b64_tr_b16 v[194:195], v59 offset:12800
    ds_read_b64_tr_b16 v[196:197], v61 offset:12288
    ds_read_b64_tr_b16 v[198:199], v62 offset:12800
    ds_read_b64_tr_b16 v[200:201], v58 offset:12296
    ds_read_b64_tr_b16 v[202:203], v59 offset:12808
    ds_read_b64_tr_b16 v[204:205], v61 offset:12296
    ds_read_b64_tr_b16 v[206:207], v62 offset:12808
    s_waitcnt lgkmcnt(0)
    s_waitcnt vmcnt(12)
    s_barrier
    s_add_u32 m0, s99, 51200
    s_mov_b32 s62, 3145728
    buffer_load_dwordx4 v56, s[12:15], s62 offen lds
    s_add_u32 m0, s99, 52224
    s_mov_b32 s62, 3178496
    buffer_load_dwordx4 v56, s[12:15], s62 offen lds
    s_add_u32 m0, s99, 53248
    s_mov_b32 s62, 3211264
    buffer_load_dwordx4 v56, s[12:15], s62 offen lds
    s_add_u32 m0, s99, 54272
    s_mov_b32 s62, 3244032
    buffer_load_dwordx4 v56, s[12:15], s62 offen lds
    ds_read_b64_tr_b16 v[12:13], v58 offset:16384
    ds_read_b64_tr_b16 v[14:15], v59 offset:16896
    ds_read_b64_tr_b16 v[16:17], v61 offset:16384
    ds_read_b64_tr_b16 v[18:19], v62 offset:16896
    ds_read_b64_tr_b16 v[36:37], v58 offset:16392
    ds_read_b64_tr_b16 v[38:39], v59 offset:16904
    ds_read_b64_tr_b16 v[40:41], v61 offset:16392
    ds_read_b64_tr_b16 v[42:43], v62 offset:16904
    s_waitcnt lgkmcnt(0)
    ds_write_b128 v2, v[12:15] offset:4096
    ds_write_b128 v2, v[16:19] offset:5120
    s_waitcnt vmcnt(12)
    s_barrier
    s_add_u32 m0, s99, 55296
    s_mov_b32 s62, 640
    buffer_load_dwordx4 v57, s[20:23], s62 offen lds
    s_add_u32 m0, s99, 56320
    s_mov_b32 s62, 9856
    buffer_load_dwordx4 v57, s[20:23], s62 offen lds
    s_add_u32 m0, s99, 57344
    s_mov_b32 s62, 19072
    buffer_load_dwordx4 v57, s[20:23], s62 offen lds
    s_add_u32 m0, s99, 58368
    s_mov_b32 s62, 28288
    buffer_load_dwordx4 v57, s[20:23], s62 offen lds
    ds_read_b64_tr_b16 v[160:161], v58 offset:0
    ds_read_b64_tr_b16 v[162:163], v59 offset:512
    ds_read_b64_tr_b16 v[164:165], v61 offset:0
    ds_read_b64_tr_b16 v[166:167], v62 offset:512
    ds_read_b64_tr_b16 v[168:169], v58 offset:8
    ds_read_b64_tr_b16 v[170:171], v59 offset:520
    ds_read_b64_tr_b16 v[172:173], v61 offset:8
    ds_read_b64_tr_b16 v[174:175], v62 offset:520
    s_waitcnt lgkmcnt(0)
    s_waitcnt vmcnt(12)
    s_barrier
    s_add_u32 m0, s99, 38912
    s_mov_b32 s62, 3670016
    buffer_load_dwordx4 v56, s[8:11], s62 offen lds
    s_add_u32 m0, s99, 39936
    s_mov_b32 s62, 3702784
    buffer_load_dwordx4 v56, s[8:11], s62 offen lds
    s_add_u32 m0, s99, 40960
    s_mov_b32 s62, 3735552
    buffer_load_dwordx4 v56, s[8:11], s62 offen lds
    s_add_u32 m0, s99, 41984
    s_mov_b32 s62, 3768320
    buffer_load_dwordx4 v56, s[8:11], s62 offen lds
    ds_read_b64_tr_b16 a[56:57], v60 offset:4096
    ds_read_b64_tr_b16 a[58:59], v60 offset:4352
    ds_read_b64_tr_b16 a[60:61], v63 offset:4096
    ds_read_b64_tr_b16 a[62:63], v63 offset:4352
    ds_read_b64_tr_b16 a[80:81], v69 offset:4096
    ds_read_b64_tr_b16 a[82:83], v69 offset:4352
    ds_read_b64_tr_b16 a[84:85], v70 offset:4096
    ds_read_b64_tr_b16 a[86:87], v70 offset:4352
    s_waitcnt lgkmcnt(0)
    s_waitcnt vmcnt(12)
    s_barrier
    s_add_u32 m0, s99, 43008
    s_mov_b32 s62, 3670016
    buffer_load_dwordx4 v56, s[12:15], s62 offen lds
    s_add_u32 m0, s99, 44032
    s_mov_b32 s62, 3702784
    buffer_load_dwordx4 v56, s[12:15], s62 offen lds
    s_add_u32 m0, s99, 45056
    s_mov_b32 s62, 3735552
    buffer_load_dwordx4 v56, s[12:15], s62 offen lds
    s_add_u32 m0, s99, 46080
    s_mov_b32 s62, 3768320
    buffer_load_dwordx4 v56, s[12:15], s62 offen lds
    ds_read_b64_tr_b16 v[20:21], v58 offset:8192
    ds_read_b64_tr_b16 v[22:23], v59 offset:8704
    ds_read_b64_tr_b16 v[24:25], v61 offset:8192
    ds_read_b64_tr_b16 v[26:27], v62 offset:8704
    ds_read_b64_tr_b16 v[44:45], v58 offset:8200
    ds_read_b64_tr_b16 v[46:47], v59 offset:8712
    ds_read_b64_tr_b16 v[48:49], v61 offset:8200
    ds_read_b64_tr_b16 v[50:51], v62 offset:8712
    s_waitcnt lgkmcnt(0)
    ds_write_b128 v2, v[20:23] offset:6144
    ds_write_b128 v2, v[24:27] offset:7168
    s_waitcnt vmcnt(12)
    s_barrier
    s_add_u32 m0, s99, 47104
    s_mov_b32 s62, 4194304
    buffer_load_dwordx4 v56, s[8:11], s62 offen lds
    s_add_u32 m0, s99, 48128
    s_mov_b32 s62, 4227072
    buffer_load_dwordx4 v56, s[8:11], s62 offen lds
    s_add_u32 m0, s99, 49152
    s_mov_b32 s62, 4259840
    buffer_load_dwordx4 v56, s[8:11], s62 offen lds
    s_add_u32 m0, s99, 50176
    s_mov_b32 s62, 4292608
    buffer_load_dwordx4 v56, s[8:11], s62 offen lds
    ds_read_b64_tr_b16 v[208:209], v58 offset:12288
    ds_read_b64_tr_b16 v[210:211], v59 offset:12800
    ds_read_b64_tr_b16 v[212:213], v61 offset:12288
    ds_read_b64_tr_b16 v[214:215], v62 offset:12800
    ds_read_b64_tr_b16 v[216:217], v58 offset:12296
    ds_read_b64_tr_b16 v[218:219], v59 offset:12808
    ds_read_b64_tr_b16 v[220:221], v61 offset:12296
    ds_read_b64_tr_b16 v[222:223], v62 offset:12808
    s_waitcnt lgkmcnt(0)
    s_waitcnt vmcnt(12)
    s_barrier
    s_add_u32 m0, s99, 51200
    s_mov_b32 s62, 768
    buffer_load_dwordx4 v57, s[20:23], s62 offen lds
    s_add_u32 m0, s99, 52224
    s_mov_b32 s62, 9984
    buffer_load_dwordx4 v57, s[20:23], s62 offen lds
    s_add_u32 m0, s99, 53248
    s_mov_b32 s62, 19200
    buffer_load_dwordx4 v57, s[20:23], s62 offen lds
    s_add_u32 m0, s99, 54272
    s_mov_b32 s62, 28416
    buffer_load_dwordx4 v57, s[20:23], s62 offen lds
    ds_read_b64_tr_b16 a[208:209], v60 offset:16384
    ds_read_b64_tr_b16 a[210:211], v60 offset:16640
    ds_read_b64_tr_b16 a[212:213], v63 offset:16384
    ds_read_b64_tr_b16 a[214:215], v63 offset:16640
    ds_read_b64_tr_b16 a[216:217], v69 offset:16384
    ds_read_b64_tr_b16 a[218:219], v69 offset:16640
    ds_read_b64_tr_b16 a[220:221], v70 offset:16384
    ds_read_b64_tr_b16 a[222:223], v70 offset:16640
    s_waitcnt lgkmcnt(0)
    s_waitcnt vmcnt(12)
    s_barrier
    s_add_u32 m0, s99, 55296
    s_mov_b32 s62, 4194304
    buffer_load_dwordx4 v56, s[12:15], s62 offen lds
    s_add_u32 m0, s99, 56320
    s_mov_b32 s62, 4227072
    buffer_load_dwordx4 v56, s[12:15], s62 offen lds
    s_add_u32 m0, s99, 57344
    s_mov_b32 s62, 4259840
    buffer_load_dwordx4 v56, s[12:15], s62 offen lds
    s_add_u32 m0, s99, 58368
    s_mov_b32 s62, 4292608
    buffer_load_dwordx4 v56, s[12:15], s62 offen lds
    ds_read_b64_tr_b16 v[224:225], v58 offset:0
    ds_read_b64_tr_b16 v[226:227], v59 offset:512
    ds_read_b64_tr_b16 v[228:229], v61 offset:0
    ds_read_b64_tr_b16 v[230:231], v62 offset:512
    ds_read_b64_tr_b16 v[232:233], v58 offset:8
    ds_read_b64_tr_b16 v[234:235], v59 offset:520
    ds_read_b64_tr_b16 v[236:237], v61 offset:8
    ds_read_b64_tr_b16 v[238:239], v62 offset:520
    s_waitcnt lgkmcnt(0)
    s_waitcnt vmcnt(12)
    s_barrier
    s_add_u32 m0, s99, 38912
    s_mov_b32 s62, 2097152
    buffer_load_dwordx4 v56, s[16:19], s62 offen lds
    s_add_u32 m0, s99, 39936
    s_mov_b32 s62, 2129920
    buffer_load_dwordx4 v56, s[16:19], s62 offen lds
    s_add_u32 m0, s99, 40960
    s_mov_b32 s62, 2162688
    buffer_load_dwordx4 v56, s[16:19], s62 offen lds
    s_add_u32 m0, s99, 41984
    s_mov_b32 s62, 2195456
    buffer_load_dwordx4 v56, s[16:19], s62 offen lds
    ds_read_b64_tr_b16 v[240:241], v58 offset:4096
    ds_read_b64_tr_b16 v[242:243], v59 offset:4608
    ds_read_b64_tr_b16 v[244:245], v61 offset:4096
    ds_read_b64_tr_b16 v[246:247], v62 offset:4608
    ds_read_b64_tr_b16 v[12:13], v58 offset:4104
    ds_read_b64_tr_b16 v[14:15], v59 offset:4616
    ds_read_b64_tr_b16 v[16:17], v61 offset:4104
    ds_read_b64_tr_b16 v[18:19], v62 offset:4616
    s_waitcnt lgkmcnt(0)
    ds_write_b128 v2, v[12:15] offset:8192
    ds_write_b128 v2, v[16:19] offset:9216
    s_waitcnt vmcnt(12)
    s_barrier
    s_add_u32 m0, s99, 43008
    s_mov_b32 s62, 896
    buffer_load_dwordx4 v57, s[20:23], s62 offen lds
    s_add_u32 m0, s99, 44032
    s_mov_b32 s62, 10112
    buffer_load_dwordx4 v57, s[20:23], s62 offen lds
    s_add_u32 m0, s99, 45056
    s_mov_b32 s62, 19328
    buffer_load_dwordx4 v57, s[20:23], s62 offen lds
    s_add_u32 m0, s99, 46080
    s_mov_b32 s62, 28544
    buffer_load_dwordx4 v57, s[20:23], s62 offen lds
    ds_read_b64_tr_b16 v[248:249], v58 offset:8192
    ds_read_b64_tr_b16 v[250:251], v59 offset:8704
    ds_read_b64_tr_b16 v[252:253], v61 offset:8192
    ds_read_b64_tr_b16 v[254:255], v62 offset:8704
    ds_read_b64_tr_b16 a[0:1], v58 offset:8200
    ds_read_b64_tr_b16 a[2:3], v59 offset:8712
    ds_read_b64_tr_b16 a[4:5], v61 offset:8200
    ds_read_b64_tr_b16 a[6:7], v62 offset:8712
    s_waitcnt lgkmcnt(0)
    s_waitcnt vmcnt(12)
    s_barrier
    s_add_u32 m0, s99, 47104
    s_mov_b32 s62, 2621440
    buffer_load_dwordx4 v56, s[16:19], s62 offen lds
    s_add_u32 m0, s99, 48128
    s_mov_b32 s62, 2654208
    buffer_load_dwordx4 v56, s[16:19], s62 offen lds
    s_add_u32 m0, s99, 49152
    s_mov_b32 s62, 2686976
    buffer_load_dwordx4 v56, s[16:19], s62 offen lds
    s_add_u32 m0, s99, 50176
    s_mov_b32 s62, 2719744
    buffer_load_dwordx4 v56, s[16:19], s62 offen lds
    ds_read_b64_tr_b16 a[224:225], v60 offset:12288
    ds_read_b64_tr_b16 a[226:227], v60 offset:12544
    ds_read_b64_tr_b16 a[228:229], v63 offset:12288
    ds_read_b64_tr_b16 a[230:231], v63 offset:12544
    ds_read_b64_tr_b16 a[232:233], v69 offset:12288
    ds_read_b64_tr_b16 a[234:235], v69 offset:12544
    ds_read_b64_tr_b16 a[236:237], v70 offset:12288
    ds_read_b64_tr_b16 a[238:239], v70 offset:12544
    s_waitcnt lgkmcnt(0)
    s_waitcnt vmcnt(12)
    s_barrier
    s_add_u32 m0, s99, 51200
    s_mov_b32 s62, 3145728
    buffer_load_dwordx4 v56, s[16:19], s62 offen lds
    s_add_u32 m0, s99, 52224
    s_mov_b32 s62, 3178496
    buffer_load_dwordx4 v56, s[16:19], s62 offen lds
    s_add_u32 m0, s99, 53248
    s_mov_b32 s62, 3211264
    buffer_load_dwordx4 v56, s[16:19], s62 offen lds
    s_add_u32 m0, s99, 54272
    s_mov_b32 s62, 3244032
    buffer_load_dwordx4 v56, s[16:19], s62 offen lds
    buffer_load_dword v64, off, s[28:31], 0 offset:144 sc1
    ds_read_b64_tr_b16 a[8:9], v58 offset:16384
    ds_read_b64_tr_b16 a[10:11], v59 offset:16896
    ds_read_b64_tr_b16 a[12:13], v61 offset:16384
    ds_read_b64_tr_b16 a[14:15], v62 offset:16896
    ds_read_b64_tr_b16 a[16:17], v58 offset:16392
    ds_read_b64_tr_b16 a[18:19], v59 offset:16904
    ds_read_b64_tr_b16 a[20:21], v61 offset:16392
    ds_read_b64_tr_b16 a[22:23], v62 offset:16904
    s_waitcnt lgkmcnt(0)
    v_mov_b32 v58, v55
    v_xor_b32 v59, 0x80, v55
    v_add_u32 v61, 69632, v58
    v_add_u32 v62, 69632, v59
    s_waitcnt vmcnt(13)
    s_barrier
    s_add_u32 m0, s99, 55296
    s_mov_b32 s62, 3670016
    buffer_load_dwordx4 v56, s[16:19], s62 offen lds
    s_add_u32 m0, s99, 56320
    s_mov_b32 s62, 3702784
    buffer_load_dwordx4 v56, s[16:19], s62 offen lds
    s_add_u32 m0, s99, 57344
    s_mov_b32 s62, 3735552
    buffer_load_dwordx4 v56, s[16:19], s62 offen lds
    s_add_u32 m0, s99, 58368
    s_mov_b32 s62, 3768320
    buffer_load_dwordx4 v56, s[16:19], s62 offen lds
    ds_read_b64_tr_b16 a[104:105], v58 offset:0
    ds_read_b64_tr_b16 a[106:107], v59 offset:512
    ds_read_b64_tr_b16 a[108:109], v61 offset:0
    ds_read_b64_tr_b16 a[110:111], v62 offset:512
    ds_read_b64_tr_b16 v[20:21], v58 offset:8
    ds_read_b64_tr_b16 v[22:23], v59 offset:520
    ds_read_b64_tr_b16 v[24:25], v61 offset:8
    ds_read_b64_tr_b16 v[26:27], v62 offset:520
    s_waitcnt lgkmcnt(0)
    buffer_store_dwordx4 v[20:23], v0, s[4:7], s96 offen offset:0
    buffer_store_dwordx4 v[24:27], v0, s[4:7], s96 offen offset:1024
    s_waitcnt vmcnt(15)
    s_barrier
    s_add_u32 m0, s99, 38912
    s_mov_b32 s62, 1024
    buffer_load_dwordx4 v57, s[20:23], s62 offen lds
    s_add_u32 m0, s99, 39936
    s_mov_b32 s62, 10240
    buffer_load_dwordx4 v57, s[20:23], s62 offen lds
    s_add_u32 m0, s99, 40960
    s_mov_b32 s62, 19456
    buffer_load_dwordx4 v57, s[20:23], s62 offen lds
    s_add_u32 m0, s99, 41984
    s_mov_b32 s62, 28672
    buffer_load_dwordx4 v57, s[20:23], s62 offen lds
    ds_read_b64_tr_b16 a[240:241], v60 offset:4096
    ds_read_b64_tr_b16 a[242:243], v60 offset:4352
    ds_read_b64_tr_b16 a[244:245], v63 offset:4096
    ds_read_b64_tr_b16 a[246:247], v63 offset:4352
    ds_read_b64_tr_b16 a[248:249], v69 offset:4096
    ds_read_b64_tr_b16 a[250:251], v69 offset:4352
    ds_read_b64_tr_b16 a[252:253], v70 offset:4096
    ds_read_b64_tr_b16 a[254:255], v70 offset:4352
    s_waitcnt lgkmcnt(0)
    s_waitcnt vmcnt(15)
    s_barrier
    s_add_u32 m0, s99, 43008
    s_mov_b32 s62, 4194304
    buffer_load_dwordx4 v56, s[16:19], s62 offen lds
    s_add_u32 m0, s99, 44032
    s_mov_b32 s62, 4227072
    buffer_load_dwordx4 v56, s[16:19], s62 offen lds
    s_add_u32 m0, s99, 45056
    s_mov_b32 s62, 4259840
    buffer_load_dwordx4 v56, s[16:19], s62 offen lds
    s_add_u32 m0, s99, 46080
    s_mov_b32 s62, 4292608
    buffer_load_dwordx4 v56, s[16:19], s62 offen lds
    ds_read_b64_tr_b16 a[88:89], v58 offset:8192
    ds_read_b64_tr_b16 a[90:91], v59 offset:8704
    ds_read_b64_tr_b16 a[92:93], v61 offset:8192
    ds_read_b64_tr_b16 a[94:95], v62 offset:8704
    ds_read_b64_tr_b16 a[96:97], v58 offset:8200
    ds_read_b64_tr_b16 a[98:99], v59 offset:8712
    ds_read_b64_tr_b16 a[100:101], v61 offset:8200
    ds_read_b64_tr_b16 a[102:103], v62 offset:8712
    s_waitcnt lgkmcnt(0)
    s_waitcnt vmcnt(15)
    s_barrier
    s_add_u32 m0, s99, 47104
    s_mov_b32 s62, 0
    buffer_load_dwordx4 v56, s[16:19], s62 offen lds
    s_add_u32 m0, s99, 48128
    s_mov_b32 s62, 32768
    buffer_load_dwordx4 v56, s[16:19], s62 offen lds
    s_add_u32 m0, s99, 49152
    s_mov_b32 s62, 65536
    buffer_load_dwordx4 v56, s[16:19], s62 offen lds
    s_add_u32 m0, s99, 50176
    s_mov_b32 s62, 98304
    buffer_load_dwordx4 v56, s[16:19], s62 offen lds
    ds_read_b64_tr_b16 a[112:113], v58 offset:12288
    ds_read_b64_tr_b16 a[114:115], v59 offset:12800
    ds_read_b64_tr_b16 a[116:117], v61 offset:12288
    ds_read_b64_tr_b16 a[118:119], v62 offset:12800
    ds_read_b64_tr_b16 a[120:121], v58 offset:12296
    ds_read_b64_tr_b16 a[122:123], v59 offset:12808
    ds_read_b64_tr_b16 a[124:125], v61 offset:12296
    ds_read_b64_tr_b16 a[126:127], v62 offset:12808
    s_waitcnt lgkmcnt(0)
    s_waitcnt vmcnt(14)
    s_barrier
    s_add_u32 m0, s99, 51200
    s_mov_b32 s62, 524288
    buffer_load_dwordx4 v56, s[16:19], s62 offen lds
    s_add_u32 m0, s99, 52224
    s_mov_b32 s62, 557056
    buffer_load_dwordx4 v56, s[16:19], s62 offen lds
    s_add_u32 m0, s99, 53248
    s_mov_b32 s62, 589824
    buffer_load_dwordx4 v56, s[16:19], s62 offen lds
    s_add_u32 m0, s99, 54272
    s_mov_b32 s62, 622592
    buffer_load_dwordx4 v56, s[16:19], s62 offen lds
    ds_read_b64_tr_b16 a[128:129], v58 offset:16384
    ds_read_b64_tr_b16 a[130:131], v59 offset:16896
    ds_read_b64_tr_b16 a[132:133], v61 offset:16384
    ds_read_b64_tr_b16 a[134:135], v62 offset:16896
    ds_read_b64_tr_b16 a[136:137], v58 offset:16392
    ds_read_b64_tr_b16 a[138:139], v59 offset:16904
    ds_read_b64_tr_b16 a[140:141], v61 offset:16392
    ds_read_b64_tr_b16 a[142:143], v62 offset:16904
    s_waitcnt lgkmcnt(0)
    s_waitcnt vmcnt(12)
    s_barrier
    s_add_u32 m0, s99, 55296
    s_mov_b32 s62, 1048576
    buffer_load_dwordx4 v56, s[16:19], s62 offen lds
    s_add_u32 m0, s99, 56320
    s_mov_b32 s62, 1081344
    buffer_load_dwordx4 v56, s[16:19], s62 offen lds
    s_add_u32 m0, s99, 57344
    s_mov_b32 s62, 1114112
    buffer_load_dwordx4 v56, s[16:19], s62 offen lds
    s_add_u32 m0, s99, 58368
    s_mov_b32 s62, 1146880
    buffer_load_dwordx4 v56, s[16:19], s62 offen lds
    ds_read_b64_tr_b16 a[64:65], v60 offset:0
    ds_read_b64_tr_b16 a[66:67], v60 offset:256
    ds_read_b64_tr_b16 a[68:69], v63 offset:0
    ds_read_b64_tr_b16 a[70:71], v63 offset:256
    ds_read_b64_tr_b16 v[28:29], v69 offset:0
    ds_read_b64_tr_b16 v[30:31], v69 offset:256
    ds_read_b64_tr_b16 v[32:33], v70 offset:0
    ds_read_b64_tr_b16 v[34:35], v70 offset:256
    s_waitcnt lgkmcnt(0)
    s_waitcnt vmcnt(12)
    s_barrier
    s_add_u32 m0, s99, 38912
    s_mov_b32 s62, 1572864
    buffer_load_dwordx4 v56, s[16:19], s62 offen lds
    s_add_u32 m0, s99, 39936
    s_mov_b32 s62, 1605632
    buffer_load_dwordx4 v56, s[16:19], s62 offen lds
    s_add_u32 m0, s99, 40960
    s_mov_b32 s62, 1638400
    buffer_load_dwordx4 v56, s[16:19], s62 offen lds
    s_add_u32 m0, s99, 41984
    s_mov_b32 s62, 1671168
    buffer_load_dwordx4 v56, s[16:19], s62 offen lds
    ds_read_b64_tr_b16 a[144:145], v58 offset:4096
    ds_read_b64_tr_b16 a[146:147], v59 offset:4608
    ds_read_b64_tr_b16 a[148:149], v61 offset:4096
    ds_read_b64_tr_b16 a[150:151], v62 offset:4608
    ds_read_b64_tr_b16 a[152:153], v58 offset:4104
    ds_read_b64_tr_b16 a[154:155], v59 offset:4616
    ds_read_b64_tr_b16 a[156:157], v61 offset:4104
    ds_read_b64_tr_b16 a[158:159], v62 offset:4616
    s_waitcnt lgkmcnt(0)
    s_waitcnt vmcnt(12)
    s_barrier
    ds_write_b128 v2, a[24:27] offset:18432
    ds_write_b128 v2, a[28:31] offset:19456
    ds_write_b128 v2, a[32:35] offset:20480
    ds_write_b128 v2, a[36:39] offset:21504
    ds_read_b64_tr_b16 a[40:41], v58 offset:8192
    ds_read_b64_tr_b16 a[42:43], v59 offset:8704
    ds_read_b64_tr_b16 a[44:45], v61 offset:8192
    ds_read_b64_tr_b16 a[46:47], v62 offset:8704
    ds_read_b64_tr_b16 a[48:49], v58 offset:8200
    ds_read_b64_tr_b16 a[50:51], v59 offset:8712
    ds_read_b64_tr_b16 a[52:53], v61 offset:8200
    ds_read_b64_tr_b16 a[54:55], v62 offset:8712
    s_waitcnt lgkmcnt(0)
    s_waitcnt vmcnt(8)
    s_barrier
    ds_write_b128 v2, a[56:59] offset:22528
    ds_write_b128 v2, a[60:63] offset:23552
    ds_write_b128 v2, a[64:67] offset:24576
    ds_write_b128 v2, a[68:71] offset:25600
    ds_read_b64_tr_b16 a[24:25], v58 offset:12288
    ds_read_b64_tr_b16 a[26:27], v59 offset:12800
    ds_read_b64_tr_b16 a[28:29], v61 offset:12288
    ds_read_b64_tr_b16 a[30:31], v62 offset:12800
    ds_read_b64_tr_b16 a[32:33], v58 offset:12296
    ds_read_b64_tr_b16 a[34:35], v59 offset:12808
    ds_read_b64_tr_b16 a[36:37], v61 offset:12296
    ds_read_b64_tr_b16 a[38:39], v62 offset:12808
    s_waitcnt lgkmcnt(0)
    s_waitcnt vmcnt(4)
    s_barrier
    v_lshrrev_b32 v65, 2, v0
    s_lshl_b32 s62, s32, 8
    s_add_u32 s62, s62, 81789952
    buffer_load_dword v65, v65, s[4:7], s62 offen sc1
    buffer_load_dword v66, off, s[28:31], 0 offset:16 sc1
    ds_write_b128 v2, a[72:75] offset:26624
    ds_write_b128 v2, a[76:79] offset:27648
    ds_write_b128 v2, a[80:83] offset:28672
    ds_write_b128 v2, a[84:87] offset:29696
    ds_read_b64_tr_b16 a[56:57], v58 offset:16384
    ds_read_b64_tr_b16 a[58:59], v59 offset:16896
    ds_read_b64_tr_b16 a[60:61], v61 offset:16384
    ds_read_b64_tr_b16 a[62:63], v62 offset:16896
    ds_read_b64_tr_b16 a[64:65], v58 offset:16392
    ds_read_b64_tr_b16 a[66:67], v59 offset:16904
    ds_read_b64_tr_b16 a[68:69], v61 offset:16392
    ds_read_b64_tr_b16 a[70:71], v62 offset:16904
    s_waitcnt lgkmcnt(0)
    s_waitcnt vmcnt(2)
    s_barrier
    ds_write_b128 v2, v[28:31] offset:30720
    ds_write_b128 v2, v[32:35] offset:31744
    ds_read_b64_tr_b16 a[72:73], v58 offset:0
    ds_read_b64_tr_b16 a[74:75], v59 offset:512
    ds_read_b64_tr_b16 a[76:77], v61 offset:0
    ds_read_b64_tr_b16 a[78:79], v62 offset:512
    ds_read_b64_tr_b16 a[80:81], v58 offset:8
    ds_read_b64_tr_b16 a[82:83], v59 offset:520
    ds_read_b64_tr_b16 a[84:85], v61 offset:8
    ds_read_b64_tr_b16 a[86:87], v62 offset:520
    s_waitcnt lgkmcnt(0)
    s_barrier
    ds_write_b128 v2, v[36:39] offset:14336
    ds_write_b128 v2, v[40:43] offset:15360
    ds_write_b128 v2, v[44:47] offset:16384
    ds_write_b128 v2, v[48:51] offset:17408
    s_branch L_initjoin_1
L_cls2_4:
    v_add_u32 v63, 34816, v60
    v_add_u32 v69, 69632, v60
    v_add_u32 v70, 104448, v60
    v_mov_b32 v58, v54
    v_xor_b32 v59, 0x80, v54
    v_add_u32 v61, 69632, v58
    v_add_u32 v62, 69632, v59
    s_waitcnt vmcnt(19)
    s_barrier
    s_add_u32 m0, s99, 55296
    s_mov_b32 s62, 524288
    buffer_load_dwordx4 v56, s[12:15], s62 offen lds
    s_add_u32 m0, s99, 56320
    s_mov_b32 s62, 557056
    buffer_load_dwordx4 v56, s[12:15], s62 offen lds
    s_add_u32 m0, s99, 57344
    s_mov_b32 s62, 589824
    buffer_load_dwordx4 v56, s[12:15], s62 offen lds
    s_add_u32 m0, s99, 58368
    s_mov_b32 s62, 622592
    buffer_load_dwordx4 v56, s[12:15], s62 offen lds
    ds_read_b64_tr_b16 v[12:13], v58 offset:0
    ds_read_b64_tr_b16 v[14:15], v59 offset:512
    ds_read_b64_tr_b16 v[16:17], v61 offset:0
    ds_read_b64_tr_b16 v[18:19], v62 offset:512
    ds_read_b64_tr_b16 v[20:21], v58 offset:8
    ds_read_b64_tr_b16 v[22:23], v59 offset:520
    ds_read_b64_tr_b16 v[24:25], v61 offset:8
    ds_read_b64_tr_b16 v[26:27], v62 offset:520
    s_waitcnt lgkmcnt(0)
    ds_write_b128 v2, v[12:15] offset:2048
    ds_write_b128 v2, v[16:19] offset:3072
    ds_write_b128 v2, v[20:23] offset:12288
    ds_write_b128 v2, v[24:27] offset:13312
    s_waitcnt vmcnt(19)
    s_barrier
    s_add_u32 m0, s99, 38912
    s_mov_b32 s62, 128
    buffer_load_dwordx4 v57, s[20:23], s62 offen lds
    s_add_u32 m0, s99, 39936
    s_mov_b32 s62, 9344
    buffer_load_dwordx4 v57, s[20:23], s62 offen lds
    s_add_u32 m0, s99, 40960
    s_mov_b32 s62, 18560
    buffer_load_dwordx4 v57, s[20:23], s62 offen lds
    s_add_u32 m0, s99, 41984
    s_mov_b32 s62, 27776
    buffer_load_dwordx4 v57, s[20:23], s62 offen lds
    ds_read_b64_tr_b16 v[112:113], v58 offset:4096
    ds_read_b64_tr_b16 v[114:115], v59 offset:4608
    ds_read_b64_tr_b16 v[116:117], v61 offset:4096
    ds_read_b64_tr_b16 v[118:119], v62 offset:4608
    ds_read_b64_tr_b16 v[120:121], v58 offset:4104
    ds_read_b64_tr_b16 v[122:123], v59 offset:4616
    ds_read_b64_tr_b16 v[124:125], v61 offset:4104
    ds_read_b64_tr_b16 v[126:127], v62 offset:4616
    s_waitcnt lgkmcnt(0)
    s_waitcnt vmcnt(19)
    s_barrier
    s_add_u32 m0, s99, 43008
    s_mov_b32 s62, 1048576
    buffer_load_dwordx4 v56, s[8:11], s62 offen lds
    s_add_u32 m0, s99, 44032
    s_mov_b32 s62, 1081344
    buffer_load_dwordx4 v56, s[8:11], s62 offen lds
    s_add_u32 m0, s99, 45056
    s_mov_b32 s62, 1114112
    buffer_load_dwordx4 v56, s[8:11], s62 offen lds
    s_add_u32 m0, s99, 46080
    s_mov_b32 s62, 1146880
    buffer_load_dwordx4 v56, s[8:11], s62 offen lds
    ds_read_b64_tr_b16 a[80:81], v60 offset:8192
    ds_read_b64_tr_b16 a[82:83], v60 offset:8448
    ds_read_b64_tr_b16 a[84:85], v63 offset:8192
    ds_read_b64_tr_b16 a[86:87], v63 offset:8448
    ds_read_b64_tr_b16 a[40:41], v69 offset:8192
    ds_read_b64_tr_b16 a[42:43], v69 offset:8448
    ds_read_b64_tr_b16 a[44:45], v70 offset:8192
    ds_read_b64_tr_b16 a[46:47], v70 offset:8448
    s_waitcnt lgkmcnt(0)
    s_waitcnt vmcnt(19)
    s_barrier
    s_add_u32 m0, s99, 47104
    s_mov_b32 s62, 1048576
    buffer_load_dwordx4 v56, s[12:15], s62 offen lds
    s_add_u32 m0, s99, 48128
    s_mov_b32 s62, 1081344
    buffer_load_dwordx4 v56, s[12:15], s62 offen lds
    s_add_u32 m0, s99, 49152
    s_mov_b32 s62, 1114112
    buffer_load_dwordx4 v56, s[12:15], s62 offen lds
    s_add_u32 m0, s99, 50176
    s_mov_b32 s62, 1146880
    buffer_load_dwordx4 v56, s[12:15], s62 offen lds
    ds_read_b64_tr_b16 v[128:129], v58 offset:12288
    ds_read_b64_tr_b16 v[130:131], v59 offset:12800
    ds_read_b64_tr_b16 v[132:133], v61 offset:12288
    ds_read_b64_tr_b16 v[134:135], v62 offset:12800
    ds_read_b64_tr_b16 v[136:137], v58 offset:12296
    ds_read_b64_tr_b16 v[138:139], v59 offset:12808
    ds_read_b64_tr_b16 v[140:141], v61 offset:12296
    ds_read_b64_tr_b16 v[142:143], v62 offset:12808
    s_waitcnt lgkmcnt(0)
    s_waitcnt vmcnt(12)
    s_barrier
    s_add_u32 m0, s99, 51200
    s_mov_b32 s62, 1572864
    buffer_load_dwordx4 v56, s[8:11], s62 offen lds
    s_add_u32 m0, s99, 52224
    s_mov_b32 s62, 1605632
    buffer_load_dwordx4 v56, s[8:11], s62 offen lds
    s_add_u32 m0, s99, 53248
    s_mov_b32 s62, 1638400
    buffer_load_dwordx4 v56, s[8:11], s62 offen lds
    s_add_u32 m0, s99, 54272
    s_mov_b32 s62, 1671168
    buffer_load_dwordx4 v56, s[8:11], s62 offen lds
    ds_read_b64_tr_b16 v[144:145], v58 offset:16384
    ds_read_b64_tr_b16 v[146:147], v59 offset:16896
    ds_read_b64_tr_b16 v[148:149], v61 offset:16384
    ds_read_b64_tr_b16 v[150:151], v62 offset:16896
    ds_read_b64_tr_b16 v[152:153], v58 offset:16392
    ds_read_b64_tr_b16 v[154:155], v59 offset:16904
    ds_read_b64_tr_b16 v[156:157], v61 offset:16392
    ds_read_b64_tr_b16 v[158:159], v62 offset:16904
    s_waitcnt lgkmcnt(0)
    s_waitcnt vmcnt(12)
    s_barrier
    s_add_u32 m0, s99, 55296
    s_mov_b32 s62, 256
    buffer_load_dwordx4 v57, s[20:23], s62 offen lds
    s_add_u32 m0, s99, 56320
    s_mov_b32 s62, 9472
    buffer_load_dwordx4 v57, s[20:23], s62 offen lds
    s_add_u32 m0, s99, 57344
    s_mov_b32 s62, 18688
    buffer_load_dwordx4 v57, s[20:23], s62 offen lds
    s_add_u32 m0, s99, 58368
    s_mov_b32 s62, 27904
    buffer_load_dwordx4 v57, s[20:23], s62 offen lds
    buffer_store_dwordx2 v[52:53], v6, s[4:7], s42 offen sc1
    ds_read_b64_tr_b16 a[160:161], v60 offset:0
    ds_read_b64_tr_b16 a[162:163], v60 offset:256
    ds_read_b64_tr_b16 a[164:165], v63 offset:0
    ds_read_b64_tr_b16 a[166:167], v63 offset:256
    ds_read_b64_tr_b16 a[168:169], v69 offset:0
    ds_read_b64_tr_b16 a[170:171], v69 offset:256
    ds_read_b64_tr_b16 a[172:173], v70 offset:0
    ds_read_b64_tr_b16 a[174:175], v70 offset:256
    s_waitcnt lgkmcnt(0)
    s_waitcnt vmcnt(13)
    s_barrier
    s_add_u32 m0, s99, 38912
    s_mov_b32 s62, 1572864
    buffer_load_dwordx4 v56, s[12:15], s62 offen lds
    s_add_u32 m0, s99, 39936
    s_mov_b32 s62, 1605632
    buffer_load_dwordx4 v56, s[12:15], s62 offen lds
    s_add_u32 m0, s99, 40960
    s_mov_b32 s62, 1638400
    buffer_load_dwordx4 v56, s[12:15], s62 offen lds
    s_add_u32 m0, s99, 41984
    s_mov_b32 s62, 1671168
    buffer_load_dwordx4 v56, s[12:15], s62 offen lds
    ds_read_b64_tr_b16 a[72:73], v58 offset:4096
    ds_read_b64_tr_b16 a[74:75], v59 offset:4608
    ds_read_b64_tr_b16 a[76:77], v61 offset:4096
    ds_read_b64_tr_b16 a[78:79], v62 offset:4608
    ds_read_b64_tr_b16 v[12:13], v58 offset:4104
    ds_read_b64_tr_b16 v[14:15], v59 offset:4616
    ds_read_b64_tr_b16 v[16:17], v61 offset:4104
    ds_read_b64_tr_b16 v[18:19], v62 offset:4616
    s_waitcnt lgkmcnt(0)
    ds_write_b128 v2, v[12:15] offset:0
    ds_write_b128 v2, v[16:19] offset:1024
    s_waitcnt vmcnt(13)
    s_barrier
    s_add_u32 m0, s99, 43008
    s_mov_b32 s62, 2097152
    buffer_load_dwordx4 v56, s[8:11], s62 offen lds
    s_add_u32 m0, s99, 44032
    s_mov_b32 s62, 2129920
    buffer_load_dwordx4 v56, s[8:11], s62 offen lds
    s_add_u32 m0, s99, 45056
    s_mov_b32 s62, 2162688
    buffer_load_dwordx4 v56, s[8:11], s62 offen lds
    s_add_u32 m0, s99, 46080
    s_mov_b32 s62, 2195456
    buffer_load_dwordx4 v56, s[8:11], s62 offen lds
    ds_read_b64_tr_b16 v[20:21], v58 offset:8192
    ds_read_b64_tr_b16 v[22:23], v59 offset:8704
    ds_read_b64_tr_b16 v[24:25], v61 offset:8192
    ds_read_b64_tr_b16 v[26:27], v62 offset:8704
    ds_read_b64_tr_b16 v[72:73], v58 offset:8200
    ds_read_b64_tr_b16 v[74:75], v59 offset:8712
    ds_read_b64_tr_b16 v[76:77], v61 offset:8200
    ds_read_b64_tr_b16 v[78:79], v62 offset:8712
    s_waitcnt lgkmcnt(0)
    ds_write_b128 v2, v[20:23] offset:10240
    ds_write_b128 v2, v[24:27] offset:11264
    s_waitcnt vmcnt(13)
    s_barrier
    s_add_u32 m0, s99, 47104
    s_mov_b32 s62, 384
    buffer_load_dwordx4 v57, s[20:23], s62 offen lds
    s_add_u32 m0, s99, 48128
    s_mov_b32 s62, 9600
    buffer_load_dwordx4 v57, s[20:23], s62 offen lds
    s_add_u32 m0, s99, 49152
    s_mov_b32 s62, 18816
    buffer_load_dwordx4 v57, s[20:23], s62 offen lds
    s_add_u32 m0, s99, 50176
    s_mov_b32 s62, 28032
    buffer_load_dwordx4 v57, s[20:23], s62 offen lds
    ds_read_b64_tr_b16 v[80:81], v58 offset:12288
    ds_read_b64_tr_b16 v[82:83], v59 offset:12800
    ds_read_b64_tr_b16 v[84:85], v61 offset:12288
    ds_read_b64_tr_b16 v[86:87], v62 offset:12800
    ds_read_b64_tr_b16 v[88:89], v58 offset:12296
    ds_read_b64_tr_b16 v[90:91], v59 offset:12808
    ds_read_b64_tr_b16 v[92:93], v61 offset:12296
    ds_read_b64_tr_b16 v[94:95], v62 offset:12808
    s_waitcnt lgkmcnt(0)
    s_waitcnt vmcnt(13)
    s_barrier
    s_add_u32 m0, s99, 51200
    s_mov_b32 s62, 2097152
    buffer_load_dwordx4 v56, s[12:15], s62 offen lds
    s_add_u32 m0, s99, 52224
    s_mov_b32 s62, 2129920
    buffer_load_dwordx4 v56, s[12:15], s62 offen lds
    s_add_u32 m0, s99, 53248
    s_mov_b32 s62, 2162688
    buffer_load_dwordx4 v56, s[12:15], s62 offen lds
    s_add_u32 m0, s99, 54272
    s_mov_b32 s62, 2195456
    buffer_load_dwordx4 v56, s[12:15], s62 offen lds
    ds_read_b64_tr_b16 a[176:177], v60 offset:16384
    ds_read_b64_tr_b16 a[178:179], v60 offset:16640
    ds_read_b64_tr_b16 a[180:181], v63 offset:16384
    ds_read_b64_tr_b16 a[182:183], v63 offset:16640
    ds_read_b64_tr_b16 a[184:185], v69 offset:16384
    ds_read_b64_tr_b16 a[186:187], v69 offset:16640
    ds_read_b64_tr_b16 a[188:189], v70 offset:16384
    ds_read_b64_tr_b16 a[190:191], v70 offset:16640
    s_waitcnt lgkmcnt(0)
    s_waitcnt vmcnt(12)
    s_barrier
    s_add_u32 m0, s99, 55296
    s_mov_b32 s62, 2621440
    buffer_load_dwordx4 v56, s[8:11], s62 offen lds
    s_add_u32 m0, s99, 56320
    s_mov_b32 s62, 2654208
    buffer_load_dwordx4 v56, s[8:11], s62 offen lds
    s_add_u32 m0, s99, 57344
    s_mov_b32 s62, 2686976
    buffer_load_dwordx4 v56, s[8:11], s62 offen lds
    s_add_u32 m0, s99, 58368
    s_mov_b32 s62, 2719744
    buffer_load_dwordx4 v56, s[8:11], s62 offen lds
    ds_read_b64_tr_b16 v[96:97], v58 offset:0
    ds_read_b64_tr_b16 v[98:99], v59 offset:512
    ds_read_b64_tr_b16 v[100:101], v61 offset:0
    ds_read_b64_tr_b16 v[102:103], v62 offset:512
    ds_read_b64_tr_b16 v[104:105], v58 offset:8
    ds_read_b64_tr_b16 v[106:107], v59 offset:520
    ds_read_b64_tr_b16 v[108:109], v61 offset:8
    ds_read_b64_tr_b16 v[110:111], v62 offset:520
    s_waitcnt lgkmcnt(0)
    s_waitcnt vmcnt(12)
    s_barrier
    s_add_u32 m0, s99, 38912
    s_mov_b32 s62, 2621440
    buffer_load_dwordx4 v56, s[12:15], s62 offen lds
    s_add_u32 m0, s99, 39936
    s_mov_b32 s62, 2654208
    buffer_load_dwordx4 v56, s[12:15], s62 offen lds
    s_add_u32 m0, s99, 40960
    s_mov_b32 s62, 2686976
    buffer_load_dwordx4 v56, s[12:15], s62 offen lds
    s_add_u32 m0, s99, 41984
    s_mov_b32 s62, 2719744
    buffer_load_dwordx4 v56, s[12:15], s62 offen lds
    ds_read_b64_tr_b16 v[12:13], v58 offset:4096
    ds_read_b64_tr_b16 v[14:15], v59 offset:4608
    ds_read_b64_tr_b16 v[16:17], v61 offset:4096
    ds_read_b64_tr_b16 v[18:19], v62 offset:4608
    ds_read_b64_tr_b16 v[44:45], v58 offset:4104
    ds_read_b64_tr_b16 v[46:47], v59 offset:4616
    ds_read_b64_tr_b16 v[48:49], v61 offset:4104
    ds_read_b64_tr_b16 v[50:51], v62 offset:4616
    s_waitcnt lgkmcnt(0)
    ds_write_b128 v2, v[12:15] offset:6144
    ds_write_b128 v2, v[16:19] offset:7168
    s_waitcnt vmcnt(12)
    s_barrier
    s_add_u32 m0, s99, 43008
    s_mov_b32 s62, 512
    buffer_load_dwordx4 v57, s[20:23], s62 offen lds
    s_add_u32 m0, s99, 44032
    s_mov_b32 s62, 9728
    buffer_load_dwordx4 v57, s[20:23], s62 offen lds
    s_add_u32 m0, s99, 45056
    s_mov_b32 s62, 18944
    buffer_load_dwordx4 v57, s[20:23], s62 offen lds
    s_add_u32 m0, s99, 46080
    s_mov_b32 s62, 28160
    buffer_load_dwordx4 v57, s[20:23], s62 offen lds
    ds_read_b64_tr_b16 a[192:193], v60 offset:8192
    ds_read_b64_tr_b16 a[194:195], v60 offset:8448
    ds_read_b64_tr_b16 a[196:197], v63 offset:8192
    ds_read_b64_tr_b16 a[198:199], v63 offset:8448
    ds_read_b64_tr_b16 a[200:201], v69 offset:8192
    ds_read_b64_tr_b16 a[202:203], v69 offset:8448
    ds_read_b64_tr_b16 a[204:205], v70 offset:8192
    ds_read_b64_tr_b16 a[206:207], v70 offset:8448
    s_waitcnt lgkmcnt(0)
    s_waitcnt vmcnt(12)
    s_barrier
    s_add_u32 m0, s99, 47104
    s_mov_b32 s62, 3145728
    buffer_load_dwordx4 v56, s[8:11], s62 offen lds
    s_add_u32 m0, s99, 48128
    s_mov_b32 s62, 3178496
    buffer_load_dwordx4 v56, s[8:11], s62 offen lds
    s_add_u32 m0, s99, 49152
    s_mov_b32 s62, 3211264
    buffer_load_dwordx4 v56, s[8:11], s62 offen lds
    s_add_u32 m0, s99, 50176
    s_mov_b32 s62, 3244032
    buffer_load_dwordx4 v56, s[8:11], s62 offen lds
    ds_read_b64_tr_b16 v[208:209], v58 offset:12288
    ds_read_b64_tr_b16 v[210:211], v59 offset:12800
    ds_read_b64_tr_b16 v[212:213], v61 offset:12288
    ds_read_b64_tr_b16 v[214:215], v62 offset:12800
    ds_read_b64_tr_b16 v[216:217], v58 offset:12296
    ds_read_b64_tr_b16 v[218:219], v59 offset:12808
    ds_read_b64_tr_b16 v[220:221], v61 offset:12296
    ds_read_b64_tr_b16 v[222:223], v62 offset:12808
    s_waitcnt lgkmcnt(0)
    s_waitcnt vmcnt(12)
    s_barrier
    s_add_u32 m0, s99, 51200
    s_mov_b32 s62, 3145728
    buffer_load_dwordx4 v56, s[12:15], s62 offen lds
    s_add_u32 m0, s99, 52224
    s_mov_b32 s62, 3178496
    buffer_load_dwordx4 v56, s[12:15], s62 offen lds
    s_add_u32 m0, s99, 53248
    s_mov_b32 s62, 3211264
    buffer_load_dwordx4 v56, s[12:15], s62 offen lds
    s_add_u32 m0, s99, 54272
    s_mov_b32 s62, 3244032
    buffer_load_dwordx4 v56, s[12:15], s62 offen lds
    ds_read_b64_tr_b16 v[224:225], v58 offset:16384
    ds_read_b64_tr_b16 v[226:227], v59 offset:16896
    ds_read_b64_tr_b16 v[228:229], v61 offset:16384
    ds_read_b64_tr_b16 v[230:231], v62 offset:16896
    ds_read_b64_tr_b16 v[232:233], v58 offset:16392
    ds_read_b64_tr_b16 v[234:235], v59 offset:16904
    ds_read_b64_tr_b16 v[236:237], v61 offset:16392
    ds_read_b64_tr_b16 v[238:239], v62 offset:16904
    s_waitcnt lgkmcnt(0)
    s_waitcnt vmcnt(12)
    s_barrier
    s_add_u32 m0, s99, 55296
    s_mov_b32 s62, 640
    buffer_load_dwordx4 v57, s[20:23], s62 offen lds
    s_add_u32 m0, s99, 56320
    s_mov_b32 s62, 9856
    buffer_load_dwordx4 v57, s[20:23], s62 offen lds
    s_add_u32 m0, s99, 57344
    s_mov_b32 s62, 19072
    buffer_load_dwordx4 v57, s[20:23], s62 offen lds
    s_add_u32 m0, s99, 58368
    s_mov_b32 s62, 28288
    buffer_load_dwordx4 v57, s[20:23], s62 offen lds
    ds_read_b64_tr_b16 v[240:241], v58 offset:0
    ds_read_b64_tr_b16 v[242:243], v59 offset:512
    ds_read_b64_tr_b16 v[244:245], v61 offset:0
    ds_read_b64_tr_b16 v[246:247], v62 offset:512
    ds_read_b64_tr_b16 v[20:21], v58 offset:8
    ds_read_b64_tr_b16 v[22:23], v59 offset:520
    ds_read_b64_tr_b16 v[24:25], v61 offset:8
    ds_read_b64_tr_b16 v[26:27], v62 offset:520
    s_waitcnt lgkmcnt(0)
    ds_write_b128 v2, v[20:23] offset:8192
    ds_write_b128 v2, v[24:27] offset:9216
    s_waitcnt vmcnt(12)
    s_barrier
    s_add_u32 m0, s99, 38912
    s_mov_b32 s62, 3670016
    buffer_load_dwordx4 v56, s[8:11], s62 offen lds
    s_add_u32 m0, s99, 39936
    s_mov_b32 s62, 3702784
    buffer_load_dwordx4 v56, s[8:11], s62 offen lds
    s_add_u32 m0, s99, 40960
    s_mov_b32 s62, 3735552
    buffer_load_dwordx4 v56, s[8:11], s62 offen lds
    s_add_u32 m0, s99, 41984
    s_mov_b32 s62, 3768320
    buffer_load_dwordx4 v56, s[8:11], s62 offen lds
    ds_read_b64_tr_b16 a[24:25], v60 offset:4096
    ds_read_b64_tr_b16 a[26:27], v60 offset:4352
    ds_read_b64_tr_b16 a[28:29], v63 offset:4096
    ds_read_b64_tr_b16 a[30:31], v63 offset:4352
    ds_read_b64_tr_b16 a[48:49], v69 offset:4096
    ds_read_b64_tr_b16 a[50:51], v69 offset:4352
    ds_read_b64_tr_b16 a[52:53], v70 offset:4096
    ds_read_b64_tr_b16 a[54:55], v70 offset:4352
    s_waitcnt lgkmcnt(0)
    s_waitcnt vmcnt(12)
    s_barrier
    s_add_u32 m0, s99, 43008
    s_mov_b32 s62, 3670016
    buffer_load_dwordx4 v56, s[12:15], s62 offen lds
    s_add_u32 m0, s99, 44032
    s_mov_b32 s62, 3702784
    buffer_load_dwordx4 v56, s[12:15], s62 offen lds
    s_add_u32 m0, s99, 45056
    s_mov_b32 s62, 3735552
    buffer_load_dwordx4 v56, s[12:15], s62 offen lds
    s_add_u32 m0, s99, 46080
    s_mov_b32 s62, 3768320
    buffer_load_dwordx4 v56, s[12:15], s62 offen lds
    ds_read_b64_tr_b16 v[12:13], v58 offset:8192
    ds_read_b64_tr_b16 v[14:15], v59 offset:8704
    ds_read_b64_tr_b16 v[16:17], v61 offset:8192
    ds_read_b64_tr_b16 v[18:19], v62 offset:8704
    ds_read_b64_tr_b16 v[36:37], v58 offset:8200
    ds_read_b64_tr_b16 v[38:39], v59 offset:8712
    ds_read_b64_tr_b16 v[40:41], v61 offset:8200
    ds_read_b64_tr_b16 v[42:43], v62 offset:8712
    s_waitcnt lgkmcnt(0)
    ds_write_b128 v2, v[12:15] offset:4096
    ds_write_b128 v2, v[16:19] offset:5120
    s_waitcnt vmcnt(12)
    s_barrier
    s_add_u32 m0, s99, 47104
    s_mov_b32 s62, 4194304
    buffer_load_dwordx4 v56, s[8:11], s62 offen lds
    s_add_u32 m0, s99, 48128
    s_mov_b32 s62, 4227072
    buffer_load_dwordx4 v56, s[8:11], s62 offen lds
    s_add_u32 m0, s99, 49152
    s_mov_b32 s62, 4259840
    buffer_load_dwordx4 v56, s[8:11], s62 offen lds
    s_add_u32 m0, s99, 50176
    s_mov_b32 s62, 4292608
    buffer_load_dwordx4 v56, s[8:11], s62 offen lds
    ds_read_b64_tr_b16 v[160:161], v58 offset:12288
    ds_read_b64_tr_b16 v[162:163], v59 offset:12800
    ds_read_b64_tr_b16 v[164:165], v61 offset:12288
    ds_read_b64_tr_b16 v[166:167], v62 offset:12800
    ds_read_b64_tr_b16 v[168:169], v58 offset:12296
    ds_read_b64_tr_b16 v[170:171], v59 offset:12808
    ds_read_b64_tr_b16 v[172:173], v61 offset:12296
    ds_read_b64_tr_b16 v[174:175], v62 offset:12808
    s_waitcnt lgkmcnt(0)
    s_waitcnt vmcnt(12)
    s_barrier
    s_add_u32 m0, s99, 51200
    s_mov_b32 s62, 768
    buffer_load_dwordx4 v57, s[20:23], s62 offen lds
    s_add_u32 m0, s99, 52224
    s_mov_b32 s62, 9984
    buffer_load_dwordx4 v57, s[20:23], s62 offen lds
    s_add_u32 m0, s99, 53248
    s_mov_b32 s62, 19200
    buffer_load_dwordx4 v57, s[20:23], s62 offen lds
    s_add_u32 m0, s99, 54272
    s_mov_b32 s62, 28416
    buffer_load_dwordx4 v57, s[20:23], s62 offen lds
    ds_read_b64_tr_b16 a[208:209], v60 offset:16384
    ds_read_b64_tr_b16 a[210:211], v60 offset:16640
    ds_read_b64_tr_b16 a[212:213], v63 offset:16384
    ds_read_b64_tr_b16 a[214:215], v63 offset:16640
    ds_read_b64_tr_b16 a[216:217], v69 offset:16384
    ds_read_b64_tr_b16 a[218:219], v69 offset:16640
    ds_read_b64_tr_b16 a[220:221], v70 offset:16384
    ds_read_b64_tr_b16 a[222:223], v70 offset:16640
    s_waitcnt lgkmcnt(0)
    s_waitcnt vmcnt(12)
    s_barrier
    s_add_u32 m0, s99, 55296
    s_mov_b32 s62, 4194304
    buffer_load_dwordx4 v56, s[12:15], s62 offen lds
    s_add_u32 m0, s99, 56320
    s_mov_b32 s62, 4227072
    buffer_load_dwordx4 v56, s[12:15], s62 offen lds
    s_add_u32 m0, s99, 57344
    s_mov_b32 s62, 4259840
    buffer_load_dwordx4 v56, s[12:15], s62 offen lds
    s_add_u32 m0, s99, 58368
    s_mov_b32 s62, 4292608
    buffer_load_dwordx4 v56, s[12:15], s62 offen lds
    ds_read_b64_tr_b16 v[176:177], v58 offset:0
    ds_read_b64_tr_b16 v[178:179], v59 offset:512
    ds_read_b64_tr_b16 v[180:181], v61 offset:0
    ds_read_b64_tr_b16 v[182:183], v62 offset:512
    ds_read_b64_tr_b16 v[184:185], v58 offset:8
    ds_read_b64_tr_b16 v[186:187], v59 offset:520
    ds_read_b64_tr_b16 v[188:189], v61 offset:8
    ds_read_b64_tr_b16 v[190:191], v62 offset:520
    s_waitcnt lgkmcnt(0)
    s_waitcnt vmcnt(12)
    s_barrier
    s_add_u32 m0, s99, 38912
    s_mov_b32 s62, 2097152
    buffer_load_dwordx4 v56, s[16:19], s62 offen lds
    s_add_u32 m0, s99, 39936
    s_mov_b32 s62, 2129920
    buffer_load_dwordx4 v56, s[16:19], s62 offen lds
    s_add_u32 m0, s99, 40960
    s_mov_b32 s62, 2162688
    buffer_load_dwordx4 v56, s[16:19], s62 offen lds
    s_add_u32 m0, s99, 41984
    s_mov_b32 s62, 2195456
    buffer_load_dwordx4 v56, s[16:19], s62 offen lds
    ds_read_b64_tr_b16 v[192:193], v58 offset:4096
    ds_read_b64_tr_b16 v[194:195], v59 offset:4608
    ds_read_b64_tr_b16 v[196:197], v61 offset:4096
    ds_read_b64_tr_b16 v[198:199], v62 offset:4608
    ds_read_b64_tr_b16 v[200:201], v58 offset:4104
    ds_read_b64_tr_b16 v[202:203], v59 offset:4616
    ds_read_b64_tr_b16 v[204:205], v61 offset:4104
    ds_read_b64_tr_b16 v[206:207], v62 offset:4616
    s_waitcnt lgkmcnt(0)
    s_waitcnt vmcnt(12)
    s_barrier
    s_add_u32 m0, s99, 43008
    s_mov_b32 s62, 896
    buffer_load_dwordx4 v57, s[20:23], s62 offen lds
    s_add_u32 m0, s99, 44032
    s_mov_b32 s62, 10112
    buffer_load_dwordx4 v57, s[20:23], s62 offen lds
    s_add_u32 m0, s99, 45056
    s_mov_b32 s62, 19328
    buffer_load_dwordx4 v57, s[20:23], s62 offen lds
    s_add_u32 m0, s99, 46080
    s_mov_b32 s62, 28544
    buffer_load_dwordx4 v57, s[20:23], s62 offen lds
    ds_read_b64_tr_b16 v[248:249], v58 offset:8192
    ds_read_b64_tr_b16 v[250:251], v59 offset:8704
    ds_read_b64_tr_b16 v[252:253], v61 offset:8192
    ds_read_b64_tr_b16 v[254:255], v62 offset:8704
    ds_read_b64_tr_b16 a[0:1], v58 offset:8200
    ds_read_b64_tr_b16 a[2:3], v59 offset:8712
    ds_read_b64_tr_b16 a[4:5], v61 offset:8200
    ds_read_b64_tr_b16 a[6:7], v62 offset:8712
    s_waitcnt lgkmcnt(0)
    s_waitcnt vmcnt(12)
    s_barrier
    s_add_u32 m0, s99, 47104
    s_mov_b32 s62, 2621440
    buffer_load_dwordx4 v56, s[16:19], s62 offen lds
    s_add_u32 m0, s99, 48128
    s_mov_b32 s62, 2654208
    buffer_load_dwordx4 v56, s[16:19], s62 offen lds
    s_add_u32 m0, s99, 49152
    s_mov_b32 s62, 2686976
    buffer_load_dwordx4 v56, s[16:19], s62 offen lds
    s_add_u32 m0, s99, 50176
    s_mov_b32 s62, 2719744
    buffer_load_dwordx4 v56, s[16:19], s62 offen lds
    ds_read_b64_tr_b16 a[224:225], v60 offset:12288
    ds_read_b64_tr_b16 a[226:227], v60 offset:12544
    ds_read_b64_tr_b16 a[228:229], v63 offset:12288
    ds_read_b64_tr_b16 a[230:231], v63 offset:12544
    ds_read_b64_tr_b16 a[232:233], v69 offset:12288
    ds_read_b64_tr_b16 a[234:235], v69 offset:12544
    ds_read_b64_tr_b16 a[236:237], v70 offset:12288
    ds_read_b64_tr_b16 a[238:239], v70 offset:12544
    s_waitcnt lgkmcnt(0)
    s_waitcnt vmcnt(12)
    s_barrier
    s_add_u32 m0, s99, 51200
    s_mov_b32 s62, 3145728
    buffer_load_dwordx4 v56, s[16:19], s62 offen lds
    s_add_u32 m0, s99, 52224
    s_mov_b32 s62, 3178496
    buffer_load_dwordx4 v56, s[16:19], s62 offen lds
    s_add_u32 m0, s99, 53248
    s_mov_b32 s62, 3211264
    buffer_load_dwordx4 v56, s[16:19], s62 offen lds
    s_add_u32 m0, s99, 54272
    s_mov_b32 s62, 3244032
    buffer_load_dwordx4 v56, s[16:19], s62 offen lds
    buffer_load_dword v64, off, s[28:31], 0 offset:144 sc1
    ds_read_b64_tr_b16 a[8:9], v58 offset:16384
    ds_read_b64_tr_b16 a[10:11], v59 offset:16896
    ds_read_b64_tr_b16 a[12:13], v61 offset:16384
    ds_read_b64_tr_b16 a[14:15], v62 offset:16896
    ds_read_b64_tr_b16 a[16:17], v58 offset:16392
    ds_read_b64_tr_b16 a[18:19], v59 offset:16904
    ds_read_b64_tr_b16 a[20:21], v61 offset:16392
    ds_read_b64_tr_b16 a[22:23], v62 offset:16904
    s_waitcnt lgkmcnt(0)
    v_mov_b32 v58, v55
    v_xor_b32 v59, 0x80, v55
    v_add_u32 v61, 69632, v58
    v_add_u32 v62, 69632, v59
    s_waitcnt vmcnt(13)
    s_barrier
    s_add_u32 m0, s99, 55296
    s_mov_b32 s62, 3670016
    buffer_load_dwordx4 v56, s[16:19], s62 offen lds
    s_add_u32 m0, s99, 56320
    s_mov_b32 s62, 3702784
    buffer_load_dwordx4 v56, s[16:19], s62 offen lds
    s_add_u32 m0, s99, 57344
    s_mov_b32 s62, 3735552
    buffer_load_dwordx4 v56, s[16:19], s62 offen lds
    s_add_u32 m0, s99, 58368
    s_mov_b32 s62, 3768320
    buffer_load_dwordx4 v56, s[16:19], s62 offen lds
    ds_read_b64_tr_b16 a[112:113], v58 offset:0
    ds_read_b64_tr_b16 a[114:115], v59 offset:512
    ds_read_b64_tr_b16 a[116:117], v61 offset:0
    ds_read_b64_tr_b16 a[118:119], v62 offset:512
    ds_read_b64_tr_b16 a[120:121], v58 offset:8
    ds_read_b64_tr_b16 a[122:123], v59 offset:520
    ds_read_b64_tr_b16 a[124:125], v61 offset:8
    ds_read_b64_tr_b16 a[126:127], v62 offset:520
    s_waitcnt lgkmcnt(0)
    s_waitcnt vmcnt(13)
    s_barrier
    s_add_u32 m0, s99, 38912
    s_mov_b32 s62, 1024
    buffer_load_dwordx4 v57, s[20:23], s62 offen lds
    s_add_u32 m0, s99, 39936
    s_mov_b32 s62, 10240
    buffer_load_dwordx4 v57, s[20:23], s62 offen lds
    s_add_u32 m0, s99, 40960
    s_mov_b32 s62, 19456
    buffer_load_dwordx4 v57, s[20:23], s62 offen lds
    s_add_u32 m0, s99, 41984
    s_mov_b32 s62, 28672
    buffer_load_dwordx4 v57, s[20:23], s62 offen lds
    ds_read_b64_tr_b16 a[240:241], v60 offset:4096
    ds_read_b64_tr_b16 a[242:243], v60 offset:4352
    ds_read_b64_tr_b16 a[244:245], v63 offset:4096
    ds_read_b64_tr_b16 a[246:247], v63 offset:4352
    ds_read_b64_tr_b16 a[248:249], v69 offset:4096
    ds_read_b64_tr_b16 a[250:251], v69 offset:4352
    ds_read_b64_tr_b16 a[252:253], v70 offset:4096
    ds_read_b64_tr_b16 a[254:255], v70 offset:4352
    s_waitcnt lgkmcnt(0)
    s_waitcnt vmcnt(13)
    s_barrier
    s_add_u32 m0, s99, 43008
    s_mov_b32 s62, 4194304
    buffer_load_dwordx4 v56, s[16:19], s62 offen lds
    s_add_u32 m0, s99, 44032
    s_mov_b32 s62, 4227072
    buffer_load_dwordx4 v56, s[16:19], s62 offen lds
    s_add_u32 m0, s99, 45056
    s_mov_b32 s62, 4259840
    buffer_load_dwordx4 v56, s[16:19], s62 offen lds
    s_add_u32 m0, s99, 46080
    s_mov_b32 s62, 4292608
    buffer_load_dwordx4 v56, s[16:19], s62 offen lds
    ds_read_b64_tr_b16 a[128:129], v58 offset:8192
    ds_read_b64_tr_b16 a[130:131], v59 offset:8704
    ds_read_b64_tr_b16 a[132:133], v61 offset:8192
    ds_read_b64_tr_b16 a[134:135], v62 offset:8704
    ds_read_b64_tr_b16 a[136:137], v58 offset:8200
    ds_read_b64_tr_b16 a[138:139], v59 offset:8712
    ds_read_b64_tr_b16 a[140:141], v61 offset:8200
    ds_read_b64_tr_b16 a[142:143], v62 offset:8712
    s_waitcnt lgkmcnt(0)
    s_waitcnt vmcnt(13)
    s_barrier
    s_add_u32 m0, s99, 47104
    s_mov_b32 s62, 0
    buffer_load_dwordx4 v56, s[16:19], s62 offen lds
    s_add_u32 m0, s99, 48128
    s_mov_b32 s62, 32768
    buffer_load_dwordx4 v56, s[16:19], s62 offen lds
    s_add_u32 m0, s99, 49152
    s_mov_b32 s62, 65536
    buffer_load_dwordx4 v56, s[16:19], s62 offen lds
    s_add_u32 m0, s99, 50176
    s_mov_b32 s62, 98304
    buffer_load_dwordx4 v56, s[16:19], s62 offen lds
    ds_read_b64_tr_b16 a[88:89], v58 offset:12288
    ds_read_b64_tr_b16 a[90:91], v59 offset:12800
    ds_read_b64_tr_b16 a[92:93], v61 offset:12288
    ds_read_b64_tr_b16 a[94:95], v62 offset:12800
    ds_read_b64_tr_b16 a[96:97], v58 offset:12296
    ds_read_b64_tr_b16 a[98:99], v59 offset:12808
    ds_read_b64_tr_b16 a[100:101], v61 offset:12296
    ds_read_b64_tr_b16 a[102:103], v62 offset:12808
    s_waitcnt lgkmcnt(0)
    s_waitcnt vmcnt(12)
    s_barrier
    s_add_u32 m0, s99, 51200
    s_mov_b32 s62, 524288
    buffer_load_dwordx4 v56, s[16:19], s62 offen lds
    s_add_u32 m0, s99, 52224
    s_mov_b32 s62, 557056
    buffer_load_dwordx4 v56, s[16:19], s62 offen lds
    s_add_u32 m0, s99, 53248
    s_mov_b32 s62, 589824
    buffer_load_dwordx4 v56, s[16:19], s62 offen lds
    s_add_u32 m0, s99, 54272
    s_mov_b32 s62, 622592
    buffer_load_dwordx4 v56, s[16:19], s62 offen lds
    ds_read_b64_tr_b16 a[104:105], v58 offset:16384
    ds_read_b64_tr_b16 a[106:107], v59 offset:16896
    ds_read_b64_tr_b16 a[108:109], v61 offset:16384
    ds_read_b64_tr_b16 a[110:111], v62 offset:16896
    ds_read_b64_tr_b16 v[20:21], v58 offset:16392
    ds_read_b64_tr_b16 v[22:23], v59 offset:16904
    ds_read_b64_tr_b16 v[24:25], v61 offset:16392
    ds_read_b64_tr_b16 v[26:27], v62 offset:16904
    s_waitcnt lgkmcnt(0)
    buffer_store_dwordx4 v[20:23], v0, s[4:7], s96 offen offset:0
    buffer_store_dwordx4 v[24:27], v0, s[4:7], s96 offen offset:1024
    s_waitcnt vmcnt(14)
    s_barrier
    s_add_u32 m0, s99, 55296
    s_mov_b32 s62, 1048576
    buffer_load_dwordx4 v56, s[16:19], s62 offen lds
    s_add_u32 m0, s99, 56320
    s_mov_b32 s62, 1081344
    buffer_load_dwordx4 v56, s[16:19], s62 offen lds
    s_add_u32 m0, s99, 57344
    s_mov_b32 s62, 1114112
    buffer_load_dwordx4 v56, s[16:19], s62 offen lds
    s_add_u32 m0, s99, 58368
    s_mov_b32 s62, 1146880
    buffer_load_dwordx4 v56, s[16:19], s62 offen lds
    ds_read_b64_tr_b16 a[32:33], v60 offset:0
    ds_read_b64_tr_b16 a[34:35], v60 offset:256
    ds_read_b64_tr_b16 a[36:37], v63 offset:0
    ds_read_b64_tr_b16 a[38:39], v63 offset:256
    ds_read_b64_tr_b16 v[28:29], v69 offset:0
    ds_read_b64_tr_b16 v[30:31], v69 offset:256
    ds_read_b64_tr_b16 v[32:33], v70 offset:0
    ds_read_b64_tr_b16 v[34:35], v70 offset:256
    s_waitcnt lgkmcnt(0)
    s_waitcnt vmcnt(14)
    s_barrier
    s_add_u32 m0, s99, 38912
    s_mov_b32 s62, 1572864
    buffer_load_dwordx4 v56, s[16:19], s62 offen lds
    s_add_u32 m0, s99, 39936
    s_mov_b32 s62, 1605632
    buffer_load_dwordx4 v56, s[16:19], s62 offen lds
    s_add_u32 m0, s99, 40960
    s_mov_b32 s62, 1638400
    buffer_load_dwordx4 v56, s[16:19], s62 offen lds
    s_add_u32 m0, s99, 41984
    s_mov_b32 s62, 1671168
    buffer_load_dwordx4 v56, s[16:19], s62 offen lds
    ds_read_b64_tr_b16 a[144:145], v58 offset:4096
    ds_read_b64_tr_b16 a[146:147], v59 offset:4608
    ds_read_b64_tr_b16 a[148:149], v61 offset:4096
    ds_read_b64_tr_b16 a[150:151], v62 offset:4608
    ds_read_b64_tr_b16 a[152:153], v58 offset:4104
    ds_read_b64_tr_b16 a[154:155], v59 offset:4616
    ds_read_b64_tr_b16 a[156:157], v61 offset:4104
    ds_read_b64_tr_b16 a[158:159], v62 offset:4616
    s_waitcnt lgkmcnt(0)
    s_waitcnt vmcnt(14)
    s_barrier
    ds_write_b128 v2, a[72:75] offset:18432
    ds_write_b128 v2, a[76:79] offset:19456
    ds_write_b128 v2, a[80:83] offset:20480
    ds_write_b128 v2, a[84:87] offset:21504
    ds_read_b64_tr_b16 a[56:57], v58 offset:8192
    ds_read_b64_tr_b16 a[58:59], v59 offset:8704
    ds_read_b64_tr_b16 a[60:61], v61 offset:8192
    ds_read_b64_tr_b16 a[62:63], v62 offset:8704
    ds_read_b64_tr_b16 a[64:65], v58 offset:8200
    ds_read_b64_tr_b16 a[66:67], v59 offset:8712
    ds_read_b64_tr_b16 a[68:69], v61 offset:8200
    ds_read_b64_tr_b16 a[70:71], v62 offset:8712
    s_waitcnt lgkmcnt(0)
    s_waitcnt vmcnt(10)
    s_barrier
    ds_write_b128 v2, a[24:27] offset:22528
    ds_write_b128 v2, a[28:31] offset:23552
    ds_write_b128 v2, a[32:35] offset:24576
    ds_write_b128 v2, a[36:39] offset:25600
    ds_read_b64_tr_b16 a[72:73], v58 offset:12288
    ds_read_b64_tr_b16 a[74:75], v59 offset:12800
    ds_read_b64_tr_b16 a[76:77], v61 offset:12288
    ds_read_b64_tr_b16 a[78:79], v62 offset:12800
    ds_read_b64_tr_b16 a[80:81], v58 offset:12296
    ds_read_b64_tr_b16 a[82:83], v59 offset:12808
    ds_read_b64_tr_b16 a[84:85], v61 offset:12296
    ds_read_b64_tr_b16 a[86:87], v62 offset:12808
    s_waitcnt lgkmcnt(0)
    s_waitcnt vmcnt(4)
    s_barrier
    v_lshrrev_b32 v65, 2, v0
    s_lshl_b32 s62, s32, 8
    s_add_u32 s62, s62, 81789952
    buffer_load_dword v65, v65, s[4:7], s62 offen sc1
    buffer_load_dword v66, off, s[28:31], 0 offset:16 sc1
    ds_write_b128 v2, a[40:43] offset:26624
    ds_write_b128 v2, a[44:47] offset:27648
    ds_write_b128 v2, a[48:51] offset:28672
    ds_write_b128 v2, a[52:55] offset:29696
    ds_read_b64_tr_b16 a[24:25], v58 offset:16384
    ds_read_b64_tr_b16 a[26:27], v59 offset:16896
    ds_read_b64_tr_b16 a[28:29], v61 offset:16384
    ds_read_b64_tr_b16 a[30:31], v62 offset:16896
    ds_read_b64_tr_b16 a[32:33], v58 offset:16392
    ds_read_b64_tr_b16 a[34:35], v59 offset:16904
    ds_read_b64_tr_b16 a[36:37], v61 offset:16392
    ds_read_b64_tr_b16 a[38:39], v62 offset:16904
    s_waitcnt lgkmcnt(0)
    s_waitcnt vmcnt(2)
    s_barrier
    ds_write_b128 v2, v[28:31] offset:30720
    ds_write_b128 v2, v[32:35] offset:31744
    ds_read_b64_tr_b16 a[40:41], v58 offset:0
    ds_read_b64_tr_b16 a[42:43], v59 offset:512
    ds_read_b64_tr_b16 a[44:45], v61 offset:0
    ds_read_b64_tr_b16 a[46:47], v62 offset:512
    ds_read_b64_tr_b16 a[48:49], v58 offset:8
    ds_read_b64_tr_b16 a[50:51], v59 offset:520
    ds_read_b64_tr_b16 a[52:53], v61 offset:8
    ds_read_b64_tr_b16 a[54:55], v62 offset:520
    s_waitcnt lgkmcnt(0)
    s_barrier
    ds_write_b128 v2, v[36:39] offset:14336
    ds_write_b128 v2, v[40:43] offset:15360
    ds_write_b128 v2, v[44:47] offset:16384
    ds_write_b128 v2, v[48:51] offset:17408
    s_branch L_initjoin_1
L_cls3_5:
    v_add_u32 v63, 34816, v60
    v_add_u32 v69, 69632, v60
    v_add_u32 v70, 104448, v60
    v_mov_b32 v58, v54
    v_xor_b32 v59, 0x80, v54
    v_add_u32 v61, 69632, v58
    v_add_u32 v62, 69632, v59
    s_waitcnt vmcnt(19)
    s_barrier
    s_add_u32 m0, s99, 55296
    s_mov_b32 s62, 524288
    buffer_load_dwordx4 v56, s[12:15], s62 offen lds
    s_add_u32 m0, s99, 56320
    s_mov_b32 s62, 557056
    buffer_load_dwordx4 v56, s[12:15], s62 offen lds
    s_add_u32 m0, s99, 57344
    s_mov_b32 s62, 589824
    buffer_load_dwordx4 v56, s[12:15], s62 offen lds
    s_add_u32 m0, s99, 58368
    s_mov_b32 s62, 622592
    buffer_load_dwordx4 v56, s[12:15], s62 offen lds
    ds_read_b64_tr_b16 v[12:13], v58 offset:0
    ds_read_b64_tr_b16 v[14:15], v59 offset:512
    ds_read_b64_tr_b16 v[16:17], v61 offset:0
    ds_read_b64_tr_b16 v[18:19], v62 offset:512
    ds_read_b64_tr_b16 v[20:21], v58 offset:8
    ds_read_b64_tr_b16 v[22:23], v59 offset:520
    ds_read_b64_tr_b16 v[24:25], v61 offset:8
    ds_read_b64_tr_b16 v[26:27], v62 offset:520
    s_waitcnt lgkmcnt(0)
    ds_write_b128 v2, v[12:15] offset:2048
    ds_write_b128 v2, v[16:19] offset:3072
    ds_write_b128 v2, v[20:23] offset:12288
    ds_write_b128 v2, v[24:27] offset:13312
    s_waitcnt vmcnt(19)
    s_barrier
    s_add_u32 m0, s99, 38912
    s_mov_b32 s62, 128
    buffer_load_dwordx4 v57, s[20:23], s62 offen lds
    s_add_u32 m0, s99, 39936
    s_mov_b32 s62, 9344
    buffer_load_dwordx4 v57, s[20:23], s62 offen lds
    s_add_u32 m0, s99, 40960
    s_mov_b32 s62, 18560
    buffer_load_dwordx4 v57, s[20:23], s62 offen lds
    s_add_u32 m0, s99, 41984
    s_mov_b32 s62, 27776
    buffer_load_dwordx4 v57, s[20:23], s62 offen lds
    ds_read_b64_tr_b16 v[112:113], v58 offset:4096
    ds_read_b64_tr_b16 v[114:115], v59 offset:4608
    ds_read_b64_tr_b16 v[116:117], v61 offset:4096
    ds_read_b64_tr_b16 v[118:119], v62 offset:4608
    ds_read_b64_tr_b16 v[120:121], v58 offset:4104
    ds_read_b64_tr_b16 v[122:123], v59 offset:4616
    ds_read_b64_tr_b16 v[124:125], v61 offset:4104
    ds_read_b64_tr_b16 v[126:127], v62 offset:4616
    s_waitcnt lgkmcnt(0)
    s_waitcnt vmcnt(19)
    s_barrier
    s_add_u32 m0, s99, 43008
    s_mov_b32 s62, 1048576
    buffer_load_dwordx4 v56, s[8:11], s62 offen lds
    s_add_u32 m0, s99, 44032
    s_mov_b32 s62, 1081344
    buffer_load_dwordx4 v56, s[8:11], s62 offen lds
    s_add_u32 m0, s99, 45056
    s_mov_b32 s62, 1114112
    buffer_load_dwordx4 v56, s[8:11], s62 offen lds
    s_add_u32 m0, s99, 46080
    s_mov_b32 s62, 1146880
    buffer_load_dwordx4 v56, s[8:11], s62 offen lds
    ds_read_b64_tr_b16 a[80:81], v60 offset:8192
    ds_read_b64_tr_b16 a[82:83], v60 offset:8448
    ds_read_b64_tr_b16 a[84:85], v63 offset:8192
    ds_read_b64_tr_b16 a[86:87], v63 offset:8448
    ds_read_b64_tr_b16 a[24:25], v69 offset:8192
    ds_read_b64_tr_b16 a[26:27], v69 offset:8448
    ds_read_b64_tr_b16 a[28:29], v70 offset:8192
    ds_read_b64_tr_b16 a[30:31], v70 offset:8448
    s_waitcnt lgkmcnt(0)
    s_waitcnt vmcnt(19)
    s_barrier
    s_add_u32 m0, s99, 47104
    s_mov_b32 s62, 1048576
    buffer_load_dwordx4 v56, s[12:15], s62 offen lds
    s_add_u32 m0, s99, 48128
    s_mov_b32 s62, 1081344
    buffer_load_dwordx4 v56, s[12:15], s62 offen lds
    s_add_u32 m0, s99, 49152
    s_mov_b32 s62, 1114112
    buffer_load_dwordx4 v56, s[12:15], s62 offen lds
    s_add_u32 m0, s99, 50176
    s_mov_b32 s62, 1146880
    buffer_load_dwordx4 v56, s[12:15], s62 offen lds
    ds_read_b64_tr_b16 v[128:129], v58 offset:12288
    ds_read_b64_tr_b16 v[130:131], v59 offset:12800
    ds_read_b64_tr_b16 v[132:133], v61 offset:12288
    ds_read_b64_tr_b16 v[134:135], v62 offset:12800
    ds_read_b64_tr_b16 v[136:137], v58 offset:12296
    ds_read_b64_tr_b16 v[138:139], v59 offset:12808
    ds_read_b64_tr_b16 v[140:141], v61 offset:12296
    ds_read_b64_tr_b16 v[142:143], v62 offset:12808
    s_waitcnt lgkmcnt(0)
    s_waitcnt vmcnt(12)
    s_barrier
    s_add_u32 m0, s99, 51200
    s_mov_b32 s62, 1572864
    buffer_load_dwordx4 v56, s[8:11], s62 offen lds
    s_add_u32 m0, s99, 52224
    s_mov_b32 s62, 1605632
    buffer_load_dwordx4 v56, s[8:11], s62 offen lds
    s_add_u32 m0, s99, 53248
    s_mov_b32 s62, 1638400
    buffer_load_dwordx4 v56, s[8:11], s62 offen lds
    s_add_u32 m0, s99, 54272
    s_mov_b32 s62, 1671168
    buffer_load_dwordx4 v56, s[8:11], s62 offen lds
    ds_read_b64_tr_b16 v[144:145], v58 offset:16384
    ds_read_b64_tr_b16 v[146:147], v59 offset:16896
    ds_read_b64_tr_b16 v[148:149], v61 offset:16384
    ds_read_b64_tr_b16 v[150:151], v62 offset:16896
    ds_read_b64_tr_b16 v[152:153], v58 offset:16392
    ds_read_b64_tr_b16 v[154:155], v59 offset:16904
    ds_read_b64_tr_b16 v[156:157], v61 offset:16392
    ds_read_b64_tr_b16 v[158:159], v62 offset:16904
    s_waitcnt lgkmcnt(0)
    s_waitcnt vmcnt(12)
    s_barrier
    s_add_u32 m0, s99, 55296
    s_mov_b32 s62, 256
    buffer_load_dwordx4 v57, s[20:23], s62 offen lds
    s_add_u32 m0, s99, 56320
    s_mov_b32 s62, 9472
    buffer_load_dwordx4 v57, s[20:23], s62 offen lds
    s_add_u32 m0, s99, 57344
    s_mov_b32 s62, 18688
    buffer_load_dwordx4 v57, s[20:23], s62 offen lds
    s_add_u32 m0, s99, 58368
    s_mov_b32 s62, 27904
    buffer_load_dwordx4 v57, s[20:23], s62 offen lds
    buffer_store_dwordx2 v[52:53], v6, s[4:7], s42 offen sc1
    ds_read_b64_tr_b16 a[160:161], v60 offset:0
    ds_read_b64_tr_b16 a[162:163], v60 offset:256
    ds_read_b64_tr_b16 a[164:165], v63 offset:0
    ds_read_b64_tr_b16 a[166:167], v63 offset:256
    ds_read_b64_tr_b16 a[168:169], v69 offset:0
    ds_read_b64_tr_b16 a[170:171], v69 offset:256
    ds_read_b64_tr_b16 a[172:173], v70 offset:0
    ds_read_b64_tr_b16 a[174:175], v70 offset:256
    s_waitcnt lgkmcnt(0)
    s_waitcnt vmcnt(13)
    s_barrier
    s_add_u32 m0, s99, 38912
    s_mov_b32 s62, 1572864
    buffer_load_dwordx4 v56, s[12:15], s62 offen lds
    s_add_u32 m0, s99, 39936
    s_mov_b32 s62, 1605632
    buffer_load_dwordx4 v56, s[12:15], s62 offen lds
    s_add_u32 m0, s99, 40960
    s_mov_b32 s62, 1638400
    buffer_load_dwordx4 v56, s[12:15], s62 offen lds
    s_add_u32 m0, s99, 41984
    s_mov_b32 s62, 1671168
    buffer_load_dwordx4 v56, s[12:15], s62 offen lds
    ds_read_b64_tr_b16 v[80:81], v58 offset:4096
    ds_read_b64_tr_b16 v[82:83], v59 offset:4608
    ds_read_b64_tr_b16 v[84:85], v61 offset:4096
    ds_read_b64_tr_b16 v[86:87], v62 offset:4608
    ds_read_b64_tr_b16 v[88:89], v58 offset:4104
    ds_read_b64_tr_b16 v[90:91], v59 offset:4616
    ds_read_b64_tr_b16 v[92:93], v61 offset:4104
    ds_read_b64_tr_b16 v[94:95], v62 offset:4616
    s_waitcnt lgkmcnt(0)
    s_waitcnt vmcnt(13)
    s_barrier
    s_add_u32 m0, s99, 43008
    s_mov_b32 s62, 2097152
    buffer_load_dwordx4 v56, s[8:11], s62 offen lds
    s_add_u32 m0, s99, 44032
    s_mov_b32 s62, 2129920
    buffer_load_dwordx4 v56, s[8:11], s62 offen lds
    s_add_u32 m0, s99, 45056
    s_mov_b32 s62, 2162688
    buffer_load_dwordx4 v56, s[8:11], s62 offen lds
    s_add_u32 m0, s99, 46080
    s_mov_b32 s62, 2195456
    buffer_load_dwordx4 v56, s[8:11], s62 offen lds
    ds_read_b64_tr_b16 v[96:97], v58 offset:8192
    ds_read_b64_tr_b16 v[98:99], v59 offset:8704
    ds_read_b64_tr_b16 v[100:101], v61 offset:8192
    ds_read_b64_tr_b16 v[102:103], v62 offset:8704
    ds_read_b64_tr_b16 v[104:105], v58 offset:8200
    ds_read_b64_tr_b16 v[106:107], v59 offset:8712
    ds_read_b64_tr_b16 v[108:109], v61 offset:8200
    ds_read_b64_tr_b16 v[110:111], v62 offset:8712
    s_waitcnt lgkmcnt(0)
    s_waitcnt vmcnt(13)
    s_barrier
    s_add_u32 m0, s99, 47104
    s_mov_b32 s62, 384
    buffer_load_dwordx4 v57, s[20:23], s62 offen lds
    s_add_u32 m0, s99, 48128
    s_mov_b32 s62, 9600
    buffer_load_dwordx4 v57, s[20:23], s62 offen lds
    s_add_u32 m0, s99, 49152
    s_mov_b32 s62, 18816
    buffer_load_dwordx4 v57, s[20:23], s62 offen lds
    s_add_u32 m0, s99, 50176
    s_mov_b32 s62, 28032
    buffer_load_dwordx4 v57, s[20:23], s62 offen lds
    ds_read_b64_tr_b16 a[72:73], v58 offset:12288
    ds_read_b64_tr_b16 a[74:75], v59 offset:12800
    ds_read_b64_tr_b16 a[76:77], v61 offset:12288
    ds_read_b64_tr_b16 a[78:79], v62 offset:12800
    ds_read_b64_tr_b16 v[12:13], v58 offset:12296
    ds_read_b64_tr_b16 v[14:15], v59 offset:12808
    ds_read_b64_tr_b16 v[16:17], v61 offset:12296
    ds_read_b64_tr_b16 v[18:19], v62 offset:12808
    s_waitcnt lgkmcnt(0)
    ds_write_b128 v2, v[12:15] offset:0
    ds_write_b128 v2, v[16:19] offset:1024
    s_waitcnt vmcnt(13)
    s_barrier
    s_add_u32 m0, s99, 51200
    s_mov_b32 s62, 2097152
    buffer_load_dwordx4 v56, s[12:15], s62 offen lds
    s_add_u32 m0, s99, 52224
    s_mov_b32 s62, 2129920
    buffer_load_dwordx4 v56, s[12:15], s62 offen lds
    s_add_u32 m0, s99, 53248
    s_mov_b32 s62, 2162688
    buffer_load_dwordx4 v56, s[12:15], s62 offen lds
    s_add_u32 m0, s99, 54272
    s_mov_b32 s62, 2195456
    buffer_load_dwordx4 v56, s[12:15], s62 offen lds
    ds_read_b64_tr_b16 a[176:177], v60 offset:16384
    ds_read_b64_tr_b16 a[178:179], v60 offset:16640
    ds_read_b64_tr_b16 a[180:181], v63 offset:16384
    ds_read_b64_tr_b16 a[182:183], v63 offset:16640
    ds_read_b64_tr_b16 a[184:185], v69 offset:16384
    ds_read_b64_tr_b16 a[186:187], v69 offset:16640
    ds_read_b64_tr_b16 a[188:189], v70 offset:16384
    ds_read_b64_tr_b16 a[190:191], v70 offset:16640
    s_waitcnt lgkmcnt(0)
    s_waitcnt vmcnt(12)
    s_barrier
    s_add_u32 m0, s99, 55296
    s_mov_b32 s62, 2621440
    buffer_load_dwordx4 v56, s[8:11], s62 offen lds
    s_add_u32 m0, s99, 56320
    s_mov_b32 s62, 2654208
    buffer_load_dwordx4 v56, s[8:11], s62 offen lds
    s_add_u32 m0, s99, 57344
    s_mov_b32 s62, 2686976
    buffer_load_dwordx4 v56, s[8:11], s62 offen lds
    s_add_u32 m0, s99, 58368
    s_mov_b32 s62, 2719744
    buffer_load_dwordx4 v56, s[8:11], s62 offen lds
    ds_read_b64_tr_b16 v[20:21], v58 offset:0
    ds_read_b64_tr_b16 v[22:23], v59 offset:512
    ds_read_b64_tr_b16 v[24:25], v61 offset:0
    ds_read_b64_tr_b16 v[26:27], v62 offset:512
    ds_read_b64_tr_b16 v[72:73], v58 offset:8
    ds_read_b64_tr_b16 v[74:75], v59 offset:520
    ds_read_b64_tr_b16 v[76:77], v61 offset:8
    ds_read_b64_tr_b16 v[78:79], v62 offset:520
    s_waitcnt lgkmcnt(0)
    ds_write_b128 v2, v[20:23] offset:10240
    ds_write_b128 v2, v[24:27] offset:11264
    s_waitcnt vmcnt(12)
    s_barrier
    s_add_u32 m0, s99, 38912
    s_mov_b32 s62, 2621440
    buffer_load_dwordx4 v56, s[12:15], s62 offen lds
    s_add_u32 m0, s99, 39936
    s_mov_b32 s62, 2654208
    buffer_load_dwordx4 v56, s[12:15], s62 offen lds
    s_add_u32 m0, s99, 40960
    s_mov_b32 s62, 2686976
    buffer_load_dwordx4 v56, s[12:15], s62 offen lds
    s_add_u32 m0, s99, 41984
    s_mov_b32 s62, 2719744
    buffer_load_dwordx4 v56, s[12:15], s62 offen lds
    ds_read_b64_tr_b16 v[12:13], v58 offset:4096
    ds_read_b64_tr_b16 v[14:15], v59 offset:4608
    ds_read_b64_tr_b16 v[16:17], v61 offset:4096
    ds_read_b64_tr_b16 v[18:19], v62 offset:4608
    ds_read_b64_tr_b16 v[44:45], v58 offset:4104
    ds_read_b64_tr_b16 v[46:47], v59 offset:4616
    ds_read_b64_tr_b16 v[48:49], v61 offset:4104
    ds_read_b64_tr_b16 v[50:51], v62 offset:4616
    s_waitcnt lgkmcnt(0)
    ds_write_b128 v2, v[12:15] offset:6144
    ds_write_b128 v2, v[16:19] offset:7168
    s_waitcnt vmcnt(12)
    s_barrier
    s_add_u32 m0, s99, 43008
    s_mov_b32 s62, 512
    buffer_load_dwordx4 v57, s[20:23], s62 offen lds
    s_add_u32 m0, s99, 44032
    s_mov_b32 s62, 9728
    buffer_load_dwordx4 v57, s[20:23], s62 offen lds
    s_add_u32 m0, s99, 45056
    s_mov_b32 s62, 18944
    buffer_load_dwordx4 v57, s[20:23], s62 offen lds
    s_add_u32 m0, s99, 46080
    s_mov_b32 s62, 28160
    buffer_load_dwordx4 v57, s[20:23], s62 offen lds
    ds_read_b64_tr_b16 a[192:193], v60 offset:8192
    ds_read_b64_tr_b16 a[194:195], v60 offset:8448
    ds_read_b64_tr_b16 a[196:197], v63 offset:8192
    ds_read_b64_tr_b16 a[198:199], v63 offset:8448
    ds_read_b64_tr_b16 a[200:201], v69 offset:8192
    ds_read_b64_tr_b16 a[202:203], v69 offset:8448
    ds_read_b64_tr_b16 a[204:205], v70 offset:8192
    ds_read_b64_tr_b16 a[206:207], v70 offset:8448
    s_waitcnt lgkmcnt(0)
    s_waitcnt vmcnt(12)
    s_barrier
    s_add_u32 m0, s99, 47104
    s_mov_b32 s62, 3145728
    buffer_load_dwordx4 v56, s[8:11], s62 offen lds
    s_add_u32 m0, s99, 48128
    s_mov_b32 s62, 3178496
    buffer_load_dwordx4 v56, s[8:11], s62 offen lds
    s_add_u32 m0, s99, 49152
    s_mov_b32 s62, 3211264
    buffer_load_dwordx4 v56, s[8:11], s62 offen lds
    s_add_u32 m0, s99, 50176
    s_mov_b32 s62, 3244032
    buffer_load_dwordx4 v56, s[8:11], s62 offen lds
    ds_read_b64_tr_b16 v[208:209], v58 offset:12288
    ds_read_b64_tr_b16 v[210:211], v59 offset:12800
    ds_read_b64_tr_b16 v[212:213], v61 offset:12288
    ds_read_b64_tr_b16 v[214:215], v62 offset:12800
    ds_read_b64_tr_b16 v[216:217], v58 offset:12296
    ds_read_b64_tr_b16 v[218:219], v59 offset:12808
    ds_read_b64_tr_b16 v[220:221], v61 offset:12296
    ds_read_b64_tr_b16 v[222:223], v62 offset:12808
    s_waitcnt lgkmcnt(0)
    s_waitcnt vmcnt(12)
    s_barrier
    s_add_u32 m0, s99, 51200
    s_mov_b32 s62, 3145728
    buffer_load_dwordx4 v56, s[12:15], s62 offen lds
    s_add_u32 m0, s99, 52224
    s_mov_b32 s62, 3178496
    buffer_load_dwordx4 v56, s[12:15], s62 offen lds
    s_add_u32 m0, s99, 53248
    s_mov_b32 s62, 3211264
    buffer_load_dwordx4 v56, s[12:15], s62 offen lds
    s_add_u32 m0, s99, 54272
    s_mov_b32 s62, 3244032
    buffer_load_dwordx4 v56, s[12:15], s62 offen lds
    ds_read_b64_tr_b16 v[224:225], v58 offset:16384
    ds_read_b64_tr_b16 v[226:227], v59 offset:16896
    ds_read_b64_tr_b16 v[228:229], v61 offset:16384
    ds_read_b64_tr_b16 v[230:231], v62 offset:16896
    ds_read_b64_tr_b16 v[232:233], v58 offset:16392
    ds_read_b64_tr_b16 v[234:235], v59 offset:16904
    ds_read_b64_tr_b16 v[236:237], v61 offset:16392
    ds_read_b64_tr_b16 v[238:239], v62 offset:16904
    s_waitcnt lgkmcnt(0)
    s_waitcnt vmcnt(12)
    s_barrier
    s_add_u32 m0, s99, 55296
    s_mov_b32 s62, 640
    buffer_load_dwordx4 v57, s[20:23], s62 offen lds
    s_add_u32 m0, s99, 56320
    s_mov_b32 s62, 9856
    buffer_load_dwordx4 v57, s[20:23], s62 offen lds
    s_add_u32 m0, s99, 57344
    s_mov_b32 s62, 19072
    buffer_load_dwordx4 v57, s[20:23], s62 offen lds
    s_add_u32 m0, s99, 58368
    s_mov_b32 s62, 28288
    buffer_load_dwordx4 v57, s[20:23], s62 offen lds
    ds_read_b64_tr_b16 v[240:241], v58 offset:0
    ds_read_b64_tr_b16 v[242:243], v59 offset:512
    ds_read_b64_tr_b16 v[244:245], v61 offset:0
    ds_read_b64_tr_b16 v[246:247], v62 offset:512
    ds_read_b64_tr_b16 v[20:21], v58 offset:8
    ds_read_b64_tr_b16 v[22:23], v59 offset:520
    ds_read_b64_tr_b16 v[24:25], v61 offset:8
    ds_read_b64_tr_b16 v[26:27], v62 offset:520
    s_waitcnt lgkmcnt(0)
    ds_write_b128 v2, v[20:23] offset:8192
    ds_write_b128 v2, v[24:27] offset:9216
    s_waitcnt vmcnt(12)
    s_barrier
    s_add_u32 m0, s99, 38912
    s_mov_b32 s62, 3670016
    buffer_load_dwordx4 v56, s[8:11], s62 offen lds
    s_add_u32 m0, s99, 39936
    s_mov_b32 s62, 3702784
    buffer_load_dwordx4 v56, s[8:11], s62 offen lds
    s_add_u32 m0, s99, 40960
    s_mov_b32 s62, 3735552
    buffer_load_dwordx4 v56, s[8:11], s62 offen lds
    s_add_u32 m0, s99, 41984
    s_mov_b32 s62, 3768320
    buffer_load_dwordx4 v56, s[8:11], s62 offen lds
    ds_read_b64_tr_b16 a[40:41], v60 offset:4096
    ds_read_b64_tr_b16 a[42:43], v60 offset:4352
    ds_read_b64_tr_b16 a[44:45], v63 offset:4096
    ds_read_b64_tr_b16 a[46:47], v63 offset:4352
    ds_read_b64_tr_b16 a[32:33], v69 offset:4096
    ds_read_b64_tr_b16 a[34:35], v69 offset:4352
    ds_read_b64_tr_b16 a[36:37], v70 offset:4096
    ds_read_b64_tr_b16 a[38:39], v70 offset:4352
    s_waitcnt lgkmcnt(0)
    s_waitcnt vmcnt(12)
    s_barrier
    s_add_u32 m0, s99, 43008
    s_mov_b32 s62, 3670016
    buffer_load_dwordx4 v56, s[12:15], s62 offen lds
    s_add_u32 m0, s99, 44032
    s_mov_b32 s62, 3702784
    buffer_load_dwordx4 v56, s[12:15], s62 offen lds
    s_add_u32 m0, s99, 45056
    s_mov_b32 s62, 3735552
    buffer_load_dwordx4 v56, s[12:15], s62 offen lds
    s_add_u32 m0, s99, 46080
    s_mov_b32 s62, 3768320
    buffer_load_dwordx4 v56, s[12:15], s62 offen lds
    ds_read_b64_tr_b16 v[176:177], v58 offset:8192
    ds_read_b64_tr_b16 v[178:179], v59 offset:8704
    ds_read_b64_tr_b16 v[180:181], v61 offset:8192
    ds_read_b64_tr_b16 v[182:183], v62 offset:8704
    ds_read_b64_tr_b16 v[184:185], v58 offset:8200
    ds_read_b64_tr_b16 v[186:187], v59 offset:8712
    ds_read_b64_tr_b16 v[188:189], v61 offset:8200
    ds_read_b64_tr_b16 v[190:191], v62 offset:8712
    s_waitcnt lgkmcnt(0)
    s_waitcnt vmcnt(12)
    s_barrier
    s_add_u32 m0, s99, 47104
    s_mov_b32 s62, 4194304
    buffer_load_dwordx4 v56, s[8:11], s62 offen lds
    s_add_u32 m0, s99, 48128
    s_mov_b32 s62, 4227072
    buffer_load_dwordx4 v56, s[8:11], s62 offen lds
    s_add_u32 m0, s99, 49152
    s_mov_b32 s62, 4259840
    buffer_load_dwordx4 v56, s[8:11], s62 offen lds
    s_add_u32 m0, s99, 50176
    s_mov_b32 s62, 4292608
    buffer_load_dwordx4 v56, s[8:11], s62 offen lds
    ds_read_b64_tr_b16 v[192:193], v58 offset:12288
    ds_read_b64_tr_b16 v[194:195], v59 offset:12800
    ds_read_b64_tr_b16 v[196:197], v61 offset:12288
    ds_read_b64_tr_b16 v[198:199], v62 offset:12800
    ds_read_b64_tr_b16 v[200:201], v58 offset:12296
    ds_read_b64_tr_b16 v[202:203], v59 offset:12808
    ds_read_b64_tr_b16 v[204:205], v61 offset:12296
    ds_read_b64_tr_b16 v[206:207], v62 offset:12808
    s_waitcnt lgkmcnt(0)
    s_waitcnt vmcnt(12)
    s_barrier
    s_add_u32 m0, s99, 51200
    s_mov_b32 s62, 768
    buffer_load_dwordx4 v57, s[20:23], s62 offen lds
    s_add_u32 m0, s99, 52224
    s_mov_b32 s62, 9984
    buffer_load_dwordx4 v57, s[20:23], s62 offen lds
    s_add_u32 m0, s99, 53248
    s_mov_b32 s62, 19200
    buffer_load_dwordx4 v57, s[20:23], s62 offen lds
    s_add_u32 m0, s99, 54272
    s_mov_b32 s62, 28416
    buffer_load_dwordx4 v57, s[20:23], s62 offen lds
    ds_read_b64_tr_b16 a[208:209], v60 offset:16384
    ds_read_b64_tr_b16 a[210:211], v60 offset:16640
    ds_read_b64_tr_b16 a[212:213], v63 offset:16384
    ds_read_b64_tr_b16 a[214:215], v63 offset:16640
    ds_read_b64_tr_b16 a[216:217], v69 offset:16384
    ds_read_b64_tr_b16 a[218:219], v69 offset:16640
    ds_read_b64_tr_b16 a[220:221], v70 offset:16384
    ds_read_b64_tr_b16 a[222:223], v70 offset:16640
    s_waitcnt lgkmcnt(0)
    s_waitcnt vmcnt(12)
    s_barrier
    s_add_u32 m0, s99, 55296
    s_mov_b32 s62, 4194304
    buffer_load_dwordx4 v56, s[12:15], s62 offen lds
    s_add_u32 m0, s99, 56320
    s_mov_b32 s62, 4227072
    buffer_load_dwordx4 v56, s[12:15], s62 offen lds
    s_add_u32 m0, s99, 57344
    s_mov_b32 s62, 4259840
    buffer_load_dwordx4 v56, s[12:15], s62 offen lds
    s_add_u32 m0, s99, 58368
    s_mov_b32 s62, 4292608
    buffer_load_dwordx4 v56, s[12:15], s62 offen lds
    ds_read_b64_tr_b16 v[12:13], v58 offset:0
    ds_read_b64_tr_b16 v[14:15], v59 offset:512
    ds_read_b64_tr_b16 v[16:17], v61 offset:0
    ds_read_b64_tr_b16 v[18:19], v62 offset:512
    ds_read_b64_tr_b16 v[36:37], v58 offset:8
    ds_read_b64_tr_b16 v[38:39], v59 offset:520
    ds_read_b64_tr_b16 v[40:41], v61 offset:8
    ds_read_b64_tr_b16 v[42:43], v62 offset:520
    s_waitcnt lgkmcnt(0)
    ds_write_b128 v2, v[12:15] offset:4096
    ds_write_b128 v2, v[16:19] offset:5120
    s_waitcnt vmcnt(12)
    s_barrier
    s_add_u32 m0, s99, 38912
    s_mov_b32 s62, 2097152
    buffer_load_dwordx4 v56, s[16:19], s62 offen lds
    s_add_u32 m0, s99, 39936
    s_mov_b32 s62, 2129920
    buffer_load_dwordx4 v56, s[16:19], s62 offen lds
    s_add_u32 m0, s99, 40960
    s_mov_b32 s62, 2162688
    buffer_load_dwordx4 v56, s[16:19], s62 offen lds
    s_add_u32 m0, s99, 41984
    s_mov_b32 s62, 2195456
    buffer_load_dwordx4 v56, s[16:19], s62 offen lds
    ds_read_b64_tr_b16 v[160:161], v58 offset:4096
    ds_read_b64_tr_b16 v[162:163], v59 offset:4608
    ds_read_b64_tr_b16 v[164:165], v61 offset:4096
    ds_read_b64_tr_b16 v[166:167], v62 offset:4608
    ds_read_b64_tr_b16 v[168:169], v58 offset:4104
    ds_read_b64_tr_b16 v[170:171], v59 offset:4616
    ds_read_b64_tr_b16 v[172:173], v61 offset:4104
    ds_read_b64_tr_b16 v[174:175], v62 offset:4616
    s_waitcnt lgkmcnt(0)
    s_waitcnt vmcnt(12)
    s_barrier
    s_add_u32 m0, s99, 43008
    s_mov_b32 s62, 896
    buffer_load_dwordx4 v57, s[20:23], s62 offen lds
    s_add_u32 m0, s99, 44032
    s_mov_b32 s62, 10112
    buffer_load_dwordx4 v57, s[20:23], s62 offen lds
    s_add_u32 m0, s99, 45056
    s_mov_b32 s62, 19328
    buffer_load_dwordx4 v57, s[20:23], s62 offen lds
    s_add_u32 m0, s99, 46080
    s_mov_b32 s62, 28544
    buffer_load_dwordx4 v57, s[20:23], s62 offen lds
    ds_read_b64_tr_b16 v[248:249], v58 offset:8192
    ds_read_b64_tr_b16 v[250:251], v59 offset:8704
    ds_read_b64_tr_b16 v[252:253], v61 offset:8192
    ds_read_b64_tr_b16 v[254:255], v62 offset:8704
    ds_read_b64_tr_b16 a[0:1], v58 offset:8200
    ds_read_b64_tr_b16 a[2:3], v59 offset:8712
    ds_read_b64_tr_b16 a[4:5], v61 offset:8200
    ds_read_b64_tr_b16 a[6:7], v62 offset:8712
    s_waitcnt lgkmcnt(0)
    s_waitcnt vmcnt(12)
    s_barrier
    s_add_u32 m0, s99, 47104
    s_mov_b32 s62, 2621440
    buffer_load_dwordx4 v56, s[16:19], s62 offen lds
    s_add_u32 m0, s99, 48128
    s_mov_b32 s62, 2654208
    buffer_load_dwordx4 v56, s[16:19], s62 offen lds
    s_add_u32 m0, s99, 49152
    s_mov_b32 s62, 2686976
    buffer_load_dwordx4 v56, s[16:19], s62 offen lds
    s_add_u32 m0, s99, 50176
    s_mov_b32 s62, 2719744
    buffer_load_dwordx4 v56, s[16:19], s62 offen lds
    ds_read_b64_tr_b16 a[224:225], v60 offset:12288
    ds_read_b64_tr_b16 a[226:227], v60 offset:12544
    ds_read_b64_tr_b16 a[228:229], v63 offset:12288
    ds_read_b64_tr_b16 a[230:231], v63 offset:12544
    ds_read_b64_tr_b16 a[232:233], v69 offset:12288
    ds_read_b64_tr_b16 a[234:235], v69 offset:12544
    ds_read_b64_tr_b16 a[236:237], v70 offset:12288
    ds_read_b64_tr_b16 a[238:239], v70 offset:12544
    s_waitcnt lgkmcnt(0)
    s_waitcnt vmcnt(12)
    s_barrier
    s_add_u32 m0, s99, 51200
    s_mov_b32 s62, 3145728
    buffer_load_dwordx4 v56, s[16:19], s62 offen lds
    s_add_u32 m0, s99, 52224
    s_mov_b32 s62, 3178496
    buffer_load_dwordx4 v56, s[16:19], s62 offen lds
    s_add_u32 m0, s99, 53248
    s_mov_b32 s62, 3211264
    buffer_load_dwordx4 v56, s[16:19], s62 offen lds
    s_add_u32 m0, s99, 54272
    s_mov_b32 s62, 3244032
    buffer_load_dwordx4 v56, s[16:19], s62 offen lds
    buffer_load_dword v64, off, s[28:31], 0 offset:144 sc1
    ds_read_b64_tr_b16 a[8:9], v58 offset:16384
    ds_read_b64_tr_b16 a[10:11], v59 offset:16896
    ds_read_b64_tr_b16 a[12:13], v61 offset:16384
    ds_read_b64_tr_b16 a[14:15], v62 offset:16896
    ds_read_b64_tr_b16 a[16:17], v58 offset:16392
    ds_read_b64_tr_b16 a[18:19], v59 offset:16904
    ds_read_b64_tr_b16 a[20:21], v61 offset:16392
    ds_read_b64_tr_b16 a[22:23], v62 offset:16904
    s_waitcnt lgkmcnt(0)
    v_mov_b32 v58, v55
    v_xor_b32 v59, 0x80, v55
    v_add_u32 v61, 69632, v58
    v_add_u32 v62, 69632, v59
    s_waitcnt vmcnt(13)
    s_barrier
    s_add_u32 m0, s99, 55296
    s_mov_b32 s62, 3670016
    buffer_load_dwordx4 v56, s[16:19], s62 offen lds
    s_add_u32 m0, s99, 56320
    s_mov_b32 s62, 3702784
    buffer_load_dwordx4 v56, s[16:19], s62 offen lds
    s_add_u32 m0, s99, 57344
    s_mov_b32 s62, 3735552
    buffer_load_dwordx4 v56, s[16:19], s62 offen lds
    s_add_u32 m0, s99, 58368
    s_mov_b32 s62, 3768320
    buffer_load_dwordx4 v56, s[16:19], s62 offen lds
    ds_read_b64_tr_b16 a[112:113], v58 offset:0
    ds_read_b64_tr_b16 a[114:115], v59 offset:512
    ds_read_b64_tr_b16 a[116:117], v61 offset:0
    ds_read_b64_tr_b16 a[118:119], v62 offset:512
    ds_read_b64_tr_b16 a[120:121], v58 offset:8
    ds_read_b64_tr_b16 a[122:123], v59 offset:520
    ds_read_b64_tr_b16 a[124:125], v61 offset:8
    ds_read_b64_tr_b16 a[126:127], v62 offset:520
    s_waitcnt lgkmcnt(0)
    s_waitcnt vmcnt(13)
    s_barrier
    s_add_u32 m0, s99, 38912
    s_mov_b32 s62, 1024
    buffer_load_dwordx4 v57, s[20:23], s62 offen lds
    s_add_u32 m0, s99, 39936
    s_mov_b32 s62, 10240
    buffer_load_dwordx4 v57, s[20:23], s62 offen lds
    s_add_u32 m0, s99, 40960
    s_mov_b32 s62, 19456
    buffer_load_dwordx4 v57, s[20:23], s62 offen lds
    s_add_u32 m0, s99, 41984
    s_mov_b32 s62, 28672
    buffer_load_dwordx4 v57, s[20:23], s62 offen lds
    ds_read_b64_tr_b16 a[240:241], v60 offset:4096
    ds_read_b64_tr_b16 a[242:243], v60 offset:4352
    ds_read_b64_tr_b16 a[244:245], v63 offset:4096
    ds_read_b64_tr_b16 a[246:247], v63 offset:4352
    ds_read_b64_tr_b16 a[248:249], v69 offset:4096
    ds_read_b64_tr_b16 a[250:251], v69 offset:4352
    ds_read_b64_tr_b16 a[252:253], v70 offset:4096
    ds_read_b64_tr_b16 a[254:255], v70 offset:4352
    s_waitcnt lgkmcnt(0)
    s_waitcnt vmcnt(13)
    s_barrier
    s_add_u32 m0, s99, 43008
    s_mov_b32 s62, 4194304
    buffer_load_dwordx4 v56, s[16:19], s62 offen lds
    s_add_u32 m0, s99, 44032
    s_mov_b32 s62, 4227072
    buffer_load_dwordx4 v56, s[16:19], s62 offen lds
    s_add_u32 m0, s99, 45056
    s_mov_b32 s62, 4259840
    buffer_load_dwordx4 v56, s[16:19], s62 offen lds
    s_add_u32 m0, s99, 46080
    s_mov_b32 s62, 4292608
    buffer_load_dwordx4 v56, s[16:19], s62 offen lds
    ds_read_b64_tr_b16 a[128:129], v58 offset:8192
    ds_read_b64_tr_b16 a[130:131], v59 offset:8704
    ds_read_b64_tr_b16 a[132:133], v61 offset:8192
    ds_read_b64_tr_b16 a[134:135], v62 offset:8704
    ds_read_b64_tr_b16 a[136:137], v58 offset:8200
    ds_read_b64_tr_b16 a[138:139], v59 offset:8712
    ds_read_b64_tr_b16 a[140:141], v61 offset:8200
    ds_read_b64_tr_b16 a[142:143], v62 offset:8712
    s_waitcnt lgkmcnt(0)
    s_waitcnt vmcnt(13)
    s_barrier
    s_add_u32 m0, s99, 47104
    s_mov_b32 s62, 0
    buffer_load_dwordx4 v56, s[16:19], s62 offen lds
    s_add_u32 m0, s99, 48128
    s_mov_b32 s62, 32768
    buffer_load_dwordx4 v56, s[16:19], s62 offen lds
    s_add_u32 m0, s99, 49152
    s_mov_b32 s62, 65536
    buffer_load_dwordx4 v56, s[16:19], s62 offen lds
    s_add_u32 m0, s99, 50176
    s_mov_b32 s62, 98304
    buffer_load_dwordx4 v56, s[16:19], s62 offen lds
    ds_read_b64_tr_b16 a[104:105], v58 offset:12288
    ds_read_b64_tr_b16 a[106:107], v59 offset:12800
    ds_read_b64_tr_b16 a[108:109], v61 offset:12288
    ds_read_b64_tr_b16 a[110:111], v62 offset:12800
    ds_read_b64_tr_b16 v[20:21], v58 offset:12296
    ds_read_b64_tr_b16 v[22:23], v59 offset:12808
    ds_read_b64_tr_b16 v[24:25], v61 offset:12296
    ds_read_b64_tr_b16 v[26:27], v62 offset:12808
    s_waitcnt lgkmcnt(0)
    buffer_store_dwordx4 v[20:23], v0, s[4:7], s96 offen offset:0
    buffer_store_dwordx4 v[24:27], v0, s[4:7], s96 offen offset:1024
    s_waitcnt vmcnt(14)
    s_barrier
    s_add_u32 m0, s99, 51200
    s_mov_b32 s62, 524288
    buffer_load_dwordx4 v56, s[16:19], s62 offen lds
    s_add_u32 m0, s99, 52224
    s_mov_b32 s62, 557056
    buffer_load_dwordx4 v56, s[16:19], s62 offen lds
    s_add_u32 m0, s99, 53248
    s_mov_b32 s62, 589824
    buffer_load_dwordx4 v56, s[16:19], s62 offen lds
    s_add_u32 m0, s99, 54272
    s_mov_b32 s62, 622592
    buffer_load_dwordx4 v56, s[16:19], s62 offen lds
    ds_read_b64_tr_b16 a[88:89], v58 offset:16384
    ds_read_b64_tr_b16 a[90:91], v59 offset:16896
    ds_read_b64_tr_b16 a[92:93], v61 offset:16384
    ds_read_b64_tr_b16 a[94:95], v62 offset:16896
    ds_read_b64_tr_b16 a[96:97], v58 offset:16392
    ds_read_b64_tr_b16 a[98:99], v59 offset:16904
    ds_read_b64_tr_b16 a[100:101], v61 offset:16392
    ds_read_b64_tr_b16 a[102:103], v62 offset:16904
    s_waitcnt lgkmcnt(0)
    s_waitcnt vmcnt(14)
    s_barrier
    s_add_u32 m0, s99, 55296
    s_mov_b32 s62, 1048576
    buffer_load_dwordx4 v56, s[16:19], s62 offen lds
    s_add_u32 m0, s99, 56320
    s_mov_b32 s62, 1081344
    buffer_load_dwordx4 v56, s[16:19], s62 offen lds
    s_add_u32 m0, s99, 57344
    s_mov_b32 s62, 1114112
    buffer_load_dwordx4 v56, s[16:19], s62 offen lds
    s_add_u32 m0, s99, 58368
    s_mov_b32 s62, 1146880
    buffer_load_dwordx4 v56, s[16:19], s62 offen lds
    ds_read_b64_tr_b16 a[48:49], v60 offset:0
    ds_read_b64_tr_b16 a[50:51], v60 offset:256
    ds_read_b64_tr_b16 a[52:53], v63 offset:0
    ds_read_b64_tr_b16 a[54:55], v63 offset:256
    ds_read_b64_tr_b16 v[28:29], v69 offset:0
    ds_read_b64_tr_b16 v[30:31], v69 offset:256
    ds_read_b64_tr_b16 v[32:33], v70 offset:0
    ds_read_b64_tr_b16 v[34:35], v70 offset:256
    s_waitcnt lgkmcnt(0)
    s_waitcnt vmcnt(14)
    s_barrier
    s_add_u32 m0, s99, 38912
    s_mov_b32 s62, 1572864
    buffer_load_dwordx4 v56, s[16:19], s62 offen lds
    s_add_u32 m0, s99, 39936
    s_mov_b32 s62, 1605632
    buffer_load_dwordx4 v56, s[16:19], s62 offen lds
    s_add_u32 m0, s99, 40960
    s_mov_b32 s62, 1638400
    buffer_load_dwordx4 v56, s[16:19], s62 offen lds
    s_add_u32 m0, s99, 41984
    s_mov_b32 s62, 1671168
    buffer_load_dwordx4 v56, s[16:19], s62 offen lds
    ds_read_b64_tr_b16 a[144:145], v58 offset:4096
    ds_read_b64_tr_b16 a[146:147], v59 offset:4608
    ds_read_b64_tr_b16 a[148:149], v61 offset:4096
    ds_read_b64_tr_b16 a[150:151], v62 offset:4608
    ds_read_b64_tr_b16 a[152:153], v58 offset:4104
    ds_read_b64_tr_b16 a[154:155], v59 offset:4616
    ds_read_b64_tr_b16 a[156:157], v61 offset:4104
    ds_read_b64_tr_b16 a[158:159], v62 offset:4616
    s_waitcnt lgkmcnt(0)
    s_waitcnt vmcnt(14)
    s_barrier
    ds_write_b128 v2, a[72:75] offset:18432
    ds_write_b128 v2, a[76:79] offset:19456
    ds_write_b128 v2, a[80:83] offset:20480
    ds_write_b128 v2, a[84:87] offset:21504
    ds_read_b64_tr_b16 a[56:57], v58 offset:8192
    ds_read_b64_tr_b16 a[58:59], v59 offset:8704
    ds_read_b64_tr_b16 a[60:61], v61 offset:8192
    ds_read_b64_tr_b16 a[62:63], v62 offset:8704
    ds_read_b64_tr_b16 a[64:65], v58 offset:8200
    ds_read_b64_tr_b16 a[66:67], v59 offset:8712
    ds_read_b64_tr_b16 a[68:69], v61 offset:8200
    ds_read_b64_tr_b16 a[70:71], v62 offset:8712
    s_waitcnt lgkmcnt(0)
    s_waitcnt vmcnt(8)
    s_barrier
    ds_write_b128 v2, a[40:43] offset:22528
    ds_write_b128 v2, a[44:47] offset:23552
    ds_write_b128 v2, a[48:51] offset:24576
    ds_write_b128 v2, a[52:55] offset:25600
    ds_read_b64_tr_b16 a[72:73], v58 offset:12288
    ds_read_b64_tr_b16 a[74:75], v59 offset:12800
    ds_read_b64_tr_b16 a[76:77], v61 offset:12288
    ds_read_b64_tr_b16 a[78:79], v62 offset:12800
    ds_read_b64_tr_b16 a[80:81], v58 offset:12296
    ds_read_b64_tr_b16 a[82:83], v59 offset:12808
    ds_read_b64_tr_b16 a[84:85], v61 offset:12296
    ds_read_b64_tr_b16 a[86:87], v62 offset:12808
    s_waitcnt lgkmcnt(0)
    s_waitcnt vmcnt(4)
    s_barrier
    v_lshrrev_b32 v65, 2, v0
    s_lshl_b32 s62, s32, 8
    s_add_u32 s62, s62, 81789952
    buffer_load_dword v65, v65, s[4:7], s62 offen sc1
    buffer_load_dword v66, off, s[28:31], 0 offset:16 sc1
    ds_write_b128 v2, a[24:27] offset:26624
    ds_write_b128 v2, a[28:31] offset:27648
    ds_write_b128 v2, a[32:35] offset:28672
    ds_write_b128 v2, a[36:39] offset:29696
    ds_read_b64_tr_b16 a[40:41], v58 offset:16384
    ds_read_b64_tr_b16 a[42:43], v59 offset:16896
    ds_read_b64_tr_b16 a[44:45], v61 offset:16384
    ds_read_b64_tr_b16 a[46:47], v62 offset:16896
    ds_read_b64_tr_b16 a[48:49], v58 offset:16392
    ds_read_b64_tr_b16 a[50:51], v59 offset:16904
    ds_read_b64_tr_b16 a[52:53], v61 offset:16392
    ds_read_b64_tr_b16 a[54:55], v62 offset:16904
    s_waitcnt lgkmcnt(0)
    s_waitcnt vmcnt(2)
    s_barrier
    ds_write_b128 v2, v[28:31] offset:30720
    ds_write_b128 v2, v[32:35] offset:31744
    ds_read_b64_tr_b16 a[24:25], v58 offset:0
    ds_read_b64_tr_b16 a[26:27], v59 offset:512
    ds_read_b64_tr_b16 a[28:29], v61 offset:0
    ds_read_b64_tr_b16 a[30:31], v62 offset:512
    ds_read_b64_tr_b16 a[32:33], v58 offset:8
    ds_read_b64_tr_b16 a[34:35], v59 offset:520
    ds_read_b64_tr_b16 a[36:37], v61 offset:8
    ds_read_b64_tr_b16 a[38:39], v62 offset:520
    s_waitcnt lgkmcnt(0)
    s_barrier
    ds_write_b128 v2, v[36:39] offset:14336
    ds_write_b128 v2, v[40:43] offset:15360
    ds_write_b128 v2, v[44:47] offset:16384
    ds_write_b128 v2, v[48:51] offset:17408
L_initjoin_1:
    s_add_u32 s8, s38, 0
    s_add_u32 s9, s38, 32768
    s_add_u32 s10, s38, 65536
    s_add_u32 s11, s38, 98304
    s_add_u32 s12, s38, 131072
    s_add_u32 s13, s38, 163840
    s_add_u32 s14, s38, 196608
    s_add_u32 s15, s38, 229376
    s_add_u32 s16, s38, 262144
    s_lshl_b32 s17, s32, 7
    s_add_u32 s17, s17, 81847296
    s_cmp_eq_u32 s33, 3
    s_cselect_b32 s17, s17, 0x40000000
    s_mov_b64 s[20:21], 1
    s_mov_b32 s26, 0xcccccccc
    s_mov_b32 s27, 0xcccccccc
    s_lshl_b32 s18, s33, 8
    s_add_u32 s18, s18, 8192
    s_cmp_lt_u32 s35, 32
    s_cselect_b32 s24, s41, 0x40000000
    s_lshl_b32 s19, s32, 8
    s_add_u32 s19, s19, 81789952
    v_mov_b32 v12, 18432
    v_mov_b32 v13, 0
    ds_write_b32 v12, v13
    s_waitcnt vmcnt(0) lgkmcnt(0)
    v_readfirstlane_b32 s61, v64
    v_readfirstlane_b32 s60, v66
    v_cmp_ne_u32 s[22:23], 0, v65
    s_nop 3
    s_cmp_eq_u32 s61, 0
    s_cbranch_scc1 L_slow0_7
    s_bitcmp1_b32 s22, 0
    s_cbranch_scc1 L_needteam_9
    s_branch L_needkv_8
L_slow0_7:
L_tw_10:
    buffer_load_dword v11, off, s[28:31], 0 offset:144 sc1
    s_waitcnt vmcnt(0)
    v_cmp_eq_u32 vcc, 0, v11
    s_cbranch_vccz L_twok_11
    s_sleep 2
    s_sub_u32 s37, s37, 1
    s_cbranch_scc0 L_tw_10
    s_mov_b32 s37, 0
L_twok_11:
L_needkv_8:
L_kvr_12:
    v_lshrrev_b32 v11, 2, v0
    buffer_load_dword v11, v11, s[4:7], s19 offen sc1
    s_waitcnt vmcnt(0)
    v_cmp_ne_u32 s[22:23], 0, v11
    s_nop 3
    s_bitcmp1_b64 s[22:23], s36
    s_cbranch_scc1 L_needteam_9
    s_sub_u32 s37, s37, 1
    s_cbranch_scc0 L_kvr_12
    s_mov_b32 s37, 0
    s_branch L_needteam_9
L_needteam_9:
    s_bitcmp1_b32 s60, 5
    s_cbranch_scc1 L_fast0_6
L_tb_13:
    buffer_load_dword v11, off, s[28:31], 0 offset:16 sc1
    s_waitcnt vmcnt(0)
    v_readfirstlane_b32 s60, v11
    s_nop 3
    s_bitcmp1_b32 s60, 5
    s_cbranch_scc1 L_fast0_6
    s_sub_u32 s37, s37, 1
    s_cbranch_scc0 L_tb_13
    s_mov_b32 s37, 0
L_fast0_6:
    s_cmp_lt_u32 s33, 3
    s_cselect_b64 s[22:23], -1, s[22:23]
    ds_read_b128 v[48:51], v2 offset:0
    ds_read_b128 v[52:55], v2 offset:1024
    ds_read_b128 v[56:59], v2 offset:10240
    ds_read_b128 v[60:63], v2 offset:11264
    ds_read_b128 v[64:67], v2 offset:18432
    ds_read_b128 v[68:71], v2 offset:19456
    v_mov_b64 v[12:13], 0
    v_mov_b64 v[14:15], 0
    v_mov_b64 v[16:17], 0
    v_mov_b64 v[18:19], 0
    v_mov_b64 v[20:21], 0
    v_mov_b64 v[22:23], 0
    v_mov_b64 v[24:25], 0
    v_mov_b64 v[26:27], 0
    v_mov_b64 v[28:29], 0
    v_mov_b64 v[30:31], 0
    v_mov_b64 v[32:33], 0
    v_mov_b64 v[34:35], 0
    s_waitcnt lgkmcnt(0)
    s_lshr_b32 s60, s60, 8
    s_bcnt1_i32_b32 s60, s60
    s_cmp_lg_u32 s60, 1
    s_cbranch_scc1 L_slow_14
    s_branch L_s1_20
L_kvrf_30:
L_kvr_32:
    v_lshrrev_b32 v11, 2, v0
    buffer_load_dword v11, v11, s[4:7], s19 offen sc1
    s_waitcnt vmcnt(0)
    v_cmp_ne_u32 s[22:23], 0, v11
    s_nop 3
    s_bitcmp1_b64 s[22:23], s36
    s_cbranch_scc1 L_kvok_31
    s_sub_u32 s37, s37, 1
    s_cbranch_scc0 L_kvr_32
    s_mov_b32 s37, 0
    s_branch L_kvok_31
L_nored_18:
    s_cmp_eq_u32 s35, -1
    s_cbranch_scc1 L_nored_18_n
    s_waitcnt vmcnt(2)
    s_branch L_go1_29
L_nored_18_n:
    s_mov_b32 s60, s42
    s_mov_b32 s42, s43
    s_mov_b32 s43, s44
    s_mov_b32 s44, s60
    s_add_u32 s39, s42, 4096
    s_add_u32 s40, s42, 8192
    s_mov_b32 m0, s18
    v_mov_b64 v[36:37], -1
    v_mov_b64 v[38:39], -1
    v_mov_b64 v[40:41], -1
    v_mov_b64 v[42:43], -1
    s_add_u32 s61, s36, 1
    s_bitcmp1_b64 s[22:23], s61
    s_cbranch_scc1 L_full_33
    v_lshrrev_b32 v11, 2, v0
    buffer_load_dword v11, v11, s[4:7], s19 offen sc1
    s_waitcnt vmcnt(0)
    v_cmp_ne_u32 s[22:23], 0, v11
L_full_33:
    v_mov_b32 v46, 18432
L_flag_34:
    ds_read_b32 v11, v46
    s_waitcnt lgkmcnt(0)
    v_cmp_eq_u32 vcc, s36, v11
    s_cbranch_vccnz L_b4_19
    s_sub_u32 s37, s37, 1
    s_cbranch_scc0 L_flag_34
    s_mov_b32 s37, 0
    s_branch L_b4_19
    s_branch L_b4_19
L_s2r_24:
    buffer_load_dwordx4 v[64:67], v8, s[4:7], s39 offen sc1
    s_waitcnt vmcnt(1)
    v_max3_u32 v11, v64, v65, v66
    v_max_u32 v11, v11, v67
    v_cmp_eq_u32 vcc, -1, v11
    s_cbranch_vccz L_s2r_24_d
    s_sub_u32 s37, s37, 1
    s_cbranch_scc0 L_s2r_24
    s_mov_b32 s37, 0
    s_branch L_s2r_24_d
L_s2r_24_d:
    s_waitcnt vmcnt(0)
    s_branch L_s2ok_25
L_s3r_26:
    buffer_load_dwordx4 v[40:43], v0, s[4:7], s40 offen sc1
    s_waitcnt vmcnt(0)
    v_max3_u32 v52, v40, v41, v42
    v_max_u32 v52, v52, v43
    v_cmp_eq_u32 vcc, -1, v52
    s_cbranch_vccz L_s3ok_27
    s_sub_u32 s37, s37, 1
    s_cbranch_scc0 L_s3r_26
    s_mov_b32 s37, 0
    s_branch L_s3ok_27
L_s1_20:
    s_add_u32 s39, s42, 4096
    s_add_u32 s40, s42, 8192
    s_mov_b32 m0, s18
    buffer_load_dwordx4 v[36:39], v8, s[4:7], s42 offen sc1
    buffer_load_dwordx4 v[40:43], v9, s[4:7], s42 offen sc1
    s_waitcnt vmcnt(0)
    s_branch L_s1w_21
    .p2align 6
L_s1r_23:
    s_mov_b64 exec, vcc
    buffer_load_dwordx4 v[36:39], v8, s[4:7], s42 offen sc1
    buffer_load_dwordx4 v[40:43], v9, s[4:7], s42 offen sc1
    s_mov_b64 exec, -1
    s_sub_u32 s37, s37, 1
    s_cbranch_scc1 L_s1r_23_give
    s_waitcnt vmcnt(2)
L_s1w_21:
    v_max3_u32 v11, v36, v37, v38
    v_max3_u32 v11, v11, v39, v40
    v_max3_u32 v11, v11, v41, v42
    v_max_u32 v11, v11, v43
    v_cmp_eq_u32 vcc, -1, v11
    s_cbranch_vccnz L_s1r_23
L_entry_15:
    ds_write_b128 v8, v[36:39] offset:0
    v_smfmac_f32_16x16x64_bf16 v[20:23], v[36:39], v[64:71], v1
    buffer_load_dwordx4 v[64:67], v8, s[4:7], s39 offen sc1
    v_smfmac_f32_16x16x64_bf16 v[24:27], v[36:39], v[48:55], v1
    v_lshrrev_b32 v69, 2, v8
    v_smfmac_f32_16x16x64_bf16 v[28:31], v[36:39], v[56:63], v1
    ds_read_b128 v[56:59], v2 offset:12288
    v_smfmac_f32_16x16x64_bf16 v[32:35], v[36:39], v[72:79], v1
    ds_read_b128 v[48:51], v2 offset:2048
    v_smfmac_f32_16x16x64_bf16 v[12:15], v[36:39], a[24:31], v1
    ds_read_b128 v[52:55], v2 offset:3072
    s_waitcnt lgkmcnt(3)
    v_smfmac_f32_16x16x64_bf16 v[16:19], v[36:39], a[32:39], v1
    s_barrier
    ds_read_b128 v[44:47], v10 offset:0
    v_smfmac_f32_16x16x64_bf16 v[20:23], v[40:43], v[80:87], v1
    buffer_load_dword v69, s[4:7], s40 offen sc1 lds
    s_mov_b32 m0, s51
    v_smfmac_f32_16x16x64_bf16 v[24:27], v[40:43], v[88:95], v1
    ds_read_b128 v[60:63], v2 offset:13312
    v_smfmac_f32_16x16x64_bf16 v[28:31], v[40:43], v[96:103], v1
    buffer_load_dwordx4 v0, s[4:7], s45 offen sc1 lds
    v_smfmac_f32_16x16x64_bf16 v[32:35], v[40:43], v[104:111], v1
    s_add_u32 s36, s36, 1
    v_smfmac_f32_16x16x64_bf16 v[12:15], v[40:43], a[40:47], v1
    buffer_load_dwordx4 v0, s[4:7], s45 offen offset:1024 sc1 lds
    v_smfmac_f32_16x16x64_bf16 v[16:19], v[40:43], a[48:55], v1
    s_waitcnt vmcnt(4)
    ds_read_b128 v[36:39], v10 offset:1024
    s_waitcnt lgkmcnt(1)
    v_smfmac_f32_16x16x64_bf16 v[20:23], v[44:47], v[48:55], v1
    ds_read_b128 v[48:51], v2 offset:4096
    v_smfmac_f32_16x16x64_bf16 v[24:27], v[44:47], v[56:63], v1
    ds_read_b128 v[52:55], v2 offset:5120
    v_smfmac_f32_16x16x64_bf16 v[28:31], v[44:47], v[112:119], v1
    ds_read_b128 v[56:59], v2 offset:14336
    v_smfmac_f32_16x16x64_bf16 v[32:35], v[44:47], v[120:127], v1
    ds_read_b128 v[60:63], v2 offset:15360
    v_smfmac_f32_16x16x64_bf16 v[12:15], v[44:47], a[56:63], v1
    s_mov_b32 m0, s50
    v_smfmac_f32_16x16x64_bf16 v[16:19], v[44:47], a[64:71], v1
    s_waitcnt lgkmcnt(4)
    v_smfmac_f32_16x16x64_bf16 v[20:23], v[36:39], v[128:135], v1
    s_waitcnt vmcnt(3)
    v_max3_u32 v11, v64, v65, v66
    v_max_u32 v11, v11, v67
    v_cmp_eq_u32 vcc, -1, v11
    v_smfmac_f32_16x16x64_bf16 v[24:27], v[36:39], v[136:143], v1
    v_smfmac_f32_16x16x64_bf16 v[28:31], v[36:39], v[144:151], v1
    s_cbranch_vccnz L_s2r_24
L_s2ok_25:
    ds_write_b128 v8, v[64:67] offset:4096
    v_smfmac_f32_16x16x64_bf16 v[32:35], v[36:39], v[152:159], v1
    v_smfmac_f32_16x16x64_bf16 v[12:15], v[36:39], a[72:79], v1
    buffer_load_dwordx4 v0, s[4:7], s97 offen sc1 lds
    v_smfmac_f32_16x16x64_bf16 v[16:19], v[36:39], a[80:87], v1
    buffer_load_dwordx4 v0, s[4:7], s97 offen offset:1024 sc1 lds
    s_waitcnt lgkmcnt(1)
    v_smfmac_f32_16x16x64_bf16 v[20:23], v[64:67], v[48:55], v1
    ds_read_b128 v[48:51], v2 offset:6144
    v_smfmac_f32_16x16x64_bf16 v[24:27], v[64:67], v[56:63], v1
    s_waitcnt vmcnt(2) lgkmcnt(1)
    s_barrier
    ds_read_b128 v[40:43], v9 offset:4096
    v_smfmac_f32_16x16x64_bf16 v[28:31], v[64:67], v[160:167], v1
    ds_read_b128 v[44:47], v10 offset:4096
    v_smfmac_f32_16x16x64_bf16 v[32:35], v[64:67], v[168:175], v1
    ds_read_b128 v[36:39], v10 offset:5120
    v_smfmac_f32_16x16x64_bf16 v[12:15], v[64:67], a[88:95], v1
    ds_read_b128 v[52:55], v2 offset:7168
    v_smfmac_f32_16x16x64_bf16 v[16:19], v[64:67], a[96:103], v1
    ds_read_b128 v[56:59], v2 offset:16384
    s_waitcnt lgkmcnt(4)
    v_smfmac_f32_16x16x64_bf16 v[20:23], v[40:43], v[176:183], v1
    buffer_load_dwordx4 v[64:67], v0, s[4:7], s96 offen offset:0
    v_smfmac_f32_16x16x64_bf16 v[24:27], v[40:43], v[184:191], v1
    buffer_load_dwordx4 v[68:71], v0, s[4:7], s96 offen offset:1024
    s_bitcmp1_b64 s[22:23], s36
    v_smfmac_f32_16x16x64_bf16 v[28:31], v[40:43], v[192:199], v1
    ds_read_b128 v[60:63], v2 offset:17408
    v_smfmac_f32_16x16x64_bf16 v[32:35], v[40:43], v[200:207], v1
    ds_read_b128 v[40:43], v0 offset:8192
    s_mov_b32 m0, 24192
    s_cbranch_scc0 L_kvrf_30
L_kvok_31:
    s_waitcnt lgkmcnt(3)
    v_smfmac_f32_16x16x64_bf16 v[20:23], v[44:47], v[48:55], v1
    ds_read_b128 v[48:51], v2 offset:8192
    s_waitcnt lgkmcnt(2)
    v_smfmac_f32_16x16x64_bf16 v[24:27], v[44:47], v[56:63], v1
    ds_read_b128 v[52:55], v2 offset:9216
    v_lshlrev_b32 v11, 4, v0
    v_smfmac_f32_16x16x64_bf16 v[28:31], v[44:47], v[208:215], v1
    buffer_load_dword v11, s[4:7], s98 offen offset:0 sc1 lds
    s_waitcnt lgkmcnt(2)
    v_smfmac_f32_16x16x64_bf16 v[32:35], v[44:47], v[216:223], v1
    v_max3_u32 v56, v40, v41, v42
    v_max_u32 v56, v56, v43
    v_smfmac_f32_16x16x64_bf16 v[20:23], v[36:39], v[224:231], v1
    buffer_load_dword v11, s[4:7], s98 offen offset:128 sc1 lds
    v_cmp_eq_u32 vcc, -1, v56
    v_smfmac_f32_16x16x64_bf16 v[24:27], v[36:39], v[232:239], v1
    ds_read_b128 v[56:59], v0 offset:11264
    ds_read_b128 v[60:63], v0 offset:12288
    v_smfmac_f32_16x16x64_bf16 v[28:31], v[36:39], v[240:247], v1
    v_cndmask_b32 v11, 2.0, 0, s[20:21]
    s_waitcnt lgkmcnt(2)
    v_smfmac_f32_16x16x64_bf16 v[32:35], v[36:39], v[48:55], v1
    ds_read_b128 v[48:51], v0 offset:9216
    s_cbranch_vccnz L_s3r_26
L_s3ok_27:
    v_smfmac_f32_16x16x64_bf16 v[20:23], v[40:43], v[248:255], v1
    ds_read_b128 v[52:55], v0 offset:10240
    v_smfmac_f32_16x16x64_bf16 v[24:27], v[40:43], a[0:7], v1
    buffer_store_dword v1, v11, s[4:7], s17 offen sc1
    v_smfmac_f32_16x16x64_bf16 v[12:15], v[36:39], a[128:135], v1
    v_lshrrev_b32 v11, 2, v0
    s_add_u32 s17, s17, 4096
    v_smfmac_f32_16x16x64_bf16 v[16:19], v[36:39], a[136:143], v1
    ds_read_b128 v[36:39], v9 offset:4096
    s_cmp_eq_u32 s36, 64
    v_smfmac_f32_16x16x64_bf16 v[28:31], v[40:43], a[8:15], v1
    v_add_f32 v20, v20, v21
    v_smfmac_f32_16x16x64_bf16 v[32:35], v[40:43], a[16:23], v1
    s_cbranch_scc1 L_exit_16_l
    v_add_f32 v22, v22, v23
    v_add_f32 v24, v24, v25
    v_add_f32 v26, v26, v27
    v_cvt_pk_bf16_f32 v20, v20, v24
    v_cvt_pk_bf16_f32 v21, v22, v26
    ds_write2_b32 v3, v20, v21 offset0:8 offset1:12
    v_add_f32 v28, v28, v29
    v_add_f32 v30, v30, v31
    v_add_f32 v32, v32, v33
    v_add_f32 v34, v34, v35
    v_cvt_pk_bf16_f32 v28, v28, v32
    v_cvt_pk_bf16_f32 v29, v30, v34
    ds_write2_b32 v3, v28, v29 offset0:0 offset1:4
    v_smfmac_f32_16x16x64_bf16 v[16:19], v[40:43], a[152:159], v1
    buffer_store_dword v28, v11, s[4:7], s46 offen offset:0 sc1
    v_smfmac_f32_16x16x64_bf16 v[12:15], v[40:43], a[144:151], v1
    v_smfmac_f32_16x16x64_bf16 v[16:19], v[44:47], a[120:127], v1
    buffer_store_dword v29, v11, s[4:7], s46 offen offset:256 sc1
    v_smfmac_f32_16x16x64_bf16 v[12:15], v[44:47], a[112:119], v1
    s_waitcnt lgkmcnt(0)
    s_barrier
    ds_read_b128 v[20:23], v0 offset:17408
    ds_read_b128 v[24:27], v0 offset:18464
    ds_read_b128 v[28:31], v0 offset:19520
    ds_read_b128 v[32:35], v0 offset:20576
    v_smfmac_f32_16x16x64_bf16 v[12:15], v[36:39], a[104:111], v1
    s_waitcnt vmcnt(5)
    v_smfmac_f32_16x16x64_bf16 v[16:19], v[36:39], v[64:71], v1
    ds_read_b128 v[64:67], v0 offset:13312
    ds_read_b128 v[68:71], v0 offset:14336
    s_waitcnt lgkmcnt(5)
    v_mfma_f32_16x16x32_bf16 v[36:39], v[48:51], v[20:23], 0
    s_waitcnt lgkmcnt(4)
    v_mfma_f32_16x16x32_bf16 v[36:39], v[52:55], v[24:27], v[36:39]
    ds_read_b128 v[48:51], v0 offset:15360
    ds_read_b128 v[52:55], v0 offset:16384
    s_waitcnt lgkmcnt(4)
    v_mfma_f32_16x16x32_bf16 v[36:39], v[56:59], v[28:31], v[36:39]
    v_mfma_f32_16x16x32_bf16 v[36:39], v[60:63], v[32:35], v[36:39]
    ds_read_b128 v[56:59], v2 offset:26624
    ds_read_b128 v[60:63], v2 offset:27648
    v_mfma_f32_16x16x32_bf16 v[44:47], v[20:23], v[20:23], 0
    v_add_f32 v12, v12, v13
    v_add_f32 v14, v14, v15
    v_mfma_f32_16x16x32_bf16 v[44:47], v[24:27], v[24:27], v[44:47]
    v_cvt_pk_bf16_f32 v12, v12, v14
    v_mov_b32 v13, 0
    v_mfma_f32_16x16x32_bf16 v[44:47], v[28:31], v[28:31], v[44:47]
    v_add_f32 v16, v16, v17
    v_add_f32 v18, v18, v19
    v_mfma_f32_16x16x32_bf16 v[44:47], v[32:35], v[32:35], v[44:47]
    buffer_store_dword v12, v11, s[4:7], s46 offen offset:512 sc1
    v_cvt_pk_bf16_f32 v16, v16, v18
    v_mov_b32 v17, 0
    s_waitcnt lgkmcnt(4)
    v_mfma_f32_16x16x32_bf16 v[40:43], v[64:67], v[20:23], 0
    ds_read_b128 v[20:23], v2 offset:32768
    v_max3_f32 v14, v36, v37, v38
    v_mfma_f32_16x16x32_bf16 v[40:43], v[68:71], v[24:27], v[40:43]
    ds_read_b128 v[24:27], v2 offset:33792
    s_waitcnt lgkmcnt(4)
    v_mfma_f32_16x16x32_bf16 v[40:43], v[48:51], v[28:31], v[40:43]
    buffer_store_dword v16, v11, s[4:7], s46 offen offset:768 sc1
    v_max3_f32 v46, v14, v39, v44
    v_mfma_f32_16x16x32_bf16 v[40:43], v[52:55], v[32:35], v[40:43]
    ds_read_b128 v[48:51], v2 offset:20480
    ds_read_b128 v[52:55], v2 offset:21504
    s_nop 0
    s_add_u32 s46, s46, 131072
    v_max_f32 v46, v46, v45
    s_nop 0
    v_mov_b32 v28, 0x3f803f80
    v_mov_b32 v29, 0x3f803f80
    v_max3_f32 v46, v46, v40, v41
    v_max3_f32 v47, v46, v42, v43
    v_max3_f32 v46, v46, v42, v43
    v_mov_b32 v30, 0x3f803f80
    v_mov_b32 v31, 0x3f803f80
    v_permlane32_swap_b32 v46, v47
    v_max_f32 v46, v46, v47
    v_mov_b32 v47, v46
    s_nop 1
    v_permlane16_swap_b32 v46, v47
    v_max_f32 v46, v46, v47
    v_mul_f32 v46, s49, v46
    v_fma_f32 v44, v44, s49, -v46
    v_fma_f32 v45, v45, s49, -v46
    v_exp_f32 v44, v44
    v_exp_f32 v45, v45
    v_fma_f32 v36, v36, s49, -v46
    v_cvt_pk_bf16_f32 v44, v44, v45
    v_mov_b32 v45, 0
    v_fma_f32 v37, v37, s49, -v46
    v_fma_f32 v38, v38, s49, -v46
    v_mfma_f32_16x16x16_bf16 v[32:35], v[28:29], v[44:45], 0
    v_fma_f32 v39, v39, s49, -v46
    v_fma_f32 v40, v40, s49, -v46
    v_mfma_f32_16x16x16_bf16 v[64:67], v[12:13], v[44:45], 0
    v_fma_f32 v41, v41, s49, -v46
    v_fma_f32 v42, v42, s49, -v46
    v_mfma_f32_16x16x16_bf16 v[68:71], v[16:17], v[44:45], 0
    v_fma_f32 v43, v43, s49, -v46
    v_exp_f32 v36, v36
    v_exp_f32 v37, v37
    v_exp_f32 v38, v38
    v_exp_f32 v39, v39
    v_exp_f32 v40, v40
    v_exp_f32 v41, v41
    v_exp_f32 v42, v42
    v_exp_f32 v43, v43
    v_cvt_pk_bf16_f32 v36, v36, v37
    v_cvt_pk_bf16_f32 v37, v38, v39
    v_cvt_pk_bf16_f32 v38, v40, v41
    v_cvt_pk_bf16_f32 v39, v42, v43
    s_waitcnt lgkmcnt(2)
    v_mov_b64 v[44:45], 0
    v_mfma_f32_16x16x32_bf16 v[32:35], v[28:31], v[36:39], v[32:35]
    v_mfma_f32_16x16x32_bf16 v[64:67], v[20:23], v[36:39], v[64:67]
    v_mfma_f32_16x16x32_bf16 v[68:71], v[24:27], v[36:39], v[68:71]
    v_mov_b64 v[12:13], 0
    v_mov_b64 v[14:15], 0
    v_mov_b64 v[16:17], 0
    v_mov_b64 v[18:19], 0
    v_mov_b64 v[20:21], 0
    v_mov_b64 v[22:23], 0
    v_rcp_f32 v11, v32
    v_mov_b64 v[24:25], 0
    v_mul_f32 v64, v64, v11
    v_mul_f32 v65, v65, v11
    v_mul_f32 v66, v66, v11
    v_mul_f32 v67, v67, v11
    v_mul_f32 v68, v68, v11
    v_mul_f32 v69, v69, v11
    v_mul_f32 v70, v70, v11
    v_mul_f32 v71, v71, v11
    v_cvt_pk_bf16_f32 v40, v64, v65
    v_cvt_pk_bf16_f32 v41, v66, v67
    v_cvt_pk_bf16_f32 v42, v68, v69
    v_cvt_pk_bf16_f32 v43, v70, v71
    s_mov_b64 exec, s[26:27]
    ds_write_b128 v4, v[40:43]
    s_mov_b64 exec, -1
    v_mov_b64 v[36:37], -1
    v_cndmask_b32 v11, 0, 1, s[100:101]
    buffer_store_dwordx2 v[36:37], v6, s[4:7], s44 offen
    v_mov_b64 v[26:27], 0
    v_mov_b64 v[28:29], 0
    v_mov_b64 v[30:31], 0
    v_mov_b64 v[32:33], 0
    v_mov_b64 v[34:35], 0
    s_waitcnt lgkmcnt(0)
    s_barrier
    ds_read_b128 v[64:67], v0 offset:21632
    ds_read_b128 v[68:71], v0 offset:22656
    v_mov_b64 v[36:37], 0
    v_mov_b64 v[38:39], 0
    v_mov_b64 v[40:41], 0
    v_mov_b64 v[42:43], 0
    v_mov_b64 v[46:47], 0
    s_waitcnt lgkmcnt(1)
    v_smfmac_f32_16x16x64_bf16 v[12:15], v[64:67], v[48:55], v1
    ds_read_b128 v[48:51], v2 offset:22528
    s_waitcnt lgkmcnt(1)
    v_smfmac_f32_16x16x64_bf16 v[12:15], v[68:71], v[56:63], v1
    ds_read_b128 v[52:55], v2 offset:23552
    s_add_u32 s98, s98, 524288
    v_smfmac_f32_16x16x64_bf16 v[16:19], v[64:67], a[160:167], v1
    ds_read_b128 v[56:59], v2 offset:28672
    s_add_u32 s45, s45, 524288
    v_smfmac_f32_16x16x64_bf16 v[16:19], v[68:71], a[168:175], v1
    ds_read_b128 v[60:63], v2 offset:29696
    s_add_u32 s97, s97, 524288
    v_add_f32 v13, v12, v13
    v_add_f32 v15, v14, v15
    v_smfmac_f32_16x16x64_bf16 v[20:23], v[64:67], a[176:183], v1
    s_cmp_ge_u32 s35, 32
    v_cvt_pk_bf16_f32 v12, v13, v15
    v_bfi_b32 v12, v11, s47, v12
    v_smfmac_f32_16x16x64_bf16 v[20:23], v[68:71], a[184:191], v1
    buffer_store_dword v12, v5, s[4:7], s8 offen
    v_add_f32 v17, v16, v17
    v_add_f32 v19, v18, v19
    v_smfmac_f32_16x16x64_bf16 v[24:27], v[64:67], a[192:199], v1
    v_cvt_pk_bf16_f32 v16, v17, v19
    v_bfi_b32 v16, v11, s47, v16
    v_smfmac_f32_16x16x64_bf16 v[24:27], v[68:71], a[200:207], v1
    buffer_store_dword v16, v5, s[4:7], s9 offen
    v_add_f32 v21, v20, v21
    v_add_f32 v23, v22, v23
    s_waitcnt lgkmcnt(0)
    v_smfmac_f32_16x16x64_bf16 v[28:31], v[64:67], v[48:55], v1
    v_cvt_pk_bf16_f32 v20, v21, v23
    v_bfi_b32 v20, v11, s47, v20
    v_smfmac_f32_16x16x64_bf16 v[28:31], v[68:71], v[56:63], v1
    buffer_store_dword v20, v5, s[4:7], s10 offen
    v_add_f32 v25, v24, v25
    v_add_f32 v27, v26, v27
    v_smfmac_f32_16x16x64_bf16 v[32:35], v[64:67], a[208:215], v1
    ds_read_b128 v[48:51], v2 offset:24576
    v_cvt_pk_bf16_f32 v24, v25, v27
    v_bfi_b32 v24, v11, s47, v24
    v_smfmac_f32_16x16x64_bf16 v[32:35], v[68:71], a[216:223], v1
    buffer_store_dword v24, v5, s[4:7], s11 offen
    ds_read_b128 v[52:55], v2 offset:25600
    v_add_f32 v29, v28, v29
    v_add_f32 v31, v30, v31
    v_smfmac_f32_16x16x64_bf16 v[36:39], v[64:67], a[224:231], v1
    ds_read_b128 v[56:59], v2 offset:30720
    v_cvt_pk_bf16_f32 v28, v29, v31
    v_bfi_b32 v28, v11, s47, v28
    v_smfmac_f32_16x16x64_bf16 v[36:39], v[68:71], a[232:239], v1
    buffer_store_dword v28, v5, s[4:7], s12 offen
    ds_read_b128 v[60:63], v2 offset:31744
    v_add_f32 v33, v32, v33
    v_add_f32 v35, v34, v35
    v_smfmac_f32_16x16x64_bf16 v[40:43], v[64:67], a[240:247], v1
    v_cvt_pk_bf16_f32 v32, v33, v35
    v_bfi_b32 v32, v11, s47, v32
    v_smfmac_f32_16x16x64_bf16 v[40:43], v[68:71], a[248:255], v1
    buffer_store_dword v32, v5, s[4:7], s13 offen
    v_add_f32 v37, v36, v37
    v_add_f32 v39, v38, v39
    s_waitcnt lgkmcnt(0)
    v_smfmac_f32_16x16x64_bf16 v[44:47], v[64:67], v[48:55], v1
    v_cvt_pk_bf16_f32 v36, v37, v39
    v_bfi_b32 v36, v11, s47, v36
    v_smfmac_f32_16x16x64_bf16 v[44:47], v[68:71], v[56:63], v1
    buffer_store_dword v36, v5, s[4:7], s14 offen
    v_add_f32 v41, v40, v41
    v_add_f32 v43, v42, v43
    v_cvt_pk_bf16_f32 v40, v41, v43
    v_bfi_b32 v40, v11, s47, v40
    buffer_store_dword v40, v5, s[4:7], s15 offen
    s_nop 1
    v_add_f32 v45, v44, v45
    v_add_f32 v47, v46, v47
    v_cvt_pk_bf16_f32 v44, v45, v47
    v_bfi_b32 v44, v11, s47, v44
    buffer_store_dword v44, v5, s[4:7], s16 offen
    s_cbranch_scc1 L_nored_18
L_go1_29:
    buffer_load_dwordx4 v[12:15], v0, s[4:7], s41 offen offset:0 sc1
    buffer_load_dwordx4 v[16:19], v0, s[4:7], s41 offen offset:1024 sc1
    buffer_load_dwordx4 v[20:23], v0, s[4:7], s41 offen offset:2048 sc1
    buffer_load_dwordx4 v[24:27], v0, s[4:7], s41 offen offset:3072 sc1
    v_cndmask_b32 v32, 0, v7, s[52:53]
    v_cndmask_b32 v33, 0, v7, s[54:55]
    v_cndmask_b32 v34, 0, v7, s[56:57]
    v_cndmask_b32 v35, 0, v7, s[58:59]
    s_mov_b32 s60, s42
    s_mov_b32 s42, s43
    s_mov_b32 s43, s44
    s_mov_b32 s44, s60
    s_add_u32 s39, s42, 4096
    s_add_u32 s40, s42, 8192
    s_mov_b32 m0, s18
    v_mov_b64 v[36:37], -1
    v_mov_b64 v[38:39], -1
    v_mov_b64 v[40:41], -1
    v_mov_b64 v[42:43], -1
    v_mov_b32 v46, 18432
    v_mov_b32 v47, s36
    buffer_load_dwordx4 v[48:51], v0, s[4:7], s41 offen offset:0 sc1
    buffer_load_dwordx4 v[52:55], v0, s[4:7], s41 offen offset:1024 sc1
    buffer_load_dwordx4 v[56:59], v0, s[4:7], s41 offen offset:2048 sc1
    buffer_load_dwordx4 v[60:63], v0, s[4:7], s41 offen offset:3072 sc1
L_p1a_22:
    s_waitcnt vmcnt(7)
    v_mfma_f32_16x16x32_bf16 v[28:31], v[32:35], v[12:15], 0
    s_waitcnt vmcnt(6)
    v_mfma_f32_16x16x32_bf16 v[28:31], v[32:35], v[16:19], v[28:31]
    v_bitop3_b32 v11, v12, v16, s47 bitop3:0x7e
    s_waitcnt vmcnt(5)
    v_mfma_f32_16x16x32_bf16 v[28:31], v[32:35], v[20:23], v[28:31]
    s_waitcnt vmcnt(4)
    v_mfma_f32_16x16x32_bf16 v[28:31], v[32:35], v[24:27], v[28:31]
    v_bitop3_b32 v45, v20, v24, s47 bitop3:0x7e
    v_bitop3_b32 v11, v11, v45, 1 bitop3:0xa8
    v_cmp_ne_u32 vcc, 0, v11
    s_nop 4
    v_add_f32_dpp v28, v28, v28 row_ror:8 row_mask:0xf bank_mask:0xf
    v_add_f32_dpp v29, v29, v29 row_ror:8 row_mask:0xf bank_mask:0xf
    v_add_f32_dpp v30, v30, v30 row_ror:8 row_mask:0xf bank_mask:0xf
    v_add_f32_dpp v31, v31, v31 row_ror:8 row_mask:0xf bank_mask:0xf
    v_cvt_pk_bf16_f32 v44, v28, v29
    v_cvt_pk_bf16_f32 v45, v30, v31
    s_cbranch_vccnz L_p1b_35
L_ok1_17:
    buffer_store_dwordx2 v[44:45], v6, s[4:7], s42 offen
    ds_write_b32 v46, v47
L_b4_19:
    buffer_load_dwordx4 v[36:39], v8, s[4:7], s42 offen sc1
    buffer_load_dwordx4 v[40:43], v9, s[4:7], s42 offen sc1
    s_waitcnt vmcnt(3)
    ds_read_b128 v[48:51], v2 offset:0
    ds_read_b128 v[52:55], v2 offset:1024
    ds_read_b128 v[56:59], v2 offset:10240
    ds_read_b128 v[60:63], v2 offset:11264
    ds_read_b128 v[64:67], v2 offset:18432
    ds_read_b128 v[68:71], v2 offset:19456
    v_mov_b64 v[12:13], 0
    v_mov_b64 v[14:15], 0
    v_mov_b64 v[16:17], 0
    v_mov_b64 v[18:19], 0
    v_mov_b64 v[20:21], 0
    v_mov_b64 v[22:23], 0
    v_mov_b64 v[24:25], 0
    v_mov_b64 v[26:27], 0
    v_mov_b64 v[28:29], 0
    v_mov_b64 v[30:31], 0
    v_mov_b64 v[32:33], 0
    v_mov_b64 v[34:35], 0
    s_xor_b32 s47, s47, 1
    s_waitcnt lgkmcnt(0)
    s_branch L_s1w_21
L_p1b_35:
    buffer_load_dwordx4 v[12:15], v0, s[4:7], s41 offen offset:0 sc1
    buffer_load_dwordx4 v[16:19], v0, s[4:7], s41 offen offset:1024 sc1
    buffer_load_dwordx4 v[20:23], v0, s[4:7], s41 offen offset:2048 sc1
    buffer_load_dwordx4 v[24:27], v0, s[4:7], s41 offen offset:3072 sc1
    s_waitcnt vmcnt(7)
    v_mfma_f32_16x16x32_bf16 v[28:31], v[32:35], v[48:51], 0
    s_waitcnt vmcnt(6)
    v_mfma_f32_16x16x32_bf16 v[28:31], v[32:35], v[52:55], v[28:31]
    v_bitop3_b32 v11, v48, v52, s47 bitop3:0x7e
    s_waitcnt vmcnt(5)
    v_mfma_f32_16x16x32_bf16 v[28:31], v[32:35], v[56:59], v[28:31]
    s_waitcnt vmcnt(4)
    v_mfma_f32_16x16x32_bf16 v[28:31], v[32:35], v[60:63], v[28:31]
    v_bitop3_b32 v45, v56, v60, s47 bitop3:0x7e
    v_bitop3_b32 v11, v11, v45, 1 bitop3:0xa8
    v_cmp_ne_u32 vcc, 0, v11
    s_nop 4
    v_add_f32_dpp v28, v28, v28 row_ror:8 row_mask:0xf bank_mask:0xf
    v_add_f32_dpp v29, v29, v29 row_ror:8 row_mask:0xf bank_mask:0xf
    v_add_f32_dpp v30, v30, v30 row_ror:8 row_mask:0xf bank_mask:0xf
    v_add_f32_dpp v31, v31, v31 row_ror:8 row_mask:0xf bank_mask:0xf
    v_cvt_pk_bf16_f32 v44, v28, v29
    v_cvt_pk_bf16_f32 v45, v30, v31
    s_cbranch_vccz L_ok1_17
    buffer_load_dwordx4 v[48:51], v0, s[4:7], s41 offen offset:0 sc1
    buffer_load_dwordx4 v[52:55], v0, s[4:7], s41 offen offset:1024 sc1
    buffer_load_dwordx4 v[56:59], v0, s[4:7], s41 offen offset:2048 sc1
    buffer_load_dwordx4 v[60:63], v0, s[4:7], s41 offen offset:3072 sc1
    s_sub_u32 s37, s37, 1
    s_cbranch_scc0 L_p1a_22
    s_mov_b32 s37, 0
    s_branch L_ok1_17
L_s1r_23_give:
    s_mov_b32 s37, 0
    s_branch L_entry_15
L_exit_16_l:
    v_smfmac_f32_16x16x64_bf16 v[12:15], v[40:43], a[144:151], v1
    v_smfmac_f32_16x16x64_bf16 v[16:19], v[40:43], a[152:159], v1
    v_smfmac_f32_16x16x64_bf16 v[12:15], v[44:47], a[112:119], v1
    v_smfmac_f32_16x16x64_bf16 v[16:19], v[44:47], a[120:127], v1
    s_waitcnt lgkmcnt(0)
    s_waitcnt vmcnt(3)
    v_smfmac_f32_16x16x64_bf16 v[12:15], v[36:39], a[104:111], v1
    v_smfmac_f32_16x16x64_bf16 v[16:19], v[36:39], v[64:71], v1
    v_add_f32 v28, v28, v29
    v_add_f32 v30, v30, v31
    v_add_f32 v32, v32, v33
    v_add_f32 v34, v34, v35
    v_cvt_pk_bf16_f32 v28, v28, v32
    v_cvt_pk_bf16_f32 v29, v30, v34
    buffer_store_dword v28, v11, s[4:7], s46 offen offset:0 sc1
    buffer_store_dword v29, v11, s[4:7], s46 offen offset:256 sc1
    v_add_f32 v12, v12, v13
    v_add_f32 v14, v14, v15
    v_cvt_pk_bf16_f32 v12, v12, v14
    v_mov_b32 v13, 0
    buffer_store_dword v12, v11, s[4:7], s46 offen offset:512 sc1
    v_add_f32 v16, v16, v17
    v_add_f32 v18, v18, v19
    v_cvt_pk_bf16_f32 v16, v16, v18
    v_mov_b32 v17, 0
    buffer_store_dword v16, v11, s[4:7], s46 offen offset:768 sc1
L_exit_16:
    s_waitcnt vmcnt(0)
    s_endpgm
L_slow_14:
    s_branch L_s1_41
L_kvrf_51:
L_kvr_53:
    v_lshrrev_b32 v11, 2, v0
    buffer_load_dword v11, v11, s[4:7], s19 offen sc1
    s_waitcnt vmcnt(0)
    v_cmp_ne_u32 s[22:23], 0, v11
    s_nop 3
    s_bitcmp1_b64 s[22:23], s36
    s_cbranch_scc1 L_kvok_52
    s_sub_u32 s37, s37, 1
    s_cbranch_scc0 L_kvr_53
    s_mov_b32 s37, 0
    s_branch L_kvok_52
L_nored_39:
    s_cmp_eq_u32 s35, -1
    s_cbranch_scc1 L_nored_39_n
    s_waitcnt vmcnt(2)
    s_branch L_go1_50
L_nored_39_n:
    s_mov_b32 s60, s42
    s_mov_b32 s42, s43
    s_mov_b32 s43, s44
    s_mov_b32 s44, s60
    s_add_u32 s39, s42, 4096
    s_add_u32 s40, s42, 8192
    s_mov_b32 m0, s18
    v_mov_b64 v[36:37], -1
    v_mov_b64 v[38:39], -1
    v_mov_b64 v[40:41], -1
    v_mov_b64 v[42:43], -1
    s_add_u32 s61, s36, 1
    s_bitcmp1_b64 s[22:23], s61
    s_cbranch_scc1 L_full_54
    v_lshrrev_b32 v11, 2, v0
    buffer_load_dword v11, v11, s[4:7], s19 offen sc1
    s_waitcnt vmcnt(0)
    v_cmp_ne_u32 s[22:23], 0, v11
L_full_54:
    v_mov_b32 v46, 18432
L_flag_55:
    ds_read_b32 v11, v46
    s_waitcnt lgkmcnt(0)
    v_cmp_eq_u32 vcc, s36, v11
    s_cbranch_vccnz L_b4_40
    s_sub_u32 s37, s37, 1
    s_cbranch_scc0 L_flag_55
    s_mov_b32 s37, 0
    s_branch L_b4_40
    s_branch L_b4_40
L_s2r_45:
    buffer_load_dwordx4 v[64:67], v8, s[4:7], s39 offen sc1
    s_waitcnt vmcnt(1)
    v_max3_u32 v11, v64, v65, v66
    v_max_u32 v11, v11, v67
    v_cmp_eq_u32 vcc, -1, v11
    s_cbranch_vccz L_s2r_45_d
    s_sub_u32 s37, s37, 1
    s_cbranch_scc0 L_s2r_45
    s_mov_b32 s37, 0
    s_branch L_s2r_45_d
L_s2r_45_d:
    s_waitcnt vmcnt(0)
    s_branch L_s2ok_46
L_s3r_47:
    buffer_load_dwordx4 v[40:43], v0, s[4:7], s40 offen sc1
    s_waitcnt vmcnt(0)
    v_max3_u32 v52, v40, v41, v42
    v_max_u32 v52, v52, v43
    v_cmp_eq_u32 vcc, -1, v52
    s_cbranch_vccz L_s3ok_48
    s_sub_u32 s37, s37, 1
    s_cbranch_scc0 L_s3r_47
    s_mov_b32 s37, 0
    s_branch L_s3ok_48
L_s1_41:
    s_add_u32 s39, s42, 4096
    s_add_u32 s40, s42, 8192
    s_mov_b32 m0, s18
    buffer_load_dwordx4 v[36:39], v8, s[4:7], s42 offen sc1
    buffer_load_dwordx4 v[40:43], v9, s[4:7], s42 offen sc1
    s_waitcnt vmcnt(0)
    s_branch L_s1w_42
    .p2align 6
L_s1r_44:
    s_mov_b64 exec, vcc
    buffer_load_dwordx4 v[36:39], v8, s[4:7], s42 offen sc1
    buffer_load_dwordx4 v[40:43], v9, s[4:7], s42 offen sc1
    s_mov_b64 exec, -1
    s_sub_u32 s37, s37, 1
    s_cbranch_scc1 L_s1r_44_give
    s_waitcnt vmcnt(2)
L_s1w_42:
    v_max3_u32 v11, v36, v37, v38
    v_max3_u32 v11, v11, v39, v40
    v_max3_u32 v11, v11, v41, v42
    v_max_u32 v11, v11, v43
    v_cmp_eq_u32 vcc, -1, v11
    s_cbranch_vccnz L_s1r_44
L_entry_36:
    ds_write_b128 v8, v[36:39] offset:0
    v_smfmac_f32_16x16x64_bf16 v[20:23], v[36:39], v[64:71], v1
    buffer_load_dwordx4 v[64:67], v8, s[4:7], s39 offen sc1
    v_smfmac_f32_16x16x64_bf16 v[24:27], v[36:39], v[48:55], v1
    v_lshrrev_b32 v69, 2, v8
    v_smfmac_f32_16x16x64_bf16 v[28:31], v[36:39], v[56:63], v1
    ds_read_b128 v[56:59], v2 offset:12288
    v_smfmac_f32_16x16x64_bf16 v[32:35], v[36:39], v[72:79], v1
    ds_read_b128 v[48:51], v2 offset:2048
    v_smfmac_f32_16x16x64_bf16 v[12:15], v[36:39], a[24:31], v1
    ds_read_b128 v[52:55], v2 offset:3072
    s_waitcnt lgkmcnt(3)
    v_smfmac_f32_16x16x64_bf16 v[16:19], v[36:39], a[32:39], v1
    s_barrier
    ds_read_b128 v[44:47], v10 offset:0
    v_smfmac_f32_16x16x64_bf16 v[20:23], v[40:43], v[80:87], v1
    buffer_load_dword v69, s[4:7], s40 offen sc1 lds
    s_mov_b32 m0, s51
    v_smfmac_f32_16x16x64_bf16 v[24:27], v[40:43], v[88:95], v1
    ds_read_b128 v[60:63], v2 offset:13312
    v_smfmac_f32_16x16x64_bf16 v[28:31], v[40:43], v[96:103], v1
    buffer_load_dwordx4 v0, s[4:7], s45 offen sc1 lds
    v_smfmac_f32_16x16x64_bf16 v[32:35], v[40:43], v[104:111], v1
    s_add_u32 s36, s36, 1
    v_smfmac_f32_16x16x64_bf16 v[12:15], v[40:43], a[40:47], v1
    buffer_load_dwordx4 v0, s[4:7], s45 offen offset:1024 sc1 lds
    v_smfmac_f32_16x16x64_bf16 v[16:19], v[40:43], a[48:55], v1
    s_waitcnt vmcnt(4)
    ds_read_b128 v[36:39], v10 offset:1024
    s_waitcnt lgkmcnt(1)
    v_smfmac_f32_16x16x64_bf16 v[20:23], v[44:47], v[48:55], v1
    ds_read_b128 v[48:51], v2 offset:4096
    v_smfmac_f32_16x16x64_bf16 v[24:27], v[44:47], v[56:63], v1
    ds_read_b128 v[52:55], v2 offset:5120
    v_smfmac_f32_16x16x64_bf16 v[28:31], v[44:47], v[112:119], v1
    ds_read_b128 v[56:59], v2 offset:14336
    v_smfmac_f32_16x16x64_bf16 v[32:35], v[44:47], v[120:127], v1
    ds_read_b128 v[60:63], v2 offset:15360
    v_smfmac_f32_16x16x64_bf16 v[12:15], v[44:47], a[56:63], v1
    s_mov_b32 m0, s50
    v_smfmac_f32_16x16x64_bf16 v[16:19], v[44:47], a[64:71], v1
    s_waitcnt lgkmcnt(4)
    v_smfmac_f32_16x16x64_bf16 v[20:23], v[36:39], v[128:135], v1
    s_waitcnt vmcnt(3)
    v_max3_u32 v11, v64, v65, v66
    v_max_u32 v11, v11, v67
    v_cmp_eq_u32 vcc, -1, v11
    v_smfmac_f32_16x16x64_bf16 v[24:27], v[36:39], v[136:143], v1
    v_smfmac_f32_16x16x64_bf16 v[28:31], v[36:39], v[144:151], v1
    s_cbranch_vccnz L_s2r_45
L_s2ok_46:
    ds_write_b128 v8, v[64:67] offset:4096
    v_smfmac_f32_16x16x64_bf16 v[32:35], v[36:39], v[152:159], v1
    v_smfmac_f32_16x16x64_bf16 v[12:15], v[36:39], a[72:79], v1
    buffer_load_dwordx4 v0, s[4:7], s97 offen sc1 lds
    v_smfmac_f32_16x16x64_bf16 v[16:19], v[36:39], a[80:87], v1
    buffer_load_dwordx4 v0, s[4:7], s97 offen offset:1024 sc1 lds
    s_waitcnt lgkmcnt(1)
    v_smfmac_f32_16x16x64_bf16 v[20:23], v[64:67], v[48:55], v1
    ds_read_b128 v[48:51], v2 offset:6144
    v_smfmac_f32_16x16x64_bf16 v[24:27], v[64:67], v[56:63], v1
    s_waitcnt vmcnt(2) lgkmcnt(1)
    s_barrier
    ds_read_b128 v[40:43], v9 offset:4096
    v_smfmac_f32_16x16x64_bf16 v[28:31], v[64:67], v[160:167], v1
    ds_read_b128 v[44:47], v10 offset:4096
    v_smfmac_f32_16x16x64_bf16 v[32:35], v[64:67], v[168:175], v1
    ds_read_b128 v[36:39], v10 offset:5120
    v_smfmac_f32_16x16x64_bf16 v[12:15], v[64:67], a[88:95], v1
    ds_read_b128 v[52:55], v2 offset:7168
    v_smfmac_f32_16x16x64_bf16 v[16:19], v[64:67], a[96:103], v1
    ds_read_b128 v[56:59], v2 offset:16384
    s_waitcnt lgkmcnt(4)
    v_smfmac_f32_16x16x64_bf16 v[20:23], v[40:43], v[176:183], v1
    buffer_load_dwordx4 v[64:67], v0, s[4:7], s96 offen offset:0
    v_smfmac_f32_16x16x64_bf16 v[24:27], v[40:43], v[184:191], v1
    buffer_load_dwordx4 v[68:71], v0, s[4:7], s96 offen offset:1024
    s_bitcmp1_b64 s[22:23], s36
    v_smfmac_f32_16x16x64_bf16 v[28:31], v[40:43], v[192:199], v1
    ds_read_b128 v[60:63], v2 offset:17408
    v_smfmac_f32_16x16x64_bf16 v[32:35], v[40:43], v[200:207], v1
    ds_read_b128 v[40:43], v0 offset:8192
    s_mov_b32 m0, 24192
    s_cbranch_scc0 L_kvrf_51
L_kvok_52:
    s_waitcnt lgkmcnt(3)
    v_smfmac_f32_16x16x64_bf16 v[20:23], v[44:47], v[48:55], v1
    ds_read_b128 v[48:51], v2 offset:8192
    s_waitcnt lgkmcnt(2)
    v_smfmac_f32_16x16x64_bf16 v[24:27], v[44:47], v[56:63], v1
    ds_read_b128 v[52:55], v2 offset:9216
    v_lshlrev_b32 v11, 4, v0
    v_smfmac_f32_16x16x64_bf16 v[28:31], v[44:47], v[208:215], v1
    buffer_load_dword v11, s[4:7], s98 offen offset:0 sc1 lds
    s_waitcnt lgkmcnt(2)
    v_smfmac_f32_16x16x64_bf16 v[32:35], v[44:47], v[216:223], v1
    v_max3_u32 v56, v40, v41, v42
    v_max_u32 v56, v56, v43
    v_smfmac_f32_16x16x64_bf16 v[20:23], v[36:39], v[224:231], v1
    buffer_load_dword v11, s[4:7], s98 offen offset:128 sc1 lds
    v_cmp_eq_u32 vcc, -1, v56
    v_smfmac_f32_16x16x64_bf16 v[24:27], v[36:39], v[232:239], v1
    ds_read_b128 v[56:59], v0 offset:11264
    ds_read_b128 v[60:63], v0 offset:12288
    v_smfmac_f32_16x16x64_bf16 v[28:31], v[36:39], v[240:247], v1
    v_cndmask_b32 v11, 2.0, 0, s[20:21]
    s_waitcnt lgkmcnt(2)
    v_smfmac_f32_16x16x64_bf16 v[32:35], v[36:39], v[48:55], v1
    ds_read_b128 v[48:51], v0 offset:9216
    s_cbranch_vccnz L_s3r_47
L_s3ok_48:
    v_smfmac_f32_16x16x64_bf16 v[20:23], v[40:43], v[248:255], v1
    ds_read_b128 v[52:55], v0 offset:10240
    v_smfmac_f32_16x16x64_bf16 v[24:27], v[40:43], a[0:7], v1
    buffer_store_dword v1, v11, s[4:7], s17 offen sc1
    v_smfmac_f32_16x16x64_bf16 v[12:15], v[36:39], a[128:135], v1
    v_lshrrev_b32 v11, 2, v0
    s_add_u32 s17, s17, 4096
    v_smfmac_f32_16x16x64_bf16 v[16:19], v[36:39], a[136:143], v1
    ds_read_b128 v[36:39], v9 offset:4096
    s_cmp_eq_u32 s36, 64
    v_smfmac_f32_16x16x64_bf16 v[28:31], v[40:43], a[8:15], v1
    v_add_f32 v20, v20, v21
    v_smfmac_f32_16x16x64_bf16 v[32:35], v[40:43], a[16:23], v1
    s_cbranch_scc1 L_exit_37_l
    v_add_f32 v22, v22, v23
    v_add_f32 v24, v24, v25
    v_add_f32 v26, v26, v27
    v_cvt_pk_bf16_f32 v20, v20, v24
    v_cvt_pk_bf16_f32 v21, v22, v26
    ds_write2_b32 v3, v20, v21 offset0:8 offset1:12
    v_add_f32 v28, v28, v29
    v_add_f32 v30, v30, v31
    v_add_f32 v32, v32, v33
    v_add_f32 v34, v34, v35
    v_cvt_pk_bf16_f32 v28, v28, v32
    v_cvt_pk_bf16_f32 v29, v30, v34
    ds_write2_b32 v3, v28, v29 offset0:0 offset1:4
    v_smfmac_f32_16x16x64_bf16 v[16:19], v[40:43], a[152:159], v1
    buffer_store_dword v28, v11, s[4:7], s46 offen offset:0 sc1
    v_smfmac_f32_16x16x64_bf16 v[12:15], v[40:43], a[144:151], v1
    v_smfmac_f32_16x16x64_bf16 v[16:19], v[44:47], a[120:127], v1
    buffer_store_dword v29, v11, s[4:7], s46 offen offset:256 sc1
    v_smfmac_f32_16x16x64_bf16 v[12:15], v[44:47], a[112:119], v1
    s_waitcnt lgkmcnt(0)
    s_barrier
    ds_read_b128 v[20:23], v0 offset:17408
    ds_read_b128 v[24:27], v0 offset:18464
    ds_read_b128 v[28:31], v0 offset:19520
    ds_read_b128 v[32:35], v0 offset:20576
    v_smfmac_f32_16x16x64_bf16 v[12:15], v[36:39], a[104:111], v1
    s_waitcnt vmcnt(5)
    v_smfmac_f32_16x16x64_bf16 v[16:19], v[36:39], v[64:71], v1
    ds_read_b128 v[64:67], v0 offset:13312
    ds_read_b128 v[68:71], v0 offset:14336
    s_waitcnt lgkmcnt(5)
    v_mfma_f32_16x16x32_bf16 v[36:39], v[48:51], v[20:23], 0
    s_waitcnt lgkmcnt(4)
    v_mfma_f32_16x16x32_bf16 v[36:39], v[52:55], v[24:27], v[36:39]
    ds_read_b128 v[48:51], v0 offset:15360
    ds_read_b128 v[52:55], v0 offset:16384
    s_waitcnt lgkmcnt(4)
    v_mfma_f32_16x16x32_bf16 v[36:39], v[56:59], v[28:31], v[36:39]
    v_mfma_f32_16x16x32_bf16 v[36:39], v[60:63], v[32:35], v[36:39]
    ds_read_b128 v[56:59], v2 offset:26624
    ds_read_b128 v[60:63], v2 offset:27648
    v_mfma_f32_16x16x32_bf16 v[44:47], v[20:23], v[20:23], 0
    v_add_f32 v12, v12, v13
    v_add_f32 v14, v14, v15
    v_mfma_f32_16x16x32_bf16 v[44:47], v[24:27], v[24:27], v[44:47]
    v_cvt_pk_bf16_f32 v12, v12, v14
    v_mov_b32 v13, 0
    v_mfma_f32_16x16x32_bf16 v[44:47], v[28:31], v[28:31], v[44:47]
    v_add_f32 v16, v16, v17
    v_add_f32 v18, v18, v19
    v_mfma_f32_16x16x32_bf16 v[44:47], v[32:35], v[32:35], v[44:47]
    buffer_store_dword v12, v11, s[4:7], s46 offen offset:512 sc1
    v_cvt_pk_bf16_f32 v16, v16, v18
    v_mov_b32 v17, 0
    s_waitcnt lgkmcnt(4)
    v_mfma_f32_16x16x32_bf16 v[40:43], v[64:67], v[20:23], 0
    ds_read_b128 v[20:23], v2 offset:32768
    v_max3_f32 v14, v36, v37, v38
    v_mfma_f32_16x16x32_bf16 v[40:43], v[68:71], v[24:27], v[40:43]
    ds_read_b128 v[24:27], v2 offset:33792
    s_waitcnt lgkmcnt(4)
    v_mfma_f32_16x16x32_bf16 v[40:43], v[48:51], v[28:31], v[40:43]
    buffer_store_dword v16, v11, s[4:7], s46 offen offset:768 sc1
    v_max3_f32 v46, v14, v39, v44
    v_mfma_f32_16x16x32_bf16 v[40:43], v[52:55], v[32:35], v[40:43]
    ds_read_b128 v[48:51], v2 offset:20480
    ds_read_b128 v[52:55], v2 offset:21504
    s_nop 0
    s_add_u32 s46, s46, 131072
    v_max_f32 v46, v46, v45
    s_nop 0
    v_mov_b32 v28, 0x3f803f80
    v_mov_b32 v29, 0x3f803f80
    v_max3_f32 v46, v46, v40, v41
    v_max3_f32 v47, v46, v42, v43
    v_max3_f32 v46, v46, v42, v43
    v_mov_b32 v30, 0x3f803f80
    v_mov_b32 v31, 0x3f803f80
    v_permlane32_swap_b32 v46, v47
    v_max_f32 v46, v46, v47
    v_mov_b32 v47, v46
    s_nop 1
    v_permlane16_swap_b32 v46, v47
    v_max_f32 v46, v46, v47
    v_mul_f32 v46, s49, v46
    v_fma_f32 v44, v44, s49, -v46
    v_fma_f32 v45, v45, s49, -v46
    v_exp_f32 v44, v44
    v_exp_f32 v45, v45
    v_fma_f32 v36, v36, s49, -v46
    v_cvt_pk_bf16_f32 v44, v44, v45
    v_mov_b32 v45, 0
    v_fma_f32 v37, v37, s49, -v46
    v_fma_f32 v38, v38, s49, -v46
    v_mfma_f32_16x16x16_bf16 v[32:35], v[28:29], v[44:45], 0
    v_fma_f32 v39, v39, s49, -v46
    v_fma_f32 v40, v40, s49, -v46
    v_mfma_f32_16x16x16_bf16 v[64:67], v[12:13], v[44:45], 0
    v_fma_f32 v41, v41, s49, -v46
    v_fma_f32 v42, v42, s49, -v46
    v_mfma_f32_16x16x16_bf16 v[68:71], v[16:17], v[44:45], 0
    v_fma_f32 v43, v43, s49, -v46
    v_exp_f32 v36, v36
    v_exp_f32 v37, v37
    v_exp_f32 v38, v38
    v_exp_f32 v39, v39
    v_exp_f32 v40, v40
    v_exp_f32 v41, v41
    v_exp_f32 v42, v42
    v_exp_f32 v43, v43
    v_cvt_pk_bf16_f32 v36, v36, v37
    v_cvt_pk_bf16_f32 v37, v38, v39
    v_cvt_pk_bf16_f32 v38, v40, v41
    v_cvt_pk_bf16_f32 v39, v42, v43
    s_waitcnt lgkmcnt(2)
    v_mov_b64 v[44:45], 0
    v_mfma_f32_16x16x32_bf16 v[32:35], v[28:31], v[36:39], v[32:35]
    v_mfma_f32_16x16x32_bf16 v[64:67], v[20:23], v[36:39], v[64:67]
    v_mfma_f32_16x16x32_bf16 v[68:71], v[24:27], v[36:39], v[68:71]
    v_mov_b64 v[12:13], 0
    v_mov_b64 v[14:15], 0
    v_mov_b64 v[16:17], 0
    v_mov_b64 v[18:19], 0
    v_mov_b64 v[20:21], 0
    v_mov_b64 v[22:23], 0
    v_rcp_f32 v11, v32
    v_mov_b64 v[24:25], 0
    v_mul_f32 v64, v64, v11
    v_mul_f32 v65, v65, v11
    v_mul_f32 v66, v66, v11
    v_mul_f32 v67, v67, v11
    v_mul_f32 v68, v68, v11
    v_mul_f32 v69, v69, v11
    v_mul_f32 v70, v70, v11
    v_mul_f32 v71, v71, v11
    v_cvt_pk_bf16_f32 v40, v64, v65
    v_cvt_pk_bf16_f32 v41, v66, v67
    v_cvt_pk_bf16_f32 v42, v68, v69
    v_cvt_pk_bf16_f32 v43, v70, v71
    s_mov_b64 exec, s[26:27]
    ds_write_b128 v4, v[40:43]
    s_mov_b64 exec, -1
    v_mov_b64 v[36:37], -1
    v_cndmask_b32 v11, 0, 1, s[100:101]
    buffer_store_dwordx2 v[36:37], v6, s[4:7], s44 offen sc1
    v_mov_b64 v[26:27], 0
    v_mov_b64 v[28:29], 0
    v_mov_b64 v[30:31], 0
    v_mov_b64 v[32:33], 0
    v_mov_b64 v[34:35], 0
    s_waitcnt lgkmcnt(0)
    s_barrier
    ds_read_b128 v[64:67], v0 offset:21632
    ds_read_b128 v[68:71], v0 offset:22656
    v_mov_b64 v[36:37], 0
    v_mov_b64 v[38:39], 0
    v_mov_b64 v[40:41], 0
    v_mov_b64 v[42:43], 0
    v_mov_b64 v[46:47], 0
    s_waitcnt lgkmcnt(1)
    v_smfmac_f32_16x16x64_bf16 v[12:15], v[64:67], v[48:55], v1
    ds_read_b128 v[48:51], v2 offset:22528
    s_waitcnt lgkmcnt(1)
    v_smfmac_f32_16x16x64_bf16 v[12:15], v[68:71], v[56:63], v1
    ds_read_b128 v[52:55], v2 offset:23552
    s_add_u32 s98, s98, 524288
    v_smfmac_f32_16x16x64_bf16 v[16:19], v[64:67], a[160:167], v1
    ds_read_b128 v[56:59], v2 offset:28672
    s_add_u32 s45, s45, 524288
    v_smfmac_f32_16x16x64_bf16 v[16:19], v[68:71], a[168:175], v1
    ds_read_b128 v[60:63], v2 offset:29696
    s_add_u32 s97, s97, 524288
    v_add_f32 v13, v12, v13
    v_add_f32 v15, v14, v15
    v_smfmac_f32_16x16x64_bf16 v[20:23], v[64:67], a[176:183], v1
    s_cmp_ge_u32 s35, 32
    v_cvt_pk_bf16_f32 v12, v13, v15
    v_bfi_b32 v12, v11, s47, v12
    v_smfmac_f32_16x16x64_bf16 v[20:23], v[68:71], a[184:191], v1
    buffer_store_dword v12, v5, s[4:7], s8 offen sc1
    v_add_f32 v17, v16, v17
    v_add_f32 v19, v18, v19
    v_smfmac_f32_16x16x64_bf16 v[24:27], v[64:67], a[192:199], v1
    v_cvt_pk_bf16_f32 v16, v17, v19
    v_bfi_b32 v16, v11, s47, v16
    v_smfmac_f32_16x16x64_bf16 v[24:27], v[68:71], a[200:207], v1
    buffer_store_dword v16, v5, s[4:7], s9 offen sc1
    v_add_f32 v21, v20, v21
    v_add_f32 v23, v22, v23
    s_waitcnt lgkmcnt(0)
    v_smfmac_f32_16x16x64_bf16 v[28:31], v[64:67], v[48:55], v1
    v_cvt_pk_bf16_f32 v20, v21, v23
    v_bfi_b32 v20, v11, s47, v20
    v_smfmac_f32_16x16x64_bf16 v[28:31], v[68:71], v[56:63], v1
    buffer_store_dword v20, v5, s[4:7], s10 offen sc1
    v_add_f32 v25, v24, v25
    v_add_f32 v27, v26, v27
    v_smfmac_f32_16x16x64_bf16 v[32:35], v[64:67], a[208:215], v1
    ds_read_b128 v[48:51], v2 offset:24576
    v_cvt_pk_bf16_f32 v24, v25, v27
    v_bfi_b32 v24, v11, s47, v24
    v_smfmac_f32_16x16x64_bf16 v[32:35], v[68:71], a[216:223], v1
    buffer_store_dword v24, v5, s[4:7], s11 offen sc1
    ds_read_b128 v[52:55], v2 offset:25600
    v_add_f32 v29, v28, v29
    v_add_f32 v31, v30, v31
    v_smfmac_f32_16x16x64_bf16 v[36:39], v[64:67], a[224:231], v1
    ds_read_b128 v[56:59], v2 offset:30720
    v_cvt_pk_bf16_f32 v28, v29, v31
    v_bfi_b32 v28, v11, s47, v28
    v_smfmac_f32_16x16x64_bf16 v[36:39], v[68:71], a[232:239], v1
    buffer_store_dword v28, v5, s[4:7], s12 offen sc1
    ds_read_b128 v[60:63], v2 offset:31744
    v_add_f32 v33, v32, v33
    v_add_f32 v35, v34, v35
    v_smfmac_f32_16x16x64_bf16 v[40:43], v[64:67], a[240:247], v1
    v_cvt_pk_bf16_f32 v32, v33, v35
    v_bfi_b32 v32, v11, s47, v32
    v_smfmac_f32_16x16x64_bf16 v[40:43], v[68:71], a[248:255], v1
    buffer_store_dword v32, v5, s[4:7], s13 offen sc1
    v_add_f32 v37, v36, v37
    v_add_f32 v39, v38, v39
    s_waitcnt lgkmcnt(0)
    v_smfmac_f32_16x16x64_bf16 v[44:47], v[64:67], v[48:55], v1
    v_cvt_pk_bf16_f32 v36, v37, v39
    v_bfi_b32 v36, v11, s47, v36
    v_smfmac_f32_16x16x64_bf16 v[44:47], v[68:71], v[56:63], v1
    buffer_store_dword v36, v5, s[4:7], s14 offen sc1
    v_add_f32 v41, v40, v41
    v_add_f32 v43, v42, v43
    v_cvt_pk_bf16_f32 v40, v41, v43
    v_bfi_b32 v40, v11, s47, v40
    buffer_store_dword v40, v5, s[4:7], s15 offen sc1
    s_nop 1
    v_add_f32 v45, v44, v45
    v_add_f32 v47, v46, v47
    v_cvt_pk_bf16_f32 v44, v45, v47
    v_bfi_b32 v44, v11, s47, v44
    buffer_store_dword v44, v5, s[4:7], s16 offen sc1
    s_cbranch_scc1 L_nored_39
L_go1_50:
    buffer_load_dwordx4 v[12:15], v0, s[4:7], s41 offen offset:0 sc1
    buffer_load_dwordx4 v[16:19], v0, s[4:7], s41 offen offset:1024 sc1
    buffer_load_dwordx4 v[20:23], v0, s[4:7], s41 offen offset:2048 sc1
    buffer_load_dwordx4 v[24:27], v0, s[4:7], s41 offen offset:3072 sc1
    v_cndmask_b32 v32, 0, v7, s[52:53]
    v_cndmask_b32 v33, 0, v7, s[54:55]
    v_cndmask_b32 v34, 0, v7, s[56:57]
    v_cndmask_b32 v35, 0, v7, s[58:59]
    s_mov_b32 s60, s42
    s_mov_b32 s42, s43
    s_mov_b32 s43, s44
    s_mov_b32 s44, s60
    s_add_u32 s39, s42, 4096
    s_add_u32 s40, s42, 8192
    s_mov_b32 m0, s18
    v_mov_b64 v[36:37], -1
    v_mov_b64 v[38:39], -1
    v_mov_b64 v[40:41], -1
    v_mov_b64 v[42:43], -1
    v_mov_b32 v46, 18432
    v_mov_b32 v47, s36
    buffer_load_dwordx4 v[48:51], v0, s[4:7], s41 offen offset:0 sc1
    buffer_load_dwordx4 v[52:55], v0, s[4:7], s41 offen offset:1024 sc1
    buffer_load_dwordx4 v[56:59], v0, s[4:7], s41 offen offset:2048 sc1
    buffer_load_dwordx4 v[60:63], v0, s[4:7], s41 offen offset:3072 sc1
L_p1a_43:
    s_waitcnt vmcnt(7)
    v_mfma_f32_16x16x32_bf16 v[28:31], v[32:35], v[12:15], 0
    s_waitcnt vmcnt(6)
    v_mfma_f32_16x16x32_bf16 v[28:31], v[32:35], v[16:19], v[28:31]
    v_bitop3_b32 v11, v12, v16, s47 bitop3:0x7e
    s_waitcnt vmcnt(5)
    v_mfma_f32_16x16x32_bf16 v[28:31], v[32:35], v[20:23], v[28:31]
    s_waitcnt vmcnt(4)
    v_mfma_f32_16x16x32_bf16 v[28:31], v[32:35], v[24:27], v[28:31]
    v_bitop3_b32 v45, v20, v24, s47 bitop3:0x7e
    v_bitop3_b32 v11, v11, v45, 1 bitop3:0xa8
    v_cmp_ne_u32 vcc, 0, v11
    s_nop 4
    v_add_f32_dpp v28, v28, v28 row_ror:8 row_mask:0xf bank_mask:0xf
    v_add_f32_dpp v29, v29, v29 row_ror:8 row_mask:0xf bank_mask:0xf
    v_add_f32_dpp v30, v30, v30 row_ror:8 row_mask:0xf bank_mask:0xf
    v_add_f32_dpp v31, v31, v31 row_ror:8 row_mask:0xf bank_mask:0xf
    v_cvt_pk_bf16_f32 v44, v28, v29
    v_cvt_pk_bf16_f32 v45, v30, v31
    s_cbranch_vccnz L_p1b_56
L_ok1_38:
    buffer_store_dwordx2 v[44:45], v6, s[4:7], s42 offen sc1
    ds_write_b32 v46, v47
L_b4_40:
    buffer_load_dwordx4 v[36:39], v8, s[4:7], s42 offen sc1
    buffer_load_dwordx4 v[40:43], v9, s[4:7], s42 offen sc1
    s_waitcnt vmcnt(3)
    ds_read_b128 v[48:51], v2 offset:0
    ds_read_b128 v[52:55], v2 offset:1024
    ds_read_b128 v[56:59], v2 offset:10240
    ds_read_b128 v[60:63], v2 offset:11264
    ds_read_b128 v[64:67], v2 offset:18432
    ds_read_b128 v[68:71], v2 offset:19456
    v_mov_b64 v[12:13], 0
    v_mov_b64 v[14:15], 0
    v_mov_b64 v[16:17], 0
    v_mov_b64 v[18:19], 0
    v_mov_b64 v[20:21], 0
    v_mov_b64 v[22:23], 0
    v_mov_b64 v[24:25], 0
    v_mov_b64 v[26:27], 0
    v_mov_b64 v[28:29], 0
    v_mov_b64 v[30:31], 0
    v_mov_b64 v[32:33], 0
    v_mov_b64 v[34:35], 0
    s_xor_b32 s47, s47, 1
    s_waitcnt lgkmcnt(0)
    s_branch L_s1w_42
L_p1b_56:
    buffer_load_dwordx4 v[12:15], v0, s[4:7], s41 offen offset:0 sc1
    buffer_load_dwordx4 v[16:19], v0, s[4:7], s41 offen offset:1024 sc1
    buffer_load_dwordx4 v[20:23], v0, s[4:7], s41 offen offset:2048 sc1
    buffer_load_dwordx4 v[24:27], v0, s[4:7], s41 offen offset:3072 sc1
    s_waitcnt vmcnt(7)
    v_mfma_f32_16x16x32_bf16 v[28:31], v[32:35], v[48:51], 0
    s_waitcnt vmcnt(6)
    v_mfma_f32_16x16x32_bf16 v[28:31], v[32:35], v[52:55], v[28:31]
    v_bitop3_b32 v11, v48, v52, s47 bitop3:0x7e
    s_waitcnt vmcnt(5)
    v_mfma_f32_16x16x32_bf16 v[28:31], v[32:35], v[56:59], v[28:31]
    s_waitcnt vmcnt(4)
    v_mfma_f32_16x16x32_bf16 v[28:31], v[32:35], v[60:63], v[28:31]
    v_bitop3_b32 v45, v56, v60, s47 bitop3:0x7e
    v_bitop3_b32 v11, v11, v45, 1 bitop3:0xa8
    v_cmp_ne_u32 vcc, 0, v11
    s_nop 4
    v_add_f32_dpp v28, v28, v28 row_ror:8 row_mask:0xf bank_mask:0xf
    v_add_f32_dpp v29, v29, v29 row_ror:8 row_mask:0xf bank_mask:0xf
    v_add_f32_dpp v30, v30, v30 row_ror:8 row_mask:0xf bank_mask:0xf
    v_add_f32_dpp v31, v31, v31 row_ror:8 row_mask:0xf bank_mask:0xf
    v_cvt_pk_bf16_f32 v44, v28, v29
    v_cvt_pk_bf16_f32 v45, v30, v31
    s_cbranch_vccz L_ok1_38
    buffer_load_dwordx4 v[48:51], v0, s[4:7], s41 offen offset:0 sc1
    buffer_load_dwordx4 v[52:55], v0, s[4:7], s41 offen offset:1024 sc1
    buffer_load_dwordx4 v[56:59], v0, s[4:7], s41 offen offset:2048 sc1
    buffer_load_dwordx4 v[60:63], v0, s[4:7], s41 offen offset:3072 sc1
    s_sub_u32 s37, s37, 1
    s_cbranch_scc0 L_p1a_43
    s_mov_b32 s37, 0
    s_branch L_ok1_38
L_s1r_44_give:
    s_mov_b32 s37, 0
    s_branch L_entry_36
L_exit_37_l:
    v_smfmac_f32_16x16x64_bf16 v[12:15], v[40:43], a[144:151], v1
    v_smfmac_f32_16x16x64_bf16 v[16:19], v[40:43], a[152:159], v1
    v_smfmac_f32_16x16x64_bf16 v[12:15], v[44:47], a[112:119], v1
    v_smfmac_f32_16x16x64_bf16 v[16:19], v[44:47], a[120:127], v1
    s_waitcnt lgkmcnt(0)
    s_waitcnt vmcnt(3)
    v_smfmac_f32_16x16x64_bf16 v[12:15], v[36:39], a[104:111], v1
    v_smfmac_f32_16x16x64_bf16 v[16:19], v[36:39], v[64:71], v1
    v_add_f32 v28, v28, v29
    v_add_f32 v30, v30, v31
    v_add_f32 v32, v32, v33
    v_add_f32 v34, v34, v35
    v_cvt_pk_bf16_f32 v28, v28, v32
    v_cvt_pk_bf16_f32 v29, v30, v34
    buffer_store_dword v28, v11, s[4:7], s46 offen offset:0 sc1
    buffer_store_dword v29, v11, s[4:7], s46 offen offset:256 sc1
    v_add_f32 v12, v12, v13
    v_add_f32 v14, v14, v15
    v_cvt_pk_bf16_f32 v12, v12, v14
    v_mov_b32 v13, 0
    buffer_store_dword v12, v11, s[4:7], s46 offen offset:512 sc1
    v_add_f32 v16, v16, v17
    v_add_f32 v18, v18, v19
    v_cvt_pk_bf16_f32 v16, v16, v18
    v_mov_b32 v17, 0
    buffer_store_dword v16, v11, s[4:7], s46 offen offset:768 sc1
L_exit_37:
    s_waitcnt vmcnt(0)
    s_endpgm
L_worker:
    s_sub_u32 s32, s32, 32
    v_mov_b32 v1, v0
    v_lshlrev_b32 v0, 4, v1
    v_lshrrev_b32 v2, 4, v1
    v_bfe_u32 v3, v1, 2, 2
    v_and_b32 v4, 3, v1
    s_mov_b32 s37, 1000000
    s_mov_b32 s80, 0x30003
    s_mov_b32 s81, 0x30003
    s_mov_b32 s82, 0xc000c
    s_mov_b32 s83, 0xc000c
    s_mov_b32 s84, 0x300030
    s_mov_b32 s85, 0x300030
    s_mov_b32 s86, 0xc000c0
    s_mov_b32 s87, 0xc000c0
    s_mov_b32 s88, 0x3000300
    s_mov_b32 s89, 0x3000300
    s_mov_b32 s90, 0xc000c00
    s_mov_b32 s91, 0xc000c00
    s_mov_b32 s92, 0x30003000
    s_mov_b32 s93, 0x30003000
    s_mov_b32 s94, 0xc000c000
    s_mov_b32 s95, 0xc000c000
    s_load_dwordx2 s[24:25], s[0:1], 0
    s_waitcnt lgkmcnt(0)
    s_and_b32 s25, s25, 0xffff
    s_mov_b32 s26, 2359296
    s_mov_b32 s27, 0x20000
    v_and_b32 v5, 7, v1
    v_lshlrev_b32 v7, 4, v5
    v_bfe_u32 v5, v1, 3, 1
    v_lshl_add_u32 v7, v5, 8, v7
    v_lshrrev_b32 v5, 1, v2
    v_lshl_add_u32 v7, v5, 7, v7
    v_and_b32 v5, 1, v2
    v_lshl_add_u32 v7, v5, 3, v7
    s_mov_b32 s64, 0x00ff00ff
    s_mov_b32 s65, 0
    v_mov_b32 v5, 0x20000000
    v_cndmask_b32 v8, v5, v7, s[64:65]
    s_mul_i32 s34, s32, 9363
    s_lshr_b32 s34, s34, 16
    s_mul_i32 s60, s34, 7
    s_sub_u32 s35, s32, s60
    s_lshl_b32 s61, s34, 8
    v_lshlrev_b32 v5, 2, v2
    v_sub_u32 v5, v1, v5
    v_and_b32 v5, 15, v5
    v_lshlrev_b32 v5, 4, v5
    v_mul_u32_u24 v77, 8192, v2
    v_add_u32 v77, v77, v5
    s_mul_i32 s63, s33, 131072
    s_add_u32 s63, s63, s61
    v_add_u32 v77, s63, v77
    s_lshr_b32 s61, s33, 1
    s_lshl_b32 s61, s61, 3
    s_and_b32 s62, s33, 1
    s_add_u32 s61, s61, s62
    v_mul_u32_u24 v5, 2, v4
    v_lshl_add_u32 v5, v3, 2, v5
    v_add_u32 v5, s61, v5
    v_and_b32 v5, 15, v5
    v_lshlrev_b32 v5, 4, v5
    v_lshl_add_u32 v78, v2, 3, v3
    v_lshl_add_u32 v78, v78, 8, v5
    s_cmp_lt_u32 s35, 3
    s_cbranch_scc1 L_mod_57
    s_lshl_b32 s60, s34, 2
    s_add_u32 s60, s60, s35
    s_sub_u32 s60, s60, 3
    s_lshl_b32 s60, s60, 2
    s_add_u32 s60, s60, s33
    s_mul_i32 s38, s60, 4608
    s_add_u32 s60, s38, 0
    buffer_load_dwordx2 v[16:17], v7, s[24:27], s60 offen offset:0
    buffer_load_dwordx2 v[18:19], v7, s[24:27], s60 offen offset:512
    buffer_load_dwordx2 v[20:21], v8, s[24:27], s60 offen offset:1024
    s_add_u32 s60, s38, 1152
    buffer_load_dwordx2 v[22:23], v7, s[24:27], s60 offen offset:0
    buffer_load_dwordx2 v[24:25], v7, s[24:27], s60 offen offset:512
    buffer_load_dwordx2 v[26:27], v8, s[24:27], s60 offen offset:1024
    s_add_u32 s60, s38, 2304
    buffer_load_dwordx2 v[28:29], v7, s[24:27], s60 offen offset:0
    buffer_load_dwordx2 v[30:31], v7, s[24:27], s60 offen offset:512
    buffer_load_dwordx2 v[32:33], v8, s[24:27], s60 offen offset:1024
    s_add_u32 s60, s38, 3456
    buffer_load_dwordx2 v[34:35], v7, s[24:27], s60 offen offset:0
    buffer_load_dwordx2 v[36:37], v7, s[24:27], s60 offen offset:512
    buffer_load_dwordx2 v[38:39], v8, s[24:27], s60 offen offset:1024
    s_lshl_b32 s99, s33, 12
    s_add_u32 m0, s99, 0
    s_mov_b32 s62, 0
    buffer_load_dwordx4 v77, s[8:11], s62 offen lds
    s_add_u32 m0, s99, 1024
    s_mov_b32 s62, 32768
    buffer_load_dwordx4 v77, s[8:11], s62 offen lds
    s_add_u32 m0, s99, 2048
    s_mov_b32 s62, 65536
    buffer_load_dwordx4 v77, s[8:11], s62 offen lds
    s_add_u32 m0, s99, 3072
    s_mov_b32 s62, 98304
    buffer_load_dwordx4 v77, s[8:11], s62 offen lds
    s_add_u32 m0, s99, 16384
    s_mov_b32 s62, 0
    buffer_load_dwordx4 v77, s[12:15], s62 offen lds
    s_add_u32 m0, s99, 17408
    s_mov_b32 s62, 32768
    buffer_load_dwordx4 v77, s[12:15], s62 offen lds
    s_add_u32 m0, s99, 18432
    s_mov_b32 s62, 65536
    buffer_load_dwordx4 v77, s[12:15], s62 offen lds
    s_add_u32 m0, s99, 19456
    s_mov_b32 s62, 98304
    buffer_load_dwordx4 v77, s[12:15], s62 offen lds
    s_add_u32 m0, s99, 32768
    s_mov_b32 s62, 0
    buffer_load_dwordx4 v77, s[16:19], s62 offen lds
    s_add_u32 m0, s99, 33792
    s_mov_b32 s62, 32768
    buffer_load_dwordx4 v77, s[16:19], s62 offen lds
    s_add_u32 m0, s99, 34816
    s_mov_b32 s62, 65536
    buffer_load_dwordx4 v77, s[16:19], s62 offen lds
    s_add_u32 m0, s99, 35840
    s_mov_b32 s62, 98304
    buffer_load_dwordx4 v77, s[16:19], s62 offen lds
    s_add_u32 m0, s99, 49152
    s_mov_b32 s62, 524288
    buffer_load_dwordx4 v77, s[8:11], s62 offen lds
    s_add_u32 m0, s99, 50176
    s_mov_b32 s62, 557056
    buffer_load_dwordx4 v77, s[8:11], s62 offen lds
    s_add_u32 m0, s99, 51200
    s_mov_b32 s62, 589824
    buffer_load_dwordx4 v77, s[8:11], s62 offen lds
    s_add_u32 m0, s99, 52224
    s_mov_b32 s62, 622592
    buffer_load_dwordx4 v77, s[8:11], s62 offen lds
    s_add_u32 m0, s99, 65536
    s_mov_b32 s62, 524288
    buffer_load_dwordx4 v77, s[12:15], s62 offen lds
    s_add_u32 m0, s99, 66560
    s_mov_b32 s62, 557056
    buffer_load_dwordx4 v77, s[12:15], s62 offen lds
    s_add_u32 m0, s99, 67584
    s_mov_b32 s62, 589824
    buffer_load_dwordx4 v77, s[12:15], s62 offen lds
    s_add_u32 m0, s99, 68608
    s_mov_b32 s62, 622592
    buffer_load_dwordx4 v77, s[12:15], s62 offen lds
    s_add_u32 m0, s99, 81920
    s_mov_b32 s62, 524288
    buffer_load_dwordx4 v77, s[16:19], s62 offen lds
    s_add_u32 m0, s99, 82944
    s_mov_b32 s62, 557056
    buffer_load_dwordx4 v77, s[16:19], s62 offen lds
    s_add_u32 m0, s99, 83968
    s_mov_b32 s62, 589824
    buffer_load_dwordx4 v77, s[16:19], s62 offen lds
    s_add_u32 m0, s99, 84992
    s_mov_b32 s62, 622592
    buffer_load_dwordx4 v77, s[16:19], s62 offen lds
    s_add_u32 m0, s99, 98304
    s_mov_b32 s62, 1048576
    buffer_load_dwordx4 v77, s[8:11], s62 offen lds
    s_add_u32 m0, s99, 99328
    s_mov_b32 s62, 1081344
    buffer_load_dwordx4 v77, s[8:11], s62 offen lds
    s_add_u32 m0, s99, 100352
    s_mov_b32 s62, 1114112
    buffer_load_dwordx4 v77, s[8:11], s62 offen lds
    s_add_u32 m0, s99, 101376
    s_mov_b32 s62, 1146880
    buffer_load_dwordx4 v77, s[8:11], s62 offen lds
    s_add_u32 m0, s99, 114688
    s_mov_b32 s62, 1048576
    buffer_load_dwordx4 v77, s[12:15], s62 offen lds
    s_add_u32 m0, s99, 115712
    s_mov_b32 s62, 1081344
    buffer_load_dwordx4 v77, s[12:15], s62 offen lds
    s_add_u32 m0, s99, 116736
    s_mov_b32 s62, 1114112
    buffer_load_dwordx4 v77, s[12:15], s62 offen lds
    s_add_u32 m0, s99, 117760
    s_mov_b32 s62, 1146880
    buffer_load_dwordx4 v77, s[12:15], s62 offen lds
    s_waitcnt vmcnt(32)
    v_and_b32 v101, 0xffff0000, v16
    v_lshlrev_b32 v100, 16, v16
    v_and_b32 v103, 0xffff0000, v17
    v_lshlrev_b32 v102, 16, v17
    v_and_b32 v105, 0xffff0000, v18
    v_lshlrev_b32 v104, 16, v18
    v_and_b32 v107, 0xffff0000, v19
    v_lshlrev_b32 v106, 16, v19
    v_and_b32 v109, 0xffff0000, v20
    v_lshlrev_b32 v108, 16, v20
    v_and_b32 v111, 0xffff0000, v21
    v_lshlrev_b32 v110, 16, v21
    v_add_f32 v64, v100, v101
    v_add_f32 v64, v64, v102
    v_add_f32 v64, v64, v103
    v_add_f32 v64, v64, v104
    v_add_f32 v64, v64, v105
    v_add_f32 v64, v64, v106
    v_add_f32 v64, v64, v107
    v_add_f32 v64, v64, v108
    v_add_f32 v64, v64, v109
    v_add_f32 v64, v64, v110
    v_add_f32 v64, v64, v111
    s_nop 1
    v_add_f32_dpp v64, v64, v64 row_ror:8 row_mask:0xf bank_mask:0xf
    s_nop 1
    v_add_f32_dpp v64, v64, v64 row_ror:4 row_mask:0xf bank_mask:0xf
    s_nop 1
    v_add_f32_dpp v64, v64, v64 row_ror:2 row_mask:0xf bank_mask:0xf
    s_nop 1
    v_add_f32_dpp v64, v64, v64 row_ror:1 row_mask:0xf bank_mask:0xf
    v_mov_b32 v11, v64
    s_nop 1
    v_permlane16_swap_b32 v64, v11
    v_add_f32 v64, v64, v11
    v_mov_b32 v11, v64
    s_nop 1
    v_permlane32_swap_b32 v64, v11
    v_add_f32 v64, v64, v11
    v_mul_f32 v64, 0x3ae38e39, v64
    v_sub_f32 v160, v100, v64
    v_sub_f32 v161, v101, v64
    v_sub_f32 v162, v102, v64
    v_sub_f32 v163, v103, v64
    v_sub_f32 v164, v104, v64
    v_sub_f32 v165, v105, v64
    v_sub_f32 v166, v106, v64
    v_sub_f32 v167, v107, v64
    v_sub_f32 v168, v108, v64
    v_sub_f32 v169, v109, v64
    v_sub_f32 v170, v110, v64
    v_sub_f32 v171, v111, v64
    v_mul_f32 v65, v168, v168
    v_fmac_f32 v65, v169, v169
    v_fmac_f32 v65, v170, v170
    v_fmac_f32 v65, v171, v171
    v_cndmask_b32 v65, 0, v65, s[64:65]
    v_fmac_f32 v65, v160, v160
    v_fmac_f32 v65, v161, v161
    v_fmac_f32 v65, v162, v162
    v_fmac_f32 v65, v163, v163
    v_fmac_f32 v65, v164, v164
    v_fmac_f32 v65, v165, v165
    v_fmac_f32 v65, v166, v166
    v_fmac_f32 v65, v167, v167
    s_nop 1
    v_add_f32_dpp v65, v65, v65 row_ror:8 row_mask:0xf bank_mask:0xf
    s_nop 1
    v_add_f32_dpp v65, v65, v65 row_ror:4 row_mask:0xf bank_mask:0xf
    s_nop 1
    v_add_f32_dpp v65, v65, v65 row_ror:2 row_mask:0xf bank_mask:0xf
    s_nop 1
    v_add_f32_dpp v65, v65, v65 row_ror:1 row_mask:0xf bank_mask:0xf
    v_mov_b32 v11, v65
    s_nop 1
    v_permlane16_swap_b32 v65, v11
    v_add_f32 v65, v65, v11
    v_mov_b32 v11, v65
    s_nop 1
    v_permlane32_swap_b32 v65, v11
    v_add_f32 v65, v65, v11
    v_mul_f32 v65, 0x3ae38e39, v65
    v_cvt_pk_bf16_f32 v65, v64, v65
    v_lshlrev_b32 v64, 16, v65
    v_and_b32 v65, 0xffff0000, v65
    v_add_f32 v65, 0x3727c5ac, v65
    v_cvt_pk_bf16_f32 v65, v65, v65
    v_and_b32 v65, 0xffff0000, v65
    v_sqrt_f32 v65, v65
    s_nop 0
    v_cvt_pk_bf16_f32 v65, v65, v65
    v_and_b32 v65, 0xffff0000, v65
    v_rcp_f32 v65, v65
    s_nop 0
    v_and_b32 v113, 0xffff0000, v22
    v_lshlrev_b32 v112, 16, v22
    v_and_b32 v115, 0xffff0000, v23
    v_lshlrev_b32 v114, 16, v23
    v_and_b32 v117, 0xffff0000, v24
    v_lshlrev_b32 v116, 16, v24
    v_and_b32 v119, 0xffff0000, v25
    v_lshlrev_b32 v118, 16, v25
    v_and_b32 v121, 0xffff0000, v26
    v_lshlrev_b32 v120, 16, v26
    v_and_b32 v123, 0xffff0000, v27
    v_lshlrev_b32 v122, 16, v27
    v_add_f32 v66, v112, v113
    v_add_f32 v66, v66, v114
    v_add_f32 v66, v66, v115
    v_add_f32 v66, v66, v116
    v_add_f32 v66, v66, v117
    v_add_f32 v66, v66, v118
    v_add_f32 v66, v66, v119
    v_add_f32 v66, v66, v120
    v_add_f32 v66, v66, v121
    v_add_f32 v66, v66, v122
    v_add_f32 v66, v66, v123
    s_nop 1
    v_add_f32_dpp v66, v66, v66 row_ror:8 row_mask:0xf bank_mask:0xf
    s_nop 1
    v_add_f32_dpp v66, v66, v66 row_ror:4 row_mask:0xf bank_mask:0xf
    s_nop 1
    v_add_f32_dpp v66, v66, v66 row_ror:2 row_mask:0xf bank_mask:0xf
    s_nop 1
    v_add_f32_dpp v66, v66, v66 row_ror:1 row_mask:0xf bank_mask:0xf
    v_mov_b32 v11, v66
    s_nop 1
    v_permlane16_swap_b32 v66, v11
    v_add_f32 v66, v66, v11
    v_mov_b32 v11, v66
    s_nop 1
    v_permlane32_swap_b32 v66, v11
    v_add_f32 v66, v66, v11
    v_mul_f32 v66, 0x3ae38e39, v66
    v_sub_f32 v160, v112, v66
    v_sub_f32 v161, v113, v66
    v_sub_f32 v162, v114, v66
    v_sub_f32 v163, v115, v66
    v_sub_f32 v164, v116, v66
    v_sub_f32 v165, v117, v66
    v_sub_f32 v166, v118, v66
    v_sub_f32 v167, v119, v66
    v_sub_f32 v168, v120, v66
    v_sub_f32 v169, v121, v66
    v_sub_f32 v170, v122, v66
    v_sub_f32 v171, v123, v66
    v_mul_f32 v67, v168, v168
    v_fmac_f32 v67, v169, v169
    v_fmac_f32 v67, v170, v170
    v_fmac_f32 v67, v171, v171
    v_cndmask_b32 v67, 0, v67, s[64:65]
    v_fmac_f32 v67, v160, v160
    v_fmac_f32 v67, v161, v161
    v_fmac_f32 v67, v162, v162
    v_fmac_f32 v67, v163, v163
    v_fmac_f32 v67, v164, v164
    v_fmac_f32 v67, v165, v165
    v_fmac_f32 v67, v166, v166
    v_fmac_f32 v67, v167, v167
    s_nop 1
    v_add_f32_dpp v67, v67, v67 row_ror:8 row_mask:0xf bank_mask:0xf
    s_nop 1
    v_add_f32_dpp v67, v67, v67 row_ror:4 row_mask:0xf bank_mask:0xf
    s_nop 1
    v_add_f32_dpp v67, v67, v67 row_ror:2 row_mask:0xf bank_mask:0xf
    s_nop 1
    v_add_f32_dpp v67, v67, v67 row_ror:1 row_mask:0xf bank_mask:0xf
    v_mov_b32 v11, v67
    s_nop 1
    v_permlane16_swap_b32 v67, v11
    v_add_f32 v67, v67, v11
    v_mov_b32 v11, v67
    s_nop 1
    v_permlane32_swap_b32 v67, v11
    v_add_f32 v67, v67, v11
    v_mul_f32 v67, 0x3ae38e39, v67
    v_cvt_pk_bf16_f32 v67, v66, v67
    v_lshlrev_b32 v66, 16, v67
    v_and_b32 v67, 0xffff0000, v67
    v_add_f32 v67, 0x3727c5ac, v67
    v_cvt_pk_bf16_f32 v67, v67, v67
    v_and_b32 v67, 0xffff0000, v67
    v_sqrt_f32 v67, v67
    s_nop 0
    v_cvt_pk_bf16_f32 v67, v67, v67
    v_and_b32 v67, 0xffff0000, v67
    v_rcp_f32 v67, v67
    s_nop 0
    v_and_b32 v125, 0xffff0000, v28
    v_lshlrev_b32 v124, 16, v28
    v_and_b32 v127, 0xffff0000, v29
    v_lshlrev_b32 v126, 16, v29
    v_and_b32 v129, 0xffff0000, v30
    v_lshlrev_b32 v128, 16, v30
    v_and_b32 v131, 0xffff0000, v31
    v_lshlrev_b32 v130, 16, v31
    v_and_b32 v133, 0xffff0000, v32
    v_lshlrev_b32 v132, 16, v32
    v_and_b32 v135, 0xffff0000, v33
    v_lshlrev_b32 v134, 16, v33
    v_add_f32 v68, v124, v125
    v_add_f32 v68, v68, v126
    v_add_f32 v68, v68, v127
    v_add_f32 v68, v68, v128
    v_add_f32 v68, v68, v129
    v_add_f32 v68, v68, v130
    v_add_f32 v68, v68, v131
    v_add_f32 v68, v68, v132
    v_add_f32 v68, v68, v133
    v_add_f32 v68, v68, v134
    v_add_f32 v68, v68, v135
    s_nop 1
    v_add_f32_dpp v68, v68, v68 row_ror:8 row_mask:0xf bank_mask:0xf
    s_nop 1
    v_add_f32_dpp v68, v68, v68 row_ror:4 row_mask:0xf bank_mask:0xf
    s_nop 1
    v_add_f32_dpp v68, v68, v68 row_ror:2 row_mask:0xf bank_mask:0xf
    s_nop 1
    v_add_f32_dpp v68, v68, v68 row_ror:1 row_mask:0xf bank_mask:0xf
    v_mov_b32 v11, v68
    s_nop 1
    v_permlane16_swap_b32 v68, v11
    v_add_f32 v68, v68, v11
    v_mov_b32 v11, v68
    s_nop 1
    v_permlane32_swap_b32 v68, v11
    v_add_f32 v68, v68, v11
    v_mul_f32 v68, 0x3ae38e39, v68
    v_sub_f32 v160, v124, v68
    v_sub_f32 v161, v125, v68
    v_sub_f32 v162, v126, v68
    v_sub_f32 v163, v127, v68
    v_sub_f32 v164, v128, v68
    v_sub_f32 v165, v129, v68
    v_sub_f32 v166, v130, v68
    v_sub_f32 v167, v131, v68
    v_sub_f32 v168, v132, v68
    v_sub_f32 v169, v133, v68
    v_sub_f32 v170, v134, v68
    v_sub_f32 v171, v135, v68
    v_mul_f32 v69, v168, v168
    v_fmac_f32 v69, v169, v169
    v_fmac_f32 v69, v170, v170
    v_fmac_f32 v69, v171, v171
    v_cndmask_b32 v69, 0, v69, s[64:65]
    v_fmac_f32 v69, v160, v160
    v_fmac_f32 v69, v161, v161
    v_fmac_f32 v69, v162, v162
    v_fmac_f32 v69, v163, v163
    v_fmac_f32 v69, v164, v164
    v_fmac_f32 v69, v165, v165
    v_fmac_f32 v69, v166, v166
    v_fmac_f32 v69, v167, v167
    s_nop 1
    v_add_f32_dpp v69, v69, v69 row_ror:8 row_mask:0xf bank_mask:0xf
    s_nop 1
    v_add_f32_dpp v69, v69, v69 row_ror:4 row_mask:0xf bank_mask:0xf
    s_nop 1
    v_add_f32_dpp v69, v69, v69 row_ror:2 row_mask:0xf bank_mask:0xf
    s_nop 1
    v_add_f32_dpp v69, v69, v69 row_ror:1 row_mask:0xf bank_mask:0xf
    v_mov_b32 v11, v69
    s_nop 1
    v_permlane16_swap_b32 v69, v11
    v_add_f32 v69, v69, v11
    v_mov_b32 v11, v69
    s_nop 1
    v_permlane32_swap_b32 v69, v11
    v_add_f32 v69, v69, v11
    v_mul_f32 v69, 0x3ae38e39, v69
    v_cvt_pk_bf16_f32 v69, v68, v69
    v_lshlrev_b32 v68, 16, v69
    v_and_b32 v69, 0xffff0000, v69
    v_add_f32 v69, 0x3727c5ac, v69
    v_cvt_pk_bf16_f32 v69, v69, v69
    v_and_b32 v69, 0xffff0000, v69
    v_sqrt_f32 v69, v69
    s_nop 0
    v_cvt_pk_bf16_f32 v69, v69, v69
    v_and_b32 v69, 0xffff0000, v69
    v_rcp_f32 v69, v69
    s_nop 0
    v_and_b32 v137, 0xffff0000, v34
    v_lshlrev_b32 v136, 16, v34
    v_and_b32 v139, 0xffff0000, v35
    v_lshlrev_b32 v138, 16, v35
    v_and_b32 v141, 0xffff0000, v36
    v_lshlrev_b32 v140, 16, v36
    v_and_b32 v143, 0xffff0000, v37
    v_lshlrev_b32 v142, 16, v37
    v_and_b32 v145, 0xffff0000, v38
    v_lshlrev_b32 v144, 16, v38
    v_and_b32 v147, 0xffff0000, v39
    v_lshlrev_b32 v146, 16, v39
    v_add_f32 v70, v136, v137
    v_add_f32 v70, v70, v138
    v_add_f32 v70, v70, v139
    v_add_f32 v70, v70, v140
    v_add_f32 v70, v70, v141
    v_add_f32 v70, v70, v142
    v_add_f32 v70, v70, v143
    v_add_f32 v70, v70, v144
    v_add_f32 v70, v70, v145
    v_add_f32 v70, v70, v146
    v_add_f32 v70, v70, v147
    s_nop 1
    v_add_f32_dpp v70, v70, v70 row_ror:8 row_mask:0xf bank_mask:0xf
    s_nop 1
    v_add_f32_dpp v70, v70, v70 row_ror:4 row_mask:0xf bank_mask:0xf
    s_nop 1
    v_add_f32_dpp v70, v70, v70 row_ror:2 row_mask:0xf bank_mask:0xf
    s_nop 1
    v_add_f32_dpp v70, v70, v70 row_ror:1 row_mask:0xf bank_mask:0xf
    v_mov_b32 v11, v70
    s_nop 1
    v_permlane16_swap_b32 v70, v11
    v_add_f32 v70, v70, v11
    v_mov_b32 v11, v70
    s_nop 1
    v_permlane32_swap_b32 v70, v11
    v_add_f32 v70, v70, v11
    v_mul_f32 v70, 0x3ae38e39, v70
    v_sub_f32 v160, v136, v70
    v_sub_f32 v161, v137, v70
    v_sub_f32 v162, v138, v70
    v_sub_f32 v163, v139, v70
    v_sub_f32 v164, v140, v70
    v_sub_f32 v165, v141, v70
    v_sub_f32 v166, v142, v70
    v_sub_f32 v167, v143, v70
    v_sub_f32 v168, v144, v70
    v_sub_f32 v169, v145, v70
    v_sub_f32 v170, v146, v70
    v_sub_f32 v171, v147, v70
    v_mul_f32 v71, v168, v168
    v_fmac_f32 v71, v169, v169
    v_fmac_f32 v71, v170, v170
    v_fmac_f32 v71, v171, v171
    v_cndmask_b32 v71, 0, v71, s[64:65]
    v_fmac_f32 v71, v160, v160
    v_fmac_f32 v71, v161, v161
    v_fmac_f32 v71, v162, v162
    v_fmac_f32 v71, v163, v163
    v_fmac_f32 v71, v164, v164
    v_fmac_f32 v71, v165, v165
    v_fmac_f32 v71, v166, v166
    v_fmac_f32 v71, v167, v167
    s_nop 1
    v_add_f32_dpp v71, v71, v71 row_ror:8 row_mask:0xf bank_mask:0xf
    s_nop 1
    v_add_f32_dpp v71, v71, v71 row_ror:4 row_mask:0xf bank_mask:0xf
    s_nop 1
    v_add_f32_dpp v71, v71, v71 row_ror:2 row_mask:0xf bank_mask:0xf
    s_nop 1
    v_add_f32_dpp v71, v71, v71 row_ror:1 row_mask:0xf bank_mask:0xf
    v_mov_b32 v11, v71
    s_nop 1
    v_permlane16_swap_b32 v71, v11
    v_add_f32 v71, v71, v11
    v_mov_b32 v11, v71
    s_nop 1
    v_permlane32_swap_b32 v71, v11
    v_add_f32 v71, v71, v11
    v_mul_f32 v71, 0x3ae38e39, v71
    v_cvt_pk_bf16_f32 v71, v70, v71
    v_lshlrev_b32 v70, 16, v71
    v_and_b32 v71, 0xffff0000, v71
    v_add_f32 v71, 0x3727c5ac, v71
    v_cvt_pk_bf16_f32 v71, v71, v71
    v_and_b32 v71, 0xffff0000, v71
    v_sqrt_f32 v71, v71
    s_nop 0
    v_cvt_pk_bf16_f32 v71, v71, v71
    v_and_b32 v71, 0xffff0000, v71
    v_rcp_f32 v71, v71
    s_nop 0
L_wf_60:
    buffer_load_dword v5, off, s[28:31], 0 offset:144 sc1
    s_waitcnt vmcnt(0)
    v_cmp_eq_u32 vcc, 0, v5
    s_cbranch_vccz L_wfok_61
    s_sleep 2
    s_sub_u32 s37, s37, 1
    s_cbranch_scc0 L_wf_60
    s_mov_b32 s37, 0
L_wfok_61:
    v_lshlrev_b32 v9, 1, v7
    v_lshlrev_b32 v10, 1, v8
    s_mov_b32 s62, 80740352
    buffer_load_dwordx4 v[40:43], v9, s[4:7], s62 offen offset:0 sc1
    buffer_load_dwordx4 v[44:47], v9, s[4:7], s62 offen offset:1024 sc1
    buffer_load_dwordx4 v[48:51], v10, s[4:7], s62 offen offset:2048 sc1
    v_lshlrev_b32 v9, 1, v7
    v_lshlrev_b32 v10, 1, v8
    s_mov_b32 s62, 80742656
    buffer_load_dwordx4 v[52:55], v9, s[4:7], s62 offen offset:0 sc1
    buffer_load_dwordx4 v[56:59], v9, s[4:7], s62 offen offset:1024 sc1
    buffer_load_dwordx4 v[60:63], v10, s[4:7], s62 offen offset:2048 sc1
    s_waitcnt vmcnt(0)
    v_add_f32 v52, 1.0, v52
    v_add_f32 v53, 1.0, v53
    v_add_f32 v54, 1.0, v54
    v_add_f32 v55, 1.0, v55
    v_add_f32 v56, 1.0, v56
    v_add_f32 v57, 1.0, v57
    v_add_f32 v58, 1.0, v58
    v_add_f32 v59, 1.0, v59
    v_add_f32 v60, 1.0, v60
    v_add_f32 v61, 1.0, v61
    v_add_f32 v62, 1.0, v62
    v_add_f32 v63, 1.0, v63
    v_cvt_pk_bf16_f32 v53, v52, v53
    v_lshlrev_b32 v52, 16, v53
    v_and_b32 v53, 0xffff0000, v53
    v_cvt_pk_bf16_f32 v55, v54, v55
    v_lshlrev_b32 v54, 16, v55
    v_and_b32 v55, 0xffff0000, v55
    v_cvt_pk_bf16_f32 v57, v56, v57
    v_lshlrev_b32 v56, 16, v57
    v_and_b32 v57, 0xffff0000, v57
    v_cvt_pk_bf16_f32 v59, v58, v59
    v_lshlrev_b32 v58, 16, v59
    v_and_b32 v59, 0xffff0000, v59
    v_cvt_pk_bf16_f32 v61, v60, v61
    v_lshlrev_b32 v60, 16, v61
    v_and_b32 v61, 0xffff0000, v61
    v_cvt_pk_bf16_f32 v63, v62, v63
    v_lshlrev_b32 v62, 16, v63
    v_and_b32 v63, 0xffff0000, v63
    v_sub_f32 v100, v100, v64
    v_sub_f32 v101, v101, v64
    v_sub_f32 v102, v102, v64
    v_sub_f32 v103, v103, v64
    v_sub_f32 v104, v104, v64
    v_sub_f32 v105, v105, v64
    v_sub_f32 v106, v106, v64
    v_sub_f32 v107, v107, v64
    v_sub_f32 v108, v108, v64
    v_sub_f32 v109, v109, v64
    v_sub_f32 v110, v110, v64
    v_sub_f32 v111, v111, v64
    v_cvt_pk_bf16_f32 v101, v100, v101
    v_lshlrev_b32 v100, 16, v101
    v_and_b32 v101, 0xffff0000, v101
    v_cvt_pk_bf16_f32 v103, v102, v103
    v_lshlrev_b32 v102, 16, v103
    v_and_b32 v103, 0xffff0000, v103
    v_cvt_pk_bf16_f32 v105, v104, v105
    v_lshlrev_b32 v104, 16, v105
    v_and_b32 v105, 0xffff0000, v105
    v_cvt_pk_bf16_f32 v107, v106, v107
    v_lshlrev_b32 v106, 16, v107
    v_and_b32 v107, 0xffff0000, v107
    v_cvt_pk_bf16_f32 v109, v108, v109
    v_lshlrev_b32 v108, 16, v109
    v_and_b32 v109, 0xffff0000, v109
    v_cvt_pk_bf16_f32 v111, v110, v111
    v_lshlrev_b32 v110, 16, v111
    v_and_b32 v111, 0xffff0000, v111
    v_mul_f32 v100, v100, v65
    v_mul_f32 v101, v101, v65
    v_mul_f32 v102, v102, v65
    v_mul_f32 v103, v103, v65
    v_mul_f32 v104, v104, v65
    v_mul_f32 v105, v105, v65
    v_mul_f32 v106, v106, v65
    v_mul_f32 v107, v107, v65
    v_mul_f32 v108, v108, v65
    v_mul_f32 v109, v109, v65
    v_mul_f32 v110, v110, v65
    v_mul_f32 v111, v111, v65
    v_cvt_pk_bf16_f32 v101, v100, v101
    v_lshlrev_b32 v100, 16, v101
    v_and_b32 v101, 0xffff0000, v101
    v_cvt_pk_bf16_f32 v103, v102, v103
    v_lshlrev_b32 v102, 16, v103
    v_and_b32 v103, 0xffff0000, v103
    v_cvt_pk_bf16_f32 v105, v104, v105
    v_lshlrev_b32 v104, 16, v105
    v_and_b32 v105, 0xffff0000, v105
    v_cvt_pk_bf16_f32 v107, v106, v107
    v_lshlrev_b32 v106, 16, v107
    v_and_b32 v107, 0xffff0000, v107
    v_cvt_pk_bf16_f32 v109, v108, v109
    v_lshlrev_b32 v108, 16, v109
    v_and_b32 v109, 0xffff0000, v109
    v_cvt_pk_bf16_f32 v111, v110, v111
    v_lshlrev_b32 v110, 16, v111
    v_and_b32 v111, 0xffff0000, v111
    v_mul_f32 v100, v100, v52
    v_mul_f32 v101, v101, v53
    v_mul_f32 v102, v102, v54
    v_mul_f32 v103, v103, v55
    v_mul_f32 v104, v104, v56
    v_mul_f32 v105, v105, v57
    v_mul_f32 v106, v106, v58
    v_mul_f32 v107, v107, v59
    v_mul_f32 v108, v108, v60
    v_mul_f32 v109, v109, v61
    v_mul_f32 v110, v110, v62
    v_mul_f32 v111, v111, v63
    v_cvt_pk_bf16_f32 v101, v100, v101
    v_lshlrev_b32 v100, 16, v101
    v_and_b32 v101, 0xffff0000, v101
    v_cvt_pk_bf16_f32 v103, v102, v103
    v_lshlrev_b32 v102, 16, v103
    v_and_b32 v103, 0xffff0000, v103
    v_cvt_pk_bf16_f32 v105, v104, v105
    v_lshlrev_b32 v104, 16, v105
    v_and_b32 v105, 0xffff0000, v105
    v_cvt_pk_bf16_f32 v107, v106, v107
    v_lshlrev_b32 v106, 16, v107
    v_and_b32 v107, 0xffff0000, v107
    v_cvt_pk_bf16_f32 v109, v108, v109
    v_lshlrev_b32 v108, 16, v109
    v_and_b32 v109, 0xffff0000, v109
    v_cvt_pk_bf16_f32 v111, v110, v111
    v_lshlrev_b32 v110, 16, v111
    v_and_b32 v111, 0xffff0000, v111
    v_add_f32 v100, v100, v40
    v_add_f32 v101, v101, v41
    v_add_f32 v102, v102, v42
    v_add_f32 v103, v103, v43
    v_add_f32 v104, v104, v44
    v_add_f32 v105, v105, v45
    v_add_f32 v106, v106, v46
    v_add_f32 v107, v107, v47
    v_add_f32 v108, v108, v48
    v_add_f32 v109, v109, v49
    v_add_f32 v110, v110, v50
    v_add_f32 v111, v111, v51
    v_cvt_pk_bf16_f32 v16, v100, v101
    v_cvt_pk_bf16_f32 v17, v102, v103
    v_cvt_pk_bf16_f32 v18, v104, v105
    v_cvt_pk_bf16_f32 v19, v106, v107
    v_cvt_pk_bf16_f32 v20, v108, v109
    v_cvt_pk_bf16_f32 v21, v110, v111
    s_add_u32 s60, s38, 71303168
    buffer_store_dwordx2 v[16:17], v7, s[4:7], s60 offen offset:0 sc1
    buffer_store_dwordx2 v[18:19], v7, s[4:7], s60 offen offset:512 sc1
    buffer_store_dwordx2 v[20:21], v8, s[4:7], s60 offen offset:1024 sc1
    v_sub_f32 v112, v112, v66
    v_sub_f32 v113, v113, v66
    v_sub_f32 v114, v114, v66
    v_sub_f32 v115, v115, v66
    v_sub_f32 v116, v116, v66
    v_sub_f32 v117, v117, v66
    v_sub_f32 v118, v118, v66
    v_sub_f32 v119, v119, v66
    v_sub_f32 v120, v120, v66
    v_sub_f32 v121, v121, v66
    v_sub_f32 v122, v122, v66
    v_sub_f32 v123, v123, v66
    v_cvt_pk_bf16_f32 v113, v112, v113
    v_lshlrev_b32 v112, 16, v113
    v_and_b32 v113, 0xffff0000, v113
    v_cvt_pk_bf16_f32 v115, v114, v115
    v_lshlrev_b32 v114, 16, v115
    v_and_b32 v115, 0xffff0000, v115
    v_cvt_pk_bf16_f32 v117, v116, v117
    v_lshlrev_b32 v116, 16, v117
    v_and_b32 v117, 0xffff0000, v117
    v_cvt_pk_bf16_f32 v119, v118, v119
    v_lshlrev_b32 v118, 16, v119
    v_and_b32 v119, 0xffff0000, v119
    v_cvt_pk_bf16_f32 v121, v120, v121
    v_lshlrev_b32 v120, 16, v121
    v_and_b32 v121, 0xffff0000, v121
    v_cvt_pk_bf16_f32 v123, v122, v123
    v_lshlrev_b32 v122, 16, v123
    v_and_b32 v123, 0xffff0000, v123
    v_mul_f32 v112, v112, v67
    v_mul_f32 v113, v113, v67
    v_mul_f32 v114, v114, v67
    v_mul_f32 v115, v115, v67
    v_mul_f32 v116, v116, v67
    v_mul_f32 v117, v117, v67
    v_mul_f32 v118, v118, v67
    v_mul_f32 v119, v119, v67
    v_mul_f32 v120, v120, v67
    v_mul_f32 v121, v121, v67
    v_mul_f32 v122, v122, v67
    v_mul_f32 v123, v123, v67
    v_cvt_pk_bf16_f32 v113, v112, v113
    v_lshlrev_b32 v112, 16, v113
    v_and_b32 v113, 0xffff0000, v113
    v_cvt_pk_bf16_f32 v115, v114, v115
    v_lshlrev_b32 v114, 16, v115
    v_and_b32 v115, 0xffff0000, v115
    v_cvt_pk_bf16_f32 v117, v116, v117
    v_lshlrev_b32 v116, 16, v117
    v_and_b32 v117, 0xffff0000, v117
    v_cvt_pk_bf16_f32 v119, v118, v119
    v_lshlrev_b32 v118, 16, v119
    v_and_b32 v119, 0xffff0000, v119
    v_cvt_pk_bf16_f32 v121, v120, v121
    v_lshlrev_b32 v120, 16, v121
    v_and_b32 v121, 0xffff0000, v121
    v_cvt_pk_bf16_f32 v123, v122, v123
    v_lshlrev_b32 v122, 16, v123
    v_and_b32 v123, 0xffff0000, v123
    v_mul_f32 v112, v112, v52
    v_mul_f32 v113, v113, v53
    v_mul_f32 v114, v114, v54
    v_mul_f32 v115, v115, v55
    v_mul_f32 v116, v116, v56
    v_mul_f32 v117, v117, v57
    v_mul_f32 v118, v118, v58
    v_mul_f32 v119, v119, v59
    v_mul_f32 v120, v120, v60
    v_mul_f32 v121, v121, v61
    v_mul_f32 v122, v122, v62
    v_mul_f32 v123, v123, v63
    v_cvt_pk_bf16_f32 v113, v112, v113
    v_lshlrev_b32 v112, 16, v113
    v_and_b32 v113, 0xffff0000, v113
    v_cvt_pk_bf16_f32 v115, v114, v115
    v_lshlrev_b32 v114, 16, v115
    v_and_b32 v115, 0xffff0000, v115
    v_cvt_pk_bf16_f32 v117, v116, v117
    v_lshlrev_b32 v116, 16, v117
    v_and_b32 v117, 0xffff0000, v117
    v_cvt_pk_bf16_f32 v119, v118, v119
    v_lshlrev_b32 v118, 16, v119
    v_and_b32 v119, 0xffff0000, v119
    v_cvt_pk_bf16_f32 v121, v120, v121
    v_lshlrev_b32 v120, 16, v121
    v_and_b32 v121, 0xffff0000, v121
    v_cvt_pk_bf16_f32 v123, v122, v123
    v_lshlrev_b32 v122, 16, v123
    v_and_b32 v123, 0xffff0000, v123
    v_add_f32 v112, v112, v40
    v_add_f32 v113, v113, v41
    v_add_f32 v114, v114, v42
    v_add_f32 v115, v115, v43
    v_add_f32 v116, v116, v44
    v_add_f32 v117, v117, v45
    v_add_f32 v118, v118, v46
    v_add_f32 v119, v119, v47
    v_add_f32 v120, v120, v48
    v_add_f32 v121, v121, v49
    v_add_f32 v122, v122, v50
    v_add_f32 v123, v123, v51
    v_cvt_pk_bf16_f32 v22, v112, v113
    v_cvt_pk_bf16_f32 v23, v114, v115
    v_cvt_pk_bf16_f32 v24, v116, v117
    v_cvt_pk_bf16_f32 v25, v118, v119
    v_cvt_pk_bf16_f32 v26, v120, v121
    v_cvt_pk_bf16_f32 v27, v122, v123
    s_add_u32 s60, s38, 71304320
    buffer_store_dwordx2 v[22:23], v7, s[4:7], s60 offen offset:0 sc1
    buffer_store_dwordx2 v[24:25], v7, s[4:7], s60 offen offset:512 sc1
    buffer_store_dwordx2 v[26:27], v8, s[4:7], s60 offen offset:1024 sc1
    v_sub_f32 v124, v124, v68
    v_sub_f32 v125, v125, v68
    v_sub_f32 v126, v126, v68
    v_sub_f32 v127, v127, v68
    v_sub_f32 v128, v128, v68
    v_sub_f32 v129, v129, v68
    v_sub_f32 v130, v130, v68
    v_sub_f32 v131, v131, v68
    v_sub_f32 v132, v132, v68
    v_sub_f32 v133, v133, v68
    v_sub_f32 v134, v134, v68
    v_sub_f32 v135, v135, v68
    v_cvt_pk_bf16_f32 v125, v124, v125
    v_lshlrev_b32 v124, 16, v125
    v_and_b32 v125, 0xffff0000, v125
    v_cvt_pk_bf16_f32 v127, v126, v127
    v_lshlrev_b32 v126, 16, v127
    v_and_b32 v127, 0xffff0000, v127
    v_cvt_pk_bf16_f32 v129, v128, v129
    v_lshlrev_b32 v128, 16, v129
    v_and_b32 v129, 0xffff0000, v129
    v_cvt_pk_bf16_f32 v131, v130, v131
    v_lshlrev_b32 v130, 16, v131
    v_and_b32 v131, 0xffff0000, v131
    v_cvt_pk_bf16_f32 v133, v132, v133
    v_lshlrev_b32 v132, 16, v133
    v_and_b32 v133, 0xffff0000, v133
    v_cvt_pk_bf16_f32 v135, v134, v135
    v_lshlrev_b32 v134, 16, v135
    v_and_b32 v135, 0xffff0000, v135
    v_mul_f32 v124, v124, v69
    v_mul_f32 v125, v125, v69
    v_mul_f32 v126, v126, v69
    v_mul_f32 v127, v127, v69
    v_mul_f32 v128, v128, v69
    v_mul_f32 v129, v129, v69
    v_mul_f32 v130, v130, v69
    v_mul_f32 v131, v131, v69
    v_mul_f32 v132, v132, v69
    v_mul_f32 v133, v133, v69
    v_mul_f32 v134, v134, v69
    v_mul_f32 v135, v135, v69
    v_cvt_pk_bf16_f32 v125, v124, v125
    v_lshlrev_b32 v124, 16, v125
    v_and_b32 v125, 0xffff0000, v125
    v_cvt_pk_bf16_f32 v127, v126, v127
    v_lshlrev_b32 v126, 16, v127
    v_and_b32 v127, 0xffff0000, v127
    v_cvt_pk_bf16_f32 v129, v128, v129
    v_lshlrev_b32 v128, 16, v129
    v_and_b32 v129, 0xffff0000, v129
    v_cvt_pk_bf16_f32 v131, v130, v131
    v_lshlrev_b32 v130, 16, v131
    v_and_b32 v131, 0xffff0000, v131
    v_cvt_pk_bf16_f32 v133, v132, v133
    v_lshlrev_b32 v132, 16, v133
    v_and_b32 v133, 0xffff0000, v133
    v_cvt_pk_bf16_f32 v135, v134, v135
    v_lshlrev_b32 v134, 16, v135
    v_and_b32 v135, 0xffff0000, v135
    v_mul_f32 v124, v124, v52
    v_mul_f32 v125, v125, v53
    v_mul_f32 v126, v126, v54
    v_mul_f32 v127, v127, v55
    v_mul_f32 v128, v128, v56
    v_mul_f32 v129, v129, v57
    v_mul_f32 v130, v130, v58
    v_mul_f32 v131, v131, v59
    v_mul_f32 v132, v132, v60
    v_mul_f32 v133, v133, v61
    v_mul_f32 v134, v134, v62
    v_mul_f32 v135, v135, v63
    v_cvt_pk_bf16_f32 v125, v124, v125
    v_lshlrev_b32 v124, 16, v125
    v_and_b32 v125, 0xffff0000, v125
    v_cvt_pk_bf16_f32 v127, v126, v127
    v_lshlrev_b32 v126, 16, v127
    v_and_b32 v127, 0xffff0000, v127
    v_cvt_pk_bf16_f32 v129, v128, v129
    v_lshlrev_b32 v128, 16, v129
    v_and_b32 v129, 0xffff0000, v129
    v_cvt_pk_bf16_f32 v131, v130, v131
    v_lshlrev_b32 v130, 16, v131
    v_and_b32 v131, 0xffff0000, v131
    v_cvt_pk_bf16_f32 v133, v132, v133
    v_lshlrev_b32 v132, 16, v133
    v_and_b32 v133, 0xffff0000, v133
    v_cvt_pk_bf16_f32 v135, v134, v135
    v_lshlrev_b32 v134, 16, v135
    v_and_b32 v135, 0xffff0000, v135
    v_add_f32 v124, v124, v40
    v_add_f32 v125, v125, v41
    v_add_f32 v126, v126, v42
    v_add_f32 v127, v127, v43
    v_add_f32 v128, v128, v44
    v_add_f32 v129, v129, v45
    v_add_f32 v130, v130, v46
    v_add_f32 v131, v131, v47
    v_add_f32 v132, v132, v48
    v_add_f32 v133, v133, v49
    v_add_f32 v134, v134, v50
    v_add_f32 v135, v135, v51
    v_cvt_pk_bf16_f32 v28, v124, v125
    v_cvt_pk_bf16_f32 v29, v126, v127
    v_cvt_pk_bf16_f32 v30, v128, v129
    v_cvt_pk_bf16_f32 v31, v130, v131
    v_cvt_pk_bf16_f32 v32, v132, v133
    v_cvt_pk_bf16_f32 v33, v134, v135
    s_add_u32 s60, s38, 71305472
    buffer_store_dwordx2 v[28:29], v7, s[4:7], s60 offen offset:0 sc1
    buffer_store_dwordx2 v[30:31], v7, s[4:7], s60 offen offset:512 sc1
    buffer_store_dwordx2 v[32:33], v8, s[4:7], s60 offen offset:1024 sc1
    v_sub_f32 v136, v136, v70
    v_sub_f32 v137, v137, v70
    v_sub_f32 v138, v138, v70
    v_sub_f32 v139, v139, v70
    v_sub_f32 v140, v140, v70
    v_sub_f32 v141, v141, v70
    v_sub_f32 v142, v142, v70
    v_sub_f32 v143, v143, v70
    v_sub_f32 v144, v144, v70
    v_sub_f32 v145, v145, v70
    v_sub_f32 v146, v146, v70
    v_sub_f32 v147, v147, v70
    v_cvt_pk_bf16_f32 v137, v136, v137
    v_lshlrev_b32 v136, 16, v137
    v_and_b32 v137, 0xffff0000, v137
    v_cvt_pk_bf16_f32 v139, v138, v139
    v_lshlrev_b32 v138, 16, v139
    v_and_b32 v139, 0xffff0000, v139
    v_cvt_pk_bf16_f32 v141, v140, v141
    v_lshlrev_b32 v140, 16, v141
    v_and_b32 v141, 0xffff0000, v141
    v_cvt_pk_bf16_f32 v143, v142, v143
    v_lshlrev_b32 v142, 16, v143
    v_and_b32 v143, 0xffff0000, v143
    v_cvt_pk_bf16_f32 v145, v144, v145
    v_lshlrev_b32 v144, 16, v145
    v_and_b32 v145, 0xffff0000, v145
    v_cvt_pk_bf16_f32 v147, v146, v147
    v_lshlrev_b32 v146, 16, v147
    v_and_b32 v147, 0xffff0000, v147
    v_mul_f32 v136, v136, v71
    v_mul_f32 v137, v137, v71
    v_mul_f32 v138, v138, v71
    v_mul_f32 v139, v139, v71
    v_mul_f32 v140, v140, v71
    v_mul_f32 v141, v141, v71
    v_mul_f32 v142, v142, v71
    v_mul_f32 v143, v143, v71
    v_mul_f32 v144, v144, v71
    v_mul_f32 v145, v145, v71
    v_mul_f32 v146, v146, v71
    v_mul_f32 v147, v147, v71
    v_cvt_pk_bf16_f32 v137, v136, v137
    v_lshlrev_b32 v136, 16, v137
    v_and_b32 v137, 0xffff0000, v137
    v_cvt_pk_bf16_f32 v139, v138, v139
    v_lshlrev_b32 v138, 16, v139
    v_and_b32 v139, 0xffff0000, v139
    v_cvt_pk_bf16_f32 v141, v140, v141
    v_lshlrev_b32 v140, 16, v141
    v_and_b32 v141, 0xffff0000, v141
    v_cvt_pk_bf16_f32 v143, v142, v143
    v_lshlrev_b32 v142, 16, v143
    v_and_b32 v143, 0xffff0000, v143
    v_cvt_pk_bf16_f32 v145, v144, v145
    v_lshlrev_b32 v144, 16, v145
    v_and_b32 v145, 0xffff0000, v145
    v_cvt_pk_bf16_f32 v147, v146, v147
    v_lshlrev_b32 v146, 16, v147
    v_and_b32 v147, 0xffff0000, v147
    v_mul_f32 v136, v136, v52
    v_mul_f32 v137, v137, v53
    v_mul_f32 v138, v138, v54
    v_mul_f32 v139, v139, v55
    v_mul_f32 v140, v140, v56
    v_mul_f32 v141, v141, v57
    v_mul_f32 v142, v142, v58
    v_mul_f32 v143, v143, v59
    v_mul_f32 v144, v144, v60
    v_mul_f32 v145, v145, v61
    v_mul_f32 v146, v146, v62
    v_mul_f32 v147, v147, v63
    v_cvt_pk_bf16_f32 v137, v136, v137
    v_lshlrev_b32 v136, 16, v137
    v_and_b32 v137, 0xffff0000, v137
    v_cvt_pk_bf16_f32 v139, v138, v139
    v_lshlrev_b32 v138, 16, v139
    v_and_b32 v139, 0xffff0000, v139
    v_cvt_pk_bf16_f32 v141, v140, v141
    v_lshlrev_b32 v140, 16, v141
    v_and_b32 v141, 0xffff0000, v141
    v_cvt_pk_bf16_f32 v143, v142, v143
    v_lshlrev_b32 v142, 16, v143
    v_and_b32 v143, 0xffff0000, v143
    v_cvt_pk_bf16_f32 v145, v144, v145
    v_lshlrev_b32 v144, 16, v145
    v_and_b32 v145, 0xffff0000, v145
    v_cvt_pk_bf16_f32 v147, v146, v147
    v_lshlrev_b32 v146, 16, v147
    v_and_b32 v147, 0xffff0000, v147
    v_add_f32 v136, v136, v40
    v_add_f32 v137, v137, v41
    v_add_f32 v138, v138, v42
    v_add_f32 v139, v139, v43
    v_add_f32 v140, v140, v44
    v_add_f32 v141, v141, v45
    v_add_f32 v142, v142, v46
    v_add_f32 v143, v143, v47
    v_add_f32 v144, v144, v48
    v_add_f32 v145, v145, v49
    v_add_f32 v146, v146, v50
    v_add_f32 v147, v147, v51
    v_cvt_pk_bf16_f32 v34, v136, v137
    v_cvt_pk_bf16_f32 v35, v138, v139
    v_cvt_pk_bf16_f32 v36, v140, v141
    v_cvt_pk_bf16_f32 v37, v142, v143
    v_cvt_pk_bf16_f32 v38, v144, v145
    v_cvt_pk_bf16_f32 v39, v146, v147
    s_add_u32 s60, s38, 71306624
    buffer_store_dwordx2 v[34:35], v7, s[4:7], s60 offen offset:0 sc1
    buffer_store_dwordx2 v[36:37], v7, s[4:7], s60 offen offset:512 sc1
    buffer_store_dwordx2 v[38:39], v8, s[4:7], s60 offen offset:1024 sc1
    s_waitcnt vmcnt(0)
    s_barrier
    s_mov_b32 s60, 81788928
    s_cmp_lg_u32 s33, 0
    s_cbranch_scc1 L_ar_62
    s_mov_b64 exec, 1
    v_mov_b32 v5, 1
    buffer_atomic_add v5, off, s[4:7], s60 sc0
    s_waitcnt vmcnt(0)
    v_cmpx_eq_u32 vcc, 127, v5
    s_cbranch_execz L_ar_62_x
    buffer_store_dword v5, off, s[4:7], s60 offset:128 sc1
L_ar_62_x:
    s_mov_b64 exec, -1
L_ar_62:
    s_branch L_predone_58
L_mod_57:
    s_cmp_eq_u32 s35, 0
    s_cbranch_scc1 L_idle_59
    s_cmp_ge_u32 s34, 27
    s_cbranch_scc1 L_idle_59
    s_load_dwordx2 s[40:41], s[0:1], 88
    s_waitcnt lgkmcnt(0)
    s_and_b32 s41, s41, 0xffff
    s_mov_b32 s42, 1152
    s_mov_b32 s43, 0x20000
    s_load_dwordx2 s[44:45], s[0:1], 96
    s_waitcnt lgkmcnt(0)
    s_and_b32 s45, s45, 0xffff
    s_mov_b32 s46, 3981312
    s_mov_b32 s47, 0x20000
    s_lshl_b32 s38, s34, 1
    s_add_u32 s38, s38, s35
    s_sub_u32 s38, s38, 1
    v_mov_b32 v12, 0
    v_mov_b32 v13, 0
    v_mov_b32 v14, 0
    v_mov_b32 v15, 0
    s_lshl_b32 s60, s38, 2
    s_add_u32 s60, s60, s33
    s_lshl_b32 s60, s60, 11
    s_add_u32 s60, s60, 81788928
    buffer_store_dwordx4 v[12:15], v0, s[4:7], s60 offen sc1
    buffer_store_dwordx4 v[12:15], v0, s[4:7], s60 offen offset:1024 sc1
    v_lshrrev_b32 v9, 3, v1
    s_mul_i32 s60, s33, 144
    v_add_u32 v9, s60, v9
    v_lshlrev_b32 v10, 1, v9
    v_mul_u32_u24 v9, 6912, v9
    v_and_b32 v11, 7, v1
    v_lshl_add_u32 v9, v11, 4, v9
    s_lshl_b32 s60, s38, 7
    buffer_load_ushort v100, v10, s[40:43], 0 offen offset:0
    buffer_load_ushort v101, v10, s[40:43], 0 offen offset:16
    buffer_load_ushort v102, v10, s[40:43], 0 offen offset:32
    buffer_load_ushort v103, v10, s[40:43], 0 offen offset:48
    buffer_load_ushort v104, v10, s[40:43], 0 offen offset:64
    buffer_load_ushort v105, v10, s[40:43], 0 offen offset:80
    buffer_load_ushort v106, v10, s[40:43], 0 offen offset:96
    buffer_load_ushort v107, v10, s[40:43], 0 offen offset:112
    buffer_load_ushort v108, v10, s[40:43], 0 offen offset:128
    buffer_load_ushort v109, v10, s[40:43], 0 offen offset:144
    buffer_load_ushort v110, v10, s[40:43], 0 offen offset:160
    buffer_load_ushort v111, v10, s[40:43], 0 offen offset:176
    buffer_load_ushort v112, v10, s[40:43], 0 offen offset:192
    buffer_load_ushort v113, v10, s[40:43], 0 offen offset:208
    buffer_load_ushort v114, v10, s[40:43], 0 offen offset:224
    buffer_load_ushort v115, v10, s[40:43], 0 offen offset:240
    buffer_load_ushort v116, v10, s[40:43], 0 offen offset:256
    buffer_load_ushort v117, v10, s[40:43], 0 offen offset:272
    s_add_u32 s61, s60, 0
    buffer_load_dwordx4 v[120:123], v9, s[44:47], s61 offen
    s_add_u32 s61, s60, 55296
    buffer_load_dwordx4 v[124:127], v9, s[44:47], s61 offen
    s_add_u32 s61, s60, 110592
    buffer_load_dwordx4 v[128:131], v9, s[44:47], s61 offen
    s_add_u32 s61, s60, 165888
    buffer_load_dwordx4 v[132:135], v9, s[44:47], s61 offen
    s_add_u32 s61, s60, 221184
    buffer_load_dwordx4 v[136:139], v9, s[44:47], s61 offen
    s_add_u32 s61, s60, 276480
    buffer_load_dwordx4 v[140:143], v9, s[44:47], s61 offen
    s_add_u32 s61, s60, 331776
    buffer_load_dwordx4 v[144:147], v9, s[44:47], s61 offen
    s_add_u32 s61, s60, 387072
    buffer_load_dwordx4 v[148:151], v9, s[44:47], s61 offen
    s_add_u32 s61, s60, 442368
    buffer_load_dwordx4 v[152:155], v9, s[44:47], s61 offen
    s_add_u32 s61, s60, 497664
    buffer_load_dwordx4 v[156:159], v9, s[44:47], s61 offen
    s_add_u32 s61, s60, 552960
    buffer_load_dwordx4 v[160:163], v9, s[44:47], s61 offen
    s_add_u32 s61, s60, 608256
    buffer_load_dwordx4 v[164:167], v9, s[44:47], s61 offen
    s_add_u32 s61, s60, 663552
    buffer_load_dwordx4 v[168:171], v9, s[44:47], s61 offen
    s_add_u32 s61, s60, 718848
    buffer_load_dwordx4 v[172:175], v9, s[44:47], s61 offen
    s_add_u32 s61, s60, 774144
    buffer_load_dwordx4 v[176:179], v9, s[44:47], s61 offen
    s_add_u32 s61, s60, 829440
    buffer_load_dwordx4 v[180:183], v9, s[44:47], s61 offen
    s_add_u32 s61, s60, 884736
    buffer_load_dwordx4 v[184:187], v9, s[44:47], s61 offen
    s_add_u32 s61, s60, 940032
    buffer_load_dwordx4 v[188:191], v9, s[44:47], s61 offen
    s_waitcnt vmcnt(18)
    v_lshlrev_b32 v100, 16, v100
    v_mul_f32 v12, 0xbfb8aa3b, v100
    v_exp_f32 v12, v12
    s_nop 0
    v_add_f32 v12, 1.0, v12
    v_rcp_f32 v12, v12
    s_nop 0
    v_mul_f32 v100, v100, v12
    v_cvt_pk_bf16_f32 v100, v100, v100
    v_and_b32 v100, 0xffff0000, v100
    v_lshlrev_b32 v101, 16, v101
    v_mul_f32 v12, 0xbfb8aa3b, v101
    v_exp_f32 v12, v12
    s_nop 0
    v_add_f32 v12, 1.0, v12
    v_rcp_f32 v12, v12
    s_nop 0
    v_mul_f32 v101, v101, v12
    v_cvt_pk_bf16_f32 v101, v101, v101
    v_and_b32 v101, 0xffff0000, v101
    v_lshlrev_b32 v102, 16, v102
    v_mul_f32 v12, 0xbfb8aa3b, v102
    v_exp_f32 v12, v12
    s_nop 0
    v_add_f32 v12, 1.0, v12
    v_rcp_f32 v12, v12
    s_nop 0
    v_mul_f32 v102, v102, v12
    v_cvt_pk_bf16_f32 v102, v102, v102
    v_and_b32 v102, 0xffff0000, v102
    v_lshlrev_b32 v103, 16, v103
    v_mul_f32 v12, 0xbfb8aa3b, v103
    v_exp_f32 v12, v12
    s_nop 0
    v_add_f32 v12, 1.0, v12
    v_rcp_f32 v12, v12
    s_nop 0
    v_mul_f32 v103, v103, v12
    v_cvt_pk_bf16_f32 v103, v103, v103
    v_and_b32 v103, 0xffff0000, v103
    v_lshlrev_b32 v104, 16, v104
    v_mul_f32 v12, 0xbfb8aa3b, v104
    v_exp_f32 v12, v12
    s_nop 0
    v_add_f32 v12, 1.0, v12
    v_rcp_f32 v12, v12
    s_nop 0
    v_mul_f32 v104, v104, v12
    v_cvt_pk_bf16_f32 v104, v104, v104
    v_and_b32 v104, 0xffff0000, v104
    v_lshlrev_b32 v105, 16, v105
    v_mul_f32 v12, 0xbfb8aa3b, v105
    v_exp_f32 v12, v12
    s_nop 0
    v_add_f32 v12, 1.0, v12
    v_rcp_f32 v12, v12
    s_nop 0
    v_mul_f32 v105, v105, v12
    v_cvt_pk_bf16_f32 v105, v105, v105
    v_and_b32 v105, 0xffff0000, v105
    v_lshlrev_b32 v106, 16, v106
    v_mul_f32 v12, 0xbfb8aa3b, v106
    v_exp_f32 v12, v12
    s_nop 0
    v_add_f32 v12, 1.0, v12
    v_rcp_f32 v12, v12
    s_nop 0
    v_mul_f32 v106, v106, v12
    v_cvt_pk_bf16_f32 v106, v106, v106
    v_and_b32 v106, 0xffff0000, v106
    v_lshlrev_b32 v107, 16, v107
    v_mul_f32 v12, 0xbfb8aa3b, v107
    v_exp_f32 v12, v12
    s_nop 0
    v_add_f32 v12, 1.0, v12
    v_rcp_f32 v12, v12
    s_nop 0
    v_mul_f32 v107, v107, v12
    v_cvt_pk_bf16_f32 v107, v107, v107
    v_and_b32 v107, 0xffff0000, v107
    v_lshlrev_b32 v108, 16, v108
    v_mul_f32 v12, 0xbfb8aa3b, v108
    v_exp_f32 v12, v12
    s_nop 0
    v_add_f32 v12, 1.0, v12
    v_rcp_f32 v12, v12
    s_nop 0
    v_mul_f32 v108, v108, v12
    v_cvt_pk_bf16_f32 v108, v108, v108
    v_and_b32 v108, 0xffff0000, v108
    v_lshlrev_b32 v109, 16, v109
    v_mul_f32 v12, 0xbfb8aa3b, v109
    v_exp_f32 v12, v12
    s_nop 0
    v_add_f32 v12, 1.0, v12
    v_rcp_f32 v12, v12
    s_nop 0
    v_mul_f32 v109, v109, v12
    v_cvt_pk_bf16_f32 v109, v109, v109
    v_and_b32 v109, 0xffff0000, v109
    v_lshlrev_b32 v110, 16, v110
    v_mul_f32 v12, 0xbfb8aa3b, v110
    v_exp_f32 v12, v12
    s_nop 0
    v_add_f32 v12, 1.0, v12
    v_rcp_f32 v12, v12
    s_nop 0
    v_mul_f32 v110, v110, v12
    v_cvt_pk_bf16_f32 v110, v110, v110
    v_and_b32 v110, 0xffff0000, v110
    v_lshlrev_b32 v111, 16, v111
    v_mul_f32 v12, 0xbfb8aa3b, v111
    v_exp_f32 v12, v12
    s_nop 0
    v_add_f32 v12, 1.0, v12
    v_rcp_f32 v12, v12
    s_nop 0
    v_mul_f32 v111, v111, v12
    v_cvt_pk_bf16_f32 v111, v111, v111
    v_and_b32 v111, 0xffff0000, v111
    v_lshlrev_b32 v112, 16, v112
    v_mul_f32 v12, 0xbfb8aa3b, v112
    v_exp_f32 v12, v12
    s_nop 0
    v_add_f32 v12, 1.0, v12
    v_rcp_f32 v12, v12
    s_nop 0
    v_mul_f32 v112, v112, v12
    v_cvt_pk_bf16_f32 v112, v112, v112
    v_and_b32 v112, 0xffff0000, v112
    v_lshlrev_b32 v113, 16, v113
    v_mul_f32 v12, 0xbfb8aa3b, v113
    v_exp_f32 v12, v12
    s_nop 0
    v_add_f32 v12, 1.0, v12
    v_rcp_f32 v12, v12
    s_nop 0
    v_mul_f32 v113, v113, v12
    v_cvt_pk_bf16_f32 v113, v113, v113
    v_and_b32 v113, 0xffff0000, v113
    v_lshlrev_b32 v114, 16, v114
    v_mul_f32 v12, 0xbfb8aa3b, v114
    v_exp_f32 v12, v12
    s_nop 0
    v_add_f32 v12, 1.0, v12
    v_rcp_f32 v12, v12
    s_nop 0
    v_mul_f32 v114, v114, v12
    v_cvt_pk_bf16_f32 v114, v114, v114
    v_and_b32 v114, 0xffff0000, v114
    v_lshlrev_b32 v115, 16, v115
    v_mul_f32 v12, 0xbfb8aa3b, v115
    v_exp_f32 v12, v12
    s_nop 0
    v_add_f32 v12, 1.0, v12
    v_rcp_f32 v12, v12
    s_nop 0
    v_mul_f32 v115, v115, v12
    v_cvt_pk_bf16_f32 v115, v115, v115
    v_and_b32 v115, 0xffff0000, v115
    v_lshlrev_b32 v116, 16, v116
    v_mul_f32 v12, 0xbfb8aa3b, v116
    v_exp_f32 v12, v12
    s_nop 0
    v_add_f32 v12, 1.0, v12
    v_rcp_f32 v12, v12
    s_nop 0
    v_mul_f32 v116, v116, v12
    v_cvt_pk_bf16_f32 v116, v116, v116
    v_and_b32 v116, 0xffff0000, v116
    v_lshlrev_b32 v117, 16, v117
    v_mul_f32 v12, 0xbfb8aa3b, v117
    v_exp_f32 v12, v12
    s_nop 0
    v_add_f32 v12, 1.0, v12
    v_rcp_f32 v12, v12
    s_nop 0
    v_mul_f32 v117, v117, v12
    v_cvt_pk_bf16_f32 v117, v117, v117
    v_and_b32 v117, 0xffff0000, v117
    v_mov_b32 v200, 0
    v_mov_b32 v201, 0
    v_mov_b32 v202, 0
    v_mov_b32 v203, 0
    v_mov_b32 v204, 0
    v_mov_b32 v205, 0
    v_mov_b32 v206, 0
    v_mov_b32 v207, 0
    s_waitcnt vmcnt(0)
    v_and_b32 v13, 0xffff0000, v120
    v_lshlrev_b32 v12, 16, v120
    v_fmac_f32 v200, v12, v100
    v_fmac_f32 v201, v13, v100
    v_and_b32 v13, 0xffff0000, v121
    v_lshlrev_b32 v12, 16, v121
    v_fmac_f32 v202, v12, v100
    v_fmac_f32 v203, v13, v100
    v_and_b32 v13, 0xffff0000, v122
    v_lshlrev_b32 v12, 16, v122
    v_fmac_f32 v204, v12, v100
    v_fmac_f32 v205, v13, v100
    v_and_b32 v13, 0xffff0000, v123
    v_lshlrev_b32 v12, 16, v123
    v_fmac_f32 v206, v12, v100
    v_fmac_f32 v207, v13, v100
    v_and_b32 v13, 0xffff0000, v124
    v_lshlrev_b32 v12, 16, v124
    v_fmac_f32 v200, v12, v101
    v_fmac_f32 v201, v13, v101
    v_and_b32 v13, 0xffff0000, v125
    v_lshlrev_b32 v12, 16, v125
    v_fmac_f32 v202, v12, v101
    v_fmac_f32 v203, v13, v101
    v_and_b32 v13, 0xffff0000, v126
    v_lshlrev_b32 v12, 16, v126
    v_fmac_f32 v204, v12, v101
    v_fmac_f32 v205, v13, v101
    v_and_b32 v13, 0xffff0000, v127
    v_lshlrev_b32 v12, 16, v127
    v_fmac_f32 v206, v12, v101
    v_fmac_f32 v207, v13, v101
    v_and_b32 v13, 0xffff0000, v128
    v_lshlrev_b32 v12, 16, v128
    v_fmac_f32 v200, v12, v102
    v_fmac_f32 v201, v13, v102
    v_and_b32 v13, 0xffff0000, v129
    v_lshlrev_b32 v12, 16, v129
    v_fmac_f32 v202, v12, v102
    v_fmac_f32 v203, v13, v102
    v_and_b32 v13, 0xffff0000, v130
    v_lshlrev_b32 v12, 16, v130
    v_fmac_f32 v204, v12, v102
    v_fmac_f32 v205, v13, v102
    v_and_b32 v13, 0xffff0000, v131
    v_lshlrev_b32 v12, 16, v131
    v_fmac_f32 v206, v12, v102
    v_fmac_f32 v207, v13, v102
    v_and_b32 v13, 0xffff0000, v132
    v_lshlrev_b32 v12, 16, v132
    v_fmac_f32 v200, v12, v103
    v_fmac_f32 v201, v13, v103
    v_and_b32 v13, 0xffff0000, v133
    v_lshlrev_b32 v12, 16, v133
    v_fmac_f32 v202, v12, v103
    v_fmac_f32 v203, v13, v103
    v_and_b32 v13, 0xffff0000, v134
    v_lshlrev_b32 v12, 16, v134
    v_fmac_f32 v204, v12, v103
    v_fmac_f32 v205, v13, v103
    v_and_b32 v13, 0xffff0000, v135
    v_lshlrev_b32 v12, 16, v135
    v_fmac_f32 v206, v12, v103
    v_fmac_f32 v207, v13, v103
    v_and_b32 v13, 0xffff0000, v136
    v_lshlrev_b32 v12, 16, v136
    v_fmac_f32 v200, v12, v104
    v_fmac_f32 v201, v13, v104
    v_and_b32 v13, 0xffff0000, v137
    v_lshlrev_b32 v12, 16, v137
    v_fmac_f32 v202, v12, v104
    v_fmac_f32 v203, v13, v104
    v_and_b32 v13, 0xffff0000, v138
    v_lshlrev_b32 v12, 16, v138
    v_fmac_f32 v204, v12, v104
    v_fmac_f32 v205, v13, v104
    v_and_b32 v13, 0xffff0000, v139
    v_lshlrev_b32 v12, 16, v139
    v_fmac_f32 v206, v12, v104
    v_fmac_f32 v207, v13, v104
    v_and_b32 v13, 0xffff0000, v140
    v_lshlrev_b32 v12, 16, v140
    v_fmac_f32 v200, v12, v105
    v_fmac_f32 v201, v13, v105
    v_and_b32 v13, 0xffff0000, v141
    v_lshlrev_b32 v12, 16, v141
    v_fmac_f32 v202, v12, v105
    v_fmac_f32 v203, v13, v105
    v_and_b32 v13, 0xffff0000, v142
    v_lshlrev_b32 v12, 16, v142
    v_fmac_f32 v204, v12, v105
    v_fmac_f32 v205, v13, v105
    v_and_b32 v13, 0xffff0000, v143
    v_lshlrev_b32 v12, 16, v143
    v_fmac_f32 v206, v12, v105
    v_fmac_f32 v207, v13, v105
    v_and_b32 v13, 0xffff0000, v144
    v_lshlrev_b32 v12, 16, v144
    v_fmac_f32 v200, v12, v106
    v_fmac_f32 v201, v13, v106
    v_and_b32 v13, 0xffff0000, v145
    v_lshlrev_b32 v12, 16, v145
    v_fmac_f32 v202, v12, v106
    v_fmac_f32 v203, v13, v106
    v_and_b32 v13, 0xffff0000, v146
    v_lshlrev_b32 v12, 16, v146
    v_fmac_f32 v204, v12, v106
    v_fmac_f32 v205, v13, v106
    v_and_b32 v13, 0xffff0000, v147
    v_lshlrev_b32 v12, 16, v147
    v_fmac_f32 v206, v12, v106
    v_fmac_f32 v207, v13, v106
    v_and_b32 v13, 0xffff0000, v148
    v_lshlrev_b32 v12, 16, v148
    v_fmac_f32 v200, v12, v107
    v_fmac_f32 v201, v13, v107
    v_and_b32 v13, 0xffff0000, v149
    v_lshlrev_b32 v12, 16, v149
    v_fmac_f32 v202, v12, v107
    v_fmac_f32 v203, v13, v107
    v_and_b32 v13, 0xffff0000, v150
    v_lshlrev_b32 v12, 16, v150
    v_fmac_f32 v204, v12, v107
    v_fmac_f32 v205, v13, v107
    v_and_b32 v13, 0xffff0000, v151
    v_lshlrev_b32 v12, 16, v151
    v_fmac_f32 v206, v12, v107
    v_fmac_f32 v207, v13, v107
    v_and_b32 v13, 0xffff0000, v152
    v_lshlrev_b32 v12, 16, v152
    v_fmac_f32 v200, v12, v108
    v_fmac_f32 v201, v13, v108
    v_and_b32 v13, 0xffff0000, v153
    v_lshlrev_b32 v12, 16, v153
    v_fmac_f32 v202, v12, v108
    v_fmac_f32 v203, v13, v108
    v_and_b32 v13, 0xffff0000, v154
    v_lshlrev_b32 v12, 16, v154
    v_fmac_f32 v204, v12, v108
    v_fmac_f32 v205, v13, v108
    v_and_b32 v13, 0xffff0000, v155
    v_lshlrev_b32 v12, 16, v155
    v_fmac_f32 v206, v12, v108
    v_fmac_f32 v207, v13, v108
    v_and_b32 v13, 0xffff0000, v156
    v_lshlrev_b32 v12, 16, v156
    v_fmac_f32 v200, v12, v109
    v_fmac_f32 v201, v13, v109
    v_and_b32 v13, 0xffff0000, v157
    v_lshlrev_b32 v12, 16, v157
    v_fmac_f32 v202, v12, v109
    v_fmac_f32 v203, v13, v109
    v_and_b32 v13, 0xffff0000, v158
    v_lshlrev_b32 v12, 16, v158
    v_fmac_f32 v204, v12, v109
    v_fmac_f32 v205, v13, v109
    v_and_b32 v13, 0xffff0000, v159
    v_lshlrev_b32 v12, 16, v159
    v_fmac_f32 v206, v12, v109
    v_fmac_f32 v207, v13, v109
    v_and_b32 v13, 0xffff0000, v160
    v_lshlrev_b32 v12, 16, v160
    v_fmac_f32 v200, v12, v110
    v_fmac_f32 v201, v13, v110
    v_and_b32 v13, 0xffff0000, v161
    v_lshlrev_b32 v12, 16, v161
    v_fmac_f32 v202, v12, v110
    v_fmac_f32 v203, v13, v110
    v_and_b32 v13, 0xffff0000, v162
    v_lshlrev_b32 v12, 16, v162
    v_fmac_f32 v204, v12, v110
    v_fmac_f32 v205, v13, v110
    v_and_b32 v13, 0xffff0000, v163
    v_lshlrev_b32 v12, 16, v163
    v_fmac_f32 v206, v12, v110
    v_fmac_f32 v207, v13, v110
    v_and_b32 v13, 0xffff0000, v164
    v_lshlrev_b32 v12, 16, v164
    v_fmac_f32 v200, v12, v111
    v_fmac_f32 v201, v13, v111
    v_and_b32 v13, 0xffff0000, v165
    v_lshlrev_b32 v12, 16, v165
    v_fmac_f32 v202, v12, v111
    v_fmac_f32 v203, v13, v111
    v_and_b32 v13, 0xffff0000, v166
    v_lshlrev_b32 v12, 16, v166
    v_fmac_f32 v204, v12, v111
    v_fmac_f32 v205, v13, v111
    v_and_b32 v13, 0xffff0000, v167
    v_lshlrev_b32 v12, 16, v167
    v_fmac_f32 v206, v12, v111
    v_fmac_f32 v207, v13, v111
    v_and_b32 v13, 0xffff0000, v168
    v_lshlrev_b32 v12, 16, v168
    v_fmac_f32 v200, v12, v112
    v_fmac_f32 v201, v13, v112
    v_and_b32 v13, 0xffff0000, v169
    v_lshlrev_b32 v12, 16, v169
    v_fmac_f32 v202, v12, v112
    v_fmac_f32 v203, v13, v112
    v_and_b32 v13, 0xffff0000, v170
    v_lshlrev_b32 v12, 16, v170
    v_fmac_f32 v204, v12, v112
    v_fmac_f32 v205, v13, v112
    v_and_b32 v13, 0xffff0000, v171
    v_lshlrev_b32 v12, 16, v171
    v_fmac_f32 v206, v12, v112
    v_fmac_f32 v207, v13, v112
    v_and_b32 v13, 0xffff0000, v172
    v_lshlrev_b32 v12, 16, v172
    v_fmac_f32 v200, v12, v113
    v_fmac_f32 v201, v13, v113
    v_and_b32 v13, 0xffff0000, v173
    v_lshlrev_b32 v12, 16, v173
    v_fmac_f32 v202, v12, v113
    v_fmac_f32 v203, v13, v113
    v_and_b32 v13, 0xffff0000, v174
    v_lshlrev_b32 v12, 16, v174
    v_fmac_f32 v204, v12, v113
    v_fmac_f32 v205, v13, v113
    v_and_b32 v13, 0xffff0000, v175
    v_lshlrev_b32 v12, 16, v175
    v_fmac_f32 v206, v12, v113
    v_fmac_f32 v207, v13, v113
    v_and_b32 v13, 0xffff0000, v176
    v_lshlrev_b32 v12, 16, v176
    v_fmac_f32 v200, v12, v114
    v_fmac_f32 v201, v13, v114
    v_and_b32 v13, 0xffff0000, v177
    v_lshlrev_b32 v12, 16, v177
    v_fmac_f32 v202, v12, v114
    v_fmac_f32 v203, v13, v114
    v_and_b32 v13, 0xffff0000, v178
    v_lshlrev_b32 v12, 16, v178
    v_fmac_f32 v204, v12, v114
    v_fmac_f32 v205, v13, v114
    v_and_b32 v13, 0xffff0000, v179
    v_lshlrev_b32 v12, 16, v179
    v_fmac_f32 v206, v12, v114
    v_fmac_f32 v207, v13, v114
    v_and_b32 v13, 0xffff0000, v180
    v_lshlrev_b32 v12, 16, v180
    v_fmac_f32 v200, v12, v115
    v_fmac_f32 v201, v13, v115
    v_and_b32 v13, 0xffff0000, v181
    v_lshlrev_b32 v12, 16, v181
    v_fmac_f32 v202, v12, v115
    v_fmac_f32 v203, v13, v115
    v_and_b32 v13, 0xffff0000, v182
    v_lshlrev_b32 v12, 16, v182
    v_fmac_f32 v204, v12, v115
    v_fmac_f32 v205, v13, v115
    v_and_b32 v13, 0xffff0000, v183
    v_lshlrev_b32 v12, 16, v183
    v_fmac_f32 v206, v12, v115
    v_fmac_f32 v207, v13, v115
    v_and_b32 v13, 0xffff0000, v184
    v_lshlrev_b32 v12, 16, v184
    v_fmac_f32 v200, v12, v116
    v_fmac_f32 v201, v13, v116
    v_and_b32 v13, 0xffff0000, v185
    v_lshlrev_b32 v12, 16, v185
    v_fmac_f32 v202, v12, v116
    v_fmac_f32 v203, v13, v116
    v_and_b32 v13, 0xffff0000, v186
    v_lshlrev_b32 v12, 16, v186
    v_fmac_f32 v204, v12, v116
    v_fmac_f32 v205, v13, v116
    v_and_b32 v13, 0xffff0000, v187
    v_lshlrev_b32 v12, 16, v187
    v_fmac_f32 v206, v12, v116
    v_fmac_f32 v207, v13, v116
    v_and_b32 v13, 0xffff0000, v188
    v_lshlrev_b32 v12, 16, v188
    v_fmac_f32 v200, v12, v117
    v_fmac_f32 v201, v13, v117
    v_and_b32 v13, 0xffff0000, v189
    v_lshlrev_b32 v12, 16, v189
    v_fmac_f32 v202, v12, v117
    v_fmac_f32 v203, v13, v117
    v_and_b32 v13, 0xffff0000, v190
    v_lshlrev_b32 v12, 16, v190
    v_fmac_f32 v204, v12, v117
    v_fmac_f32 v205, v13, v117
    v_and_b32 v13, 0xffff0000, v191
    v_lshlrev_b32 v12, 16, v191
    v_fmac_f32 v206, v12, v117
    v_fmac_f32 v207, v13, v117
    s_nop 1
    v_add_f32_dpp v200, v200, v200 row_ror:8 row_mask:0xf bank_mask:0xf
    v_mov_b32 v12, v200
    s_nop 1
    v_permlane16_swap_b32 v200, v12
    v_add_f32 v200, v200, v12
    v_mov_b32 v12, v200
    s_nop 1
    v_permlane32_swap_b32 v200, v12
    v_add_f32 v200, v200, v12
    s_nop 1
    v_add_f32_dpp v201, v201, v201 row_ror:8 row_mask:0xf bank_mask:0xf
    v_mov_b32 v12, v201
    s_nop 1
    v_permlane16_swap_b32 v201, v12
    v_add_f32 v201, v201, v12
    v_mov_b32 v12, v201
    s_nop 1
    v_permlane32_swap_b32 v201, v12
    v_add_f32 v201, v201, v12
    s_nop 1
    v_add_f32_dpp v202, v202, v202 row_ror:8 row_mask:0xf bank_mask:0xf
    v_mov_b32 v12, v202
    s_nop 1
    v_permlane16_swap_b32 v202, v12
    v_add_f32 v202, v202, v12
    v_mov_b32 v12, v202
    s_nop 1
    v_permlane32_swap_b32 v202, v12
    v_add_f32 v202, v202, v12
    s_nop 1
    v_add_f32_dpp v203, v203, v203 row_ror:8 row_mask:0xf bank_mask:0xf
    v_mov_b32 v12, v203
    s_nop 1
    v_permlane16_swap_b32 v203, v12
    v_add_f32 v203, v203, v12
    v_mov_b32 v12, v203
    s_nop 1
    v_permlane32_swap_b32 v203, v12
    v_add_f32 v203, v203, v12
    s_nop 1
    v_add_f32_dpp v204, v204, v204 row_ror:8 row_mask:0xf bank_mask:0xf
    v_mov_b32 v12, v204
    s_nop 1
    v_permlane16_swap_b32 v204, v12
    v_add_f32 v204, v204, v12
    v_mov_b32 v12, v204
    s_nop 1
    v_permlane32_swap_b32 v204, v12
    v_add_f32 v204, v204, v12
    s_nop 1
    v_add_f32_dpp v205, v205, v205 row_ror:8 row_mask:0xf bank_mask:0xf
    v_mov_b32 v12, v205
    s_nop 1
    v_permlane16_swap_b32 v205, v12
    v_add_f32 v205, v205, v12
    v_mov_b32 v12, v205
    s_nop 1
    v_permlane32_swap_b32 v205, v12
    v_add_f32 v205, v205, v12
    s_nop 1
    v_add_f32_dpp v206, v206, v206 row_ror:8 row_mask:0xf bank_mask:0xf
    v_mov_b32 v12, v206
    s_nop 1
    v_permlane16_swap_b32 v206, v12
    v_add_f32 v206, v206, v12
    v_mov_b32 v12, v206
    s_nop 1
    v_permlane32_swap_b32 v206, v12
    v_add_f32 v206, v206, v12
    s_nop 1
    v_add_f32_dpp v207, v207, v207 row_ror:8 row_mask:0xf bank_mask:0xf
    v_mov_b32 v12, v207
    s_nop 1
    v_permlane16_swap_b32 v207, v12
    v_add_f32 v207, v207, v12
    v_mov_b32 v12, v207
    s_nop 1
    v_permlane32_swap_b32 v207, v12
    v_add_f32 v207, v207, v12
    s_lshl_b32 s61, s33, 8
    s_add_u32 s61, s61, 147456
    v_lshlrev_b32 v11, 5, v11
    v_add_u32 v11, s61, v11
    ds_write_b128 v11, v[200:203]
    ds_write_b128 v11, v[204:207] offset:16
    s_waitcnt lgkmcnt(0)
    s_barrier
    v_lshlrev_b32 v10, 2, v1
    v_add_u32 v11, 147456, v10
    ds_read_b32 v12, v11 offset:0
    ds_read_b32 v13, v11 offset:256
    ds_read_b32 v14, v11 offset:512
    ds_read_b32 v15, v11 offset:768
    s_waitcnt lgkmcnt(0)
    v_add_f32 v12, v12, v13
    v_add_f32 v14, v14, v15
    v_add_f32 v12, v12, v14
    v_cvt_pk_bf16_f32 v12, v12, v12
    v_and_b32 v12, 0xffff0000, v12
    s_lshl_b32 s60, s38, 8
    s_add_u32 s60, s60, 80740352
    s_cmp_lg_u32 s33, 0
    s_cbranch_scc1 L_modw_63
    buffer_store_dword v12, v10, s[4:7], s60 offen sc1
    s_waitcnt vmcnt(0)
    s_mov_b64 exec, 1
    v_mov_b32 v12, 1
    buffer_atomic_add v12, off, s[28:31], 0 offset:48 sc0
    s_waitcnt vmcnt(0)
    v_cmpx_eq_u32 vcc, 53, v12
    s_cbranch_execz L_modw_63_x
    buffer_store_dword v12, off, s[28:31], 0 offset:144 sc1
L_modw_63_x:
    s_mov_b64 exec, -1
L_modw_63:
L_idle_59:
    s_lshl_b32 s99, s33, 12
    s_add_u32 m0, s99, 0
    s_mov_b32 s62, 0
    buffer_load_dwordx4 v77, s[8:11], s62 offen lds
    s_add_u32 m0, s99, 1024
    s_mov_b32 s62, 32768
    buffer_load_dwordx4 v77, s[8:11], s62 offen lds
    s_add_u32 m0, s99, 2048
    s_mov_b32 s62, 65536
    buffer_load_dwordx4 v77, s[8:11], s62 offen lds
    s_add_u32 m0, s99, 3072
    s_mov_b32 s62, 98304
    buffer_load_dwordx4 v77, s[8:11], s62 offen lds
    s_add_u32 m0, s99, 16384
    s_mov_b32 s62, 0
    buffer_load_dwordx4 v77, s[12:15], s62 offen lds
    s_add_u32 m0, s99, 17408
    s_mov_b32 s62, 32768
    buffer_load_dwordx4 v77, s[12:15], s62 offen lds
    s_add_u32 m0, s99, 18432
    s_mov_b32 s62, 65536
    buffer_load_dwordx4 v77, s[12:15], s62 offen lds
    s_add_u32 m0, s99, 19456
    s_mov_b32 s62, 98304
    buffer_load_dwordx4 v77, s[12:15], s62 offen lds
    s_add_u32 m0, s99, 32768
    s_mov_b32 s62, 0
    buffer_load_dwordx4 v77, s[16:19], s62 offen lds
    s_add_u32 m0, s99, 33792
    s_mov_b32 s62, 32768
    buffer_load_dwordx4 v77, s[16:19], s62 offen lds
    s_add_u32 m0, s99, 34816
    s_mov_b32 s62, 65536
    buffer_load_dwordx4 v77, s[16:19], s62 offen lds
    s_add_u32 m0, s99, 35840
    s_mov_b32 s62, 98304
    buffer_load_dwordx4 v77, s[16:19], s62 offen lds
    s_add_u32 m0, s99, 49152
    s_mov_b32 s62, 524288
    buffer_load_dwordx4 v77, s[8:11], s62 offen lds
    s_add_u32 m0, s99, 50176
    s_mov_b32 s62, 557056
    buffer_load_dwordx4 v77, s[8:11], s62 offen lds
    s_add_u32 m0, s99, 51200
    s_mov_b32 s62, 589824
    buffer_load_dwordx4 v77, s[8:11], s62 offen lds
    s_add_u32 m0, s99, 52224
    s_mov_b32 s62, 622592
    buffer_load_dwordx4 v77, s[8:11], s62 offen lds
    s_add_u32 m0, s99, 65536
    s_mov_b32 s62, 524288
    buffer_load_dwordx4 v77, s[12:15], s62 offen lds
    s_add_u32 m0, s99, 66560
    s_mov_b32 s62, 557056
    buffer_load_dwordx4 v77, s[12:15], s62 offen lds
    s_add_u32 m0, s99, 67584
    s_mov_b32 s62, 589824
    buffer_load_dwordx4 v77, s[12:15], s62 offen lds
    s_add_u32 m0, s99, 68608
    s_mov_b32 s62, 622592
    buffer_load_dwordx4 v77, s[12:15], s62 offen lds
    s_add_u32 m0, s99, 81920
    s_mov_b32 s62, 524288
    buffer_load_dwordx4 v77, s[16:19], s62 offen lds
    s_add_u32 m0, s99, 82944
    s_mov_b32 s62, 557056
    buffer_load_dwordx4 v77, s[16:19], s62 offen lds
    s_add_u32 m0, s99, 83968
    s_mov_b32 s62, 589824
    buffer_load_dwordx4 v77, s[16:19], s62 offen lds
    s_add_u32 m0, s99, 84992
    s_mov_b32 s62, 622592
    buffer_load_dwordx4 v77, s[16:19], s62 offen lds
    s_add_u32 m0, s99, 98304
    s_mov_b32 s62, 1048576
    buffer_load_dwordx4 v77, s[8:11], s62 offen lds
    s_add_u32 m0, s99, 99328
    s_mov_b32 s62, 1081344
    buffer_load_dwordx4 v77, s[8:11], s62 offen lds
    s_add_u32 m0, s99, 100352
    s_mov_b32 s62, 1114112
    buffer_load_dwordx4 v77, s[8:11], s62 offen lds
    s_add_u32 m0, s99, 101376
    s_mov_b32 s62, 1146880
    buffer_load_dwordx4 v77, s[8:11], s62 offen lds
    s_add_u32 m0, s99, 114688
    s_mov_b32 s62, 1048576
    buffer_load_dwordx4 v77, s[12:15], s62 offen lds
    s_add_u32 m0, s99, 115712
    s_mov_b32 s62, 1081344
    buffer_load_dwordx4 v77, s[12:15], s62 offen lds
    s_add_u32 m0, s99, 116736
    s_mov_b32 s62, 1114112
    buffer_load_dwordx4 v77, s[12:15], s62 offen lds
    s_add_u32 m0, s99, 117760
    s_mov_b32 s62, 1146880
    buffer_load_dwordx4 v77, s[12:15], s62 offen lds
L_predone_58:
    s_waitcnt vmcnt(28)
    s_barrier
    s_add_u32 m0, s99, 131072
    s_mov_b32 s62, 1048576
    buffer_load_dwordx4 v77, s[16:19], s62 offen lds
    s_add_u32 m0, s99, 132096
    s_mov_b32 s62, 1081344
    buffer_load_dwordx4 v77, s[16:19], s62 offen lds
    s_add_u32 m0, s99, 133120
    s_mov_b32 s62, 1114112
    buffer_load_dwordx4 v77, s[16:19], s62 offen lds
    s_add_u32 m0, s99, 134144
    s_mov_b32 s62, 1146880
    buffer_load_dwordx4 v77, s[16:19], s62 offen lds
    v_add_u32 v11, 0, v78
    ds_read_b64_tr_b16 v[80:81], v11 offset:0
    ds_read_b64_tr_b16 v[82:83], v11 offset:1024
    ds_read_b64_tr_b16 v[84:85], v11 offset:8
    ds_read_b64_tr_b16 v[86:87], v11 offset:1032
    ds_read_b64_tr_b16 v[104:105], v11 offset:8192
    ds_read_b64_tr_b16 v[106:107], v11 offset:9216
    ds_read_b64_tr_b16 v[108:109], v11 offset:8200
    ds_read_b64_tr_b16 v[110:111], v11 offset:9224
    s_waitcnt lgkmcnt(0)
    s_waitcnt vmcnt(28)
    s_barrier
    s_add_u32 m0, s99, 0
    s_mov_b32 s62, 1572864
    buffer_load_dwordx4 v77, s[8:11], s62 offen lds
    s_add_u32 m0, s99, 1024
    s_mov_b32 s62, 1605632
    buffer_load_dwordx4 v77, s[8:11], s62 offen lds
    s_add_u32 m0, s99, 2048
    s_mov_b32 s62, 1638400
    buffer_load_dwordx4 v77, s[8:11], s62 offen lds
    s_add_u32 m0, s99, 3072
    s_mov_b32 s62, 1671168
    buffer_load_dwordx4 v77, s[8:11], s62 offen lds
    v_add_u32 v11, 16384, v78
    ds_read_b64_tr_b16 v[88:89], v11 offset:0
    ds_read_b64_tr_b16 v[90:91], v11 offset:1024
    ds_read_b64_tr_b16 v[92:93], v11 offset:8
    ds_read_b64_tr_b16 v[94:95], v11 offset:1032
    ds_read_b64_tr_b16 v[112:113], v11 offset:8192
    ds_read_b64_tr_b16 v[114:115], v11 offset:9216
    ds_read_b64_tr_b16 v[116:117], v11 offset:8200
    ds_read_b64_tr_b16 v[118:119], v11 offset:9224
    s_waitcnt lgkmcnt(0)
    s_waitcnt vmcnt(28)
    s_barrier
    s_add_u32 m0, s99, 16384
    s_mov_b32 s62, 1572864
    buffer_load_dwordx4 v77, s[12:15], s62 offen lds
    s_add_u32 m0, s99, 17408
    s_mov_b32 s62, 1605632
    buffer_load_dwordx4 v77, s[12:15], s62 offen lds
    s_add_u32 m0, s99, 18432
    s_mov_b32 s62, 1638400
    buffer_load_dwordx4 v77, s[12:15], s62 offen lds
    s_add_u32 m0, s99, 19456
    s_mov_b32 s62, 1671168
    buffer_load_dwordx4 v77, s[12:15], s62 offen lds
    v_add_u32 v11, 32768, v78
    ds_read_b64_tr_b16 v[96:97], v11 offset:0
    ds_read_b64_tr_b16 v[98:99], v11 offset:1024
    ds_read_b64_tr_b16 v[100:101], v11 offset:8
    ds_read_b64_tr_b16 v[102:103], v11 offset:1032
    ds_read_b64_tr_b16 v[120:121], v11 offset:8192
    ds_read_b64_tr_b16 v[122:123], v11 offset:9216
    ds_read_b64_tr_b16 v[124:125], v11 offset:8200
    ds_read_b64_tr_b16 v[126:127], v11 offset:9224
    s_waitcnt lgkmcnt(0)
    s_waitcnt vmcnt(28)
    s_barrier
    s_add_u32 m0, s99, 32768
    s_mov_b32 s62, 1572864
    buffer_load_dwordx4 v77, s[16:19], s62 offen lds
    s_add_u32 m0, s99, 33792
    s_mov_b32 s62, 1605632
    buffer_load_dwordx4 v77, s[16:19], s62 offen lds
    s_add_u32 m0, s99, 34816
    s_mov_b32 s62, 1638400
    buffer_load_dwordx4 v77, s[16:19], s62 offen lds
    s_add_u32 m0, s99, 35840
    s_mov_b32 s62, 1671168
    buffer_load_dwordx4 v77, s[16:19], s62 offen lds
    v_add_u32 v11, 49152, v78
    ds_read_b64_tr_b16 v[128:129], v11 offset:0
    ds_read_b64_tr_b16 v[130:131], v11 offset:1024
    ds_read_b64_tr_b16 v[132:133], v11 offset:8
    ds_read_b64_tr_b16 v[134:135], v11 offset:1032
    ds_read_b64_tr_b16 v[152:153], v11 offset:8192
    ds_read_b64_tr_b16 v[154:155], v11 offset:9216
    ds_read_b64_tr_b16 v[156:157], v11 offset:8200
    ds_read_b64_tr_b16 v[158:159], v11 offset:9224
    s_waitcnt lgkmcnt(0)
    s_waitcnt vmcnt(28)
    s_barrier
    s_add_u32 m0, s99, 49152
    s_mov_b32 s62, 2097152
    buffer_load_dwordx4 v77, s[8:11], s62 offen lds
    s_add_u32 m0, s99, 50176
    s_mov_b32 s62, 2129920
    buffer_load_dwordx4 v77, s[8:11], s62 offen lds
    s_add_u32 m0, s99, 51200
    s_mov_b32 s62, 2162688
    buffer_load_dwordx4 v77, s[8:11], s62 offen lds
    s_add_u32 m0, s99, 52224
    s_mov_b32 s62, 2195456
    buffer_load_dwordx4 v77, s[8:11], s62 offen lds
    v_add_u32 v11, 65536, v78
    ds_read_b64_tr_b16 v[136:137], v11 offset:0
    ds_read_b64_tr_b16 v[138:139], v11 offset:1024
    ds_read_b64_tr_b16 v[140:141], v11 offset:8
    ds_read_b64_tr_b16 v[142:143], v11 offset:1032
    ds_read_b64_tr_b16 v[160:161], v11 offset:8192
    ds_read_b64_tr_b16 v[162:163], v11 offset:9216
    ds_read_b64_tr_b16 v[164:165], v11 offset:8200
    ds_read_b64_tr_b16 v[166:167], v11 offset:9224
    s_waitcnt lgkmcnt(0)
    s_waitcnt vmcnt(28)
    s_barrier
    s_add_u32 m0, s99, 65536
    s_mov_b32 s62, 2097152
    buffer_load_dwordx4 v77, s[12:15], s62 offen lds
    s_add_u32 m0, s99, 66560
    s_mov_b32 s62, 2129920
    buffer_load_dwordx4 v77, s[12:15], s62 offen lds
    s_add_u32 m0, s99, 67584
    s_mov_b32 s62, 2162688
    buffer_load_dwordx4 v77, s[12:15], s62 offen lds
    s_add_u32 m0, s99, 68608
    s_mov_b32 s62, 2195456
    buffer_load_dwordx4 v77, s[12:15], s62 offen lds
    v_add_u32 v11, 81920, v78
    ds_read_b64_tr_b16 v[144:145], v11 offset:0
    ds_read_b64_tr_b16 v[146:147], v11 offset:1024
    ds_read_b64_tr_b16 v[148:149], v11 offset:8
    ds_read_b64_tr_b16 v[150:151], v11 offset:1032
    ds_read_b64_tr_b16 v[168:169], v11 offset:8192
    ds_read_b64_tr_b16 v[170:171], v11 offset:9216
    ds_read_b64_tr_b16 v[172:173], v11 offset:8200
    ds_read_b64_tr_b16 v[174:175], v11 offset:9224
    s_waitcnt lgkmcnt(0)
    s_waitcnt vmcnt(28)
    s_barrier
    s_add_u32 m0, s99, 81920
    s_mov_b32 s62, 2097152
    buffer_load_dwordx4 v77, s[16:19], s62 offen lds
    s_add_u32 m0, s99, 82944
    s_mov_b32 s62, 2129920
    buffer_load_dwordx4 v77, s[16:19], s62 offen lds
    s_add_u32 m0, s99, 83968
    s_mov_b32 s62, 2162688
    buffer_load_dwordx4 v77, s[16:19], s62 offen lds
    s_add_u32 m0, s99, 84992
    s_mov_b32 s62, 2195456
    buffer_load_dwordx4 v77, s[16:19], s62 offen lds
    v_add_u32 v11, 98304, v78
    ds_read_b64_tr_b16 v[176:177], v11 offset:0
    ds_read_b64_tr_b16 v[178:179], v11 offset:1024
    ds_read_b64_tr_b16 v[180:181], v11 offset:8
    ds_read_b64_tr_b16 v[182:183], v11 offset:1032
    ds_read_b64_tr_b16 v[200:201], v11 offset:8192
    ds_read_b64_tr_b16 v[202:203], v11 offset:9216
    ds_read_b64_tr_b16 v[204:205], v11 offset:8200
    ds_read_b64_tr_b16 v[206:207], v11 offset:9224
    s_waitcnt lgkmcnt(0)
    s_waitcnt vmcnt(28)
    s_barrier
    s_add_u32 m0, s99, 98304
    s_mov_b32 s62, 2621440
    buffer_load_dwordx4 v77, s[8:11], s62 offen lds
    s_add_u32 m0, s99, 99328
    s_mov_b32 s62, 2654208
    buffer_load_dwordx4 v77, s[8:11], s62 offen lds
    s_add_u32 m0, s99, 100352
    s_mov_b32 s62, 2686976
    buffer_load_dwordx4 v77, s[8:11], s62 offen lds
    s_add_u32 m0, s99, 101376
    s_mov_b32 s62, 2719744
    buffer_load_dwordx4 v77, s[8:11], s62 offen lds
    v_add_u32 v11, 114688, v78
    ds_read_b64_tr_b16 v[184:185], v11 offset:0
    ds_read_b64_tr_b16 v[186:187], v11 offset:1024
    ds_read_b64_tr_b16 v[188:189], v11 offset:8
    ds_read_b64_tr_b16 v[190:191], v11 offset:1032
    ds_read_b64_tr_b16 v[208:209], v11 offset:8192
    ds_read_b64_tr_b16 v[210:211], v11 offset:9216
    ds_read_b64_tr_b16 v[212:213], v11 offset:8200
    ds_read_b64_tr_b16 v[214:215], v11 offset:9224
    s_waitcnt lgkmcnt(0)
    s_waitcnt vmcnt(28)
    s_barrier
    s_add_u32 m0, s99, 114688
    s_mov_b32 s62, 2621440
    buffer_load_dwordx4 v77, s[12:15], s62 offen lds
    s_add_u32 m0, s99, 115712
    s_mov_b32 s62, 2654208
    buffer_load_dwordx4 v77, s[12:15], s62 offen lds
    s_add_u32 m0, s99, 116736
    s_mov_b32 s62, 2686976
    buffer_load_dwordx4 v77, s[12:15], s62 offen lds
    s_add_u32 m0, s99, 117760
    s_mov_b32 s62, 2719744
    buffer_load_dwordx4 v77, s[12:15], s62 offen lds
    v_add_u32 v11, 131072, v78
    ds_read_b64_tr_b16 v[192:193], v11 offset:0
    ds_read_b64_tr_b16 v[194:195], v11 offset:1024
    ds_read_b64_tr_b16 v[196:197], v11 offset:8
    ds_read_b64_tr_b16 v[198:199], v11 offset:1032
    ds_read_b64_tr_b16 v[216:217], v11 offset:8192
    ds_read_b64_tr_b16 v[218:219], v11 offset:9216
    ds_read_b64_tr_b16 v[220:221], v11 offset:8200
    ds_read_b64_tr_b16 v[222:223], v11 offset:9224
    s_waitcnt lgkmcnt(0)
    s_waitcnt vmcnt(28)
    s_barrier
    s_add_u32 m0, s99, 131072
    s_mov_b32 s62, 2621440
    buffer_load_dwordx4 v77, s[16:19], s62 offen lds
    s_add_u32 m0, s99, 132096
    s_mov_b32 s62, 2654208
    buffer_load_dwordx4 v77, s[16:19], s62 offen lds
    s_add_u32 m0, s99, 133120
    s_mov_b32 s62, 2686976
    buffer_load_dwordx4 v77, s[16:19], s62 offen lds
    s_add_u32 m0, s99, 134144
    s_mov_b32 s62, 2719744
    buffer_load_dwordx4 v77, s[16:19], s62 offen lds
    v_add_u32 v11, 0, v78
    ds_read_b64_tr_b16 v[224:225], v11 offset:0
    ds_read_b64_tr_b16 v[226:227], v11 offset:1024
    ds_read_b64_tr_b16 v[228:229], v11 offset:8
    ds_read_b64_tr_b16 v[230:231], v11 offset:1032
    ds_read_b64_tr_b16 v[248:249], v11 offset:8192
    ds_read_b64_tr_b16 v[250:251], v11 offset:9216
    ds_read_b64_tr_b16 v[252:253], v11 offset:8200
    ds_read_b64_tr_b16 v[254:255], v11 offset:9224
    s_waitcnt lgkmcnt(0)
    s_waitcnt vmcnt(28)
    s_barrier
    s_add_u32 m0, s99, 0
    s_mov_b32 s62, 3145728
    buffer_load_dwordx4 v77, s[8:11], s62 offen lds
    s_add_u32 m0, s99, 1024
    s_mov_b32 s62, 3178496
    buffer_load_dwordx4 v77, s[8:11], s62 offen lds
    s_add_u32 m0, s99, 2048
    s_mov_b32 s62, 3211264
    buffer_load_dwordx4 v77, s[8:11], s62 offen lds
    s_add_u32 m0, s99, 3072
    s_mov_b32 s62, 3244032
    buffer_load_dwordx4 v77, s[8:11], s62 offen lds
    v_add_u32 v11, 16384, v78
    ds_read_b64_tr_b16 v[232:233], v11 offset:0
    ds_read_b64_tr_b16 v[234:235], v11 offset:1024
    ds_read_b64_tr_b16 v[236:237], v11 offset:8
    ds_read_b64_tr_b16 v[238:239], v11 offset:1032
    ds_read_b64_tr_b16 a[0:1], v11 offset:8192
    ds_read_b64_tr_b16 a[2:3], v11 offset:9216
    ds_read_b64_tr_b16 a[4:5], v11 offset:8200
    ds_read_b64_tr_b16 a[6:7], v11 offset:9224
    s_waitcnt lgkmcnt(0)
    s_waitcnt vmcnt(28)
    s_barrier
    s_add_u32 m0, s99, 16384
    s_mov_b32 s62, 3145728
    buffer_load_dwordx4 v77, s[12:15], s62 offen lds
    s_add_u32 m0, s99, 17408
    s_mov_b32 s62, 3178496
    buffer_load_dwordx4 v77, s[12:15], s62 offen lds
    s_add_u32 m0, s99, 18432
    s_mov_b32 s62, 3211264
    buffer_load_dwordx4 v77, s[12:15], s62 offen lds
    s_add_u32 m0, s99, 19456
    s_mov_b32 s62, 3244032
    buffer_load_dwordx4 v77, s[12:15], s62 offen lds
    v_add_u32 v11, 32768, v78
    ds_read_b64_tr_b16 v[240:241], v11 offset:0
    ds_read_b64_tr_b16 v[242:243], v11 offset:1024
    ds_read_b64_tr_b16 v[244:245], v11 offset:8
    ds_read_b64_tr_b16 v[246:247], v11 offset:1032
    ds_read_b64_tr_b16 a[8:9], v11 offset:8192
    ds_read_b64_tr_b16 a[10:11], v11 offset:9216
    ds_read_b64_tr_b16 a[12:13], v11 offset:8200
    ds_read_b64_tr_b16 a[14:15], v11 offset:9224
    s_waitcnt lgkmcnt(0)
    s_waitcnt vmcnt(28)
    s_barrier
    s_add_u32 m0, s99, 32768
    s_mov_b32 s62, 3145728
    buffer_load_dwordx4 v77, s[16:19], s62 offen lds
    s_add_u32 m0, s99, 33792
    s_mov_b32 s62, 3178496
    buffer_load_dwordx4 v77, s[16:19], s62 offen lds
    s_add_u32 m0, s99, 34816
    s_mov_b32 s62, 3211264
    buffer_load_dwordx4 v77, s[16:19], s62 offen lds
    s_add_u32 m0, s99, 35840
    s_mov_b32 s62, 3244032
    buffer_load_dwordx4 v77, s[16:19], s62 offen lds
    v_add_u32 v11, 49152, v78
    ds_read_b64_tr_b16 a[16:17], v11 offset:0
    ds_read_b64_tr_b16 a[18:19], v11 offset:1024
    ds_read_b64_tr_b16 a[20:21], v11 offset:8
    ds_read_b64_tr_b16 a[22:23], v11 offset:1032
    ds_read_b64_tr_b16 a[40:41], v11 offset:8192
    ds_read_b64_tr_b16 a[42:43], v11 offset:9216
    ds_read_b64_tr_b16 a[44:45], v11 offset:8200
    ds_read_b64_tr_b16 a[46:47], v11 offset:9224
    s_waitcnt lgkmcnt(0)
    s_waitcnt vmcnt(28)
    s_barrier
    s_add_u32 m0, s99, 49152
    s_mov_b32 s62, 3670016
    buffer_load_dwordx4 v77, s[8:11], s62 offen lds
    s_add_u32 m0, s99, 50176
    s_mov_b32 s62, 3702784
    buffer_load_dwordx4 v77, s[8:11], s62 offen lds
    s_add_u32 m0, s99, 51200
    s_mov_b32 s62, 3735552
    buffer_load_dwordx4 v77, s[8:11], s62 offen lds
    s_add_u32 m0, s99, 52224
    s_mov_b32 s62, 3768320
    buffer_load_dwordx4 v77, s[8:11], s62 offen lds
    v_add_u32 v11, 65536, v78
    ds_read_b64_tr_b16 a[24:25], v11 offset:0
    ds_read_b64_tr_b16 a[26:27], v11 offset:1024
    ds_read_b64_tr_b16 a[28:29], v11 offset:8
    ds_read_b64_tr_b16 a[30:31], v11 offset:1032
    ds_read_b64_tr_b16 a[48:49], v11 offset:8192
    ds_read_b64_tr_b16 a[50:51], v11 offset:9216
    ds_read_b64_tr_b16 a[52:53], v11 offset:8200
    ds_read_b64_tr_b16 a[54:55], v11 offset:9224
    s_waitcnt lgkmcnt(0)
    s_waitcnt vmcnt(28)
    s_barrier
    s_add_u32 m0, s99, 65536
    s_mov_b32 s62, 3670016
    buffer_load_dwordx4 v77, s[12:15], s62 offen lds
    s_add_u32 m0, s99, 66560
    s_mov_b32 s62, 3702784
    buffer_load_dwordx4 v77, s[12:15], s62 offen lds
    s_add_u32 m0, s99, 67584
    s_mov_b32 s62, 3735552
    buffer_load_dwordx4 v77, s[12:15], s62 offen lds
    s_add_u32 m0, s99, 68608
    s_mov_b32 s62, 3768320
    buffer_load_dwordx4 v77, s[12:15], s62 offen lds
    v_add_u32 v11, 81920, v78
    ds_read_b64_tr_b16 a[32:33], v11 offset:0
    ds_read_b64_tr_b16 a[34:35], v11 offset:1024
    ds_read_b64_tr_b16 a[36:37], v11 offset:8
    ds_read_b64_tr_b16 a[38:39], v11 offset:1032
    ds_read_b64_tr_b16 a[56:57], v11 offset:8192
    ds_read_b64_tr_b16 a[58:59], v11 offset:9216
    ds_read_b64_tr_b16 a[60:61], v11 offset:8200
    ds_read_b64_tr_b16 a[62:63], v11 offset:9224
    s_waitcnt lgkmcnt(0)
    s_waitcnt vmcnt(28)
    s_barrier
    s_add_u32 m0, s99, 81920
    s_mov_b32 s62, 3670016
    buffer_load_dwordx4 v77, s[16:19], s62 offen lds
    s_add_u32 m0, s99, 82944
    s_mov_b32 s62, 3702784
    buffer_load_dwordx4 v77, s[16:19], s62 offen lds
    s_add_u32 m0, s99, 83968
    s_mov_b32 s62, 3735552
    buffer_load_dwordx4 v77, s[16:19], s62 offen lds
    s_add_u32 m0, s99, 84992
    s_mov_b32 s62, 3768320
    buffer_load_dwordx4 v77, s[16:19], s62 offen lds
    v_add_u32 v11, 98304, v78
    ds_read_b64_tr_b16 a[64:65], v11 offset:0
    ds_read_b64_tr_b16 a[66:67], v11 offset:1024
    ds_read_b64_tr_b16 a[68:69], v11 offset:8
    ds_read_b64_tr_b16 a[70:71], v11 offset:1032
    ds_read_b64_tr_b16 a[88:89], v11 offset:8192
    ds_read_b64_tr_b16 a[90:91], v11 offset:9216
    ds_read_b64_tr_b16 a[92:93], v11 offset:8200
    ds_read_b64_tr_b16 a[94:95], v11 offset:9224
    s_waitcnt lgkmcnt(0)
    s_waitcnt vmcnt(28)
    s_barrier
    s_add_u32 m0, s99, 98304
    s_mov_b32 s62, 4194304
    buffer_load_dwordx4 v77, s[8:11], s62 offen lds
    s_add_u32 m0, s99, 99328
    s_mov_b32 s62, 4227072
    buffer_load_dwordx4 v77, s[8:11], s62 offen lds
    s_add_u32 m0, s99, 100352
    s_mov_b32 s62, 4259840
    buffer_load_dwordx4 v77, s[8:11], s62 offen lds
    s_add_u32 m0, s99, 101376
    s_mov_b32 s62, 4292608
    buffer_load_dwordx4 v77, s[8:11], s62 offen lds
    v_add_u32 v11, 114688, v78
    ds_read_b64_tr_b16 a[72:73], v11 offset:0
    ds_read_b64_tr_b16 a[74:75], v11 offset:1024
    ds_read_b64_tr_b16 a[76:77], v11 offset:8
    ds_read_b64_tr_b16 a[78:79], v11 offset:1032
    ds_read_b64_tr_b16 a[96:97], v11 offset:8192
    ds_read_b64_tr_b16 a[98:99], v11 offset:9216
    ds_read_b64_tr_b16 a[100:101], v11 offset:8200
    ds_read_b64_tr_b16 a[102:103], v11 offset:9224
    s_waitcnt lgkmcnt(0)
    s_waitcnt vmcnt(28)
    s_barrier
    s_add_u32 m0, s99, 114688
    s_mov_b32 s62, 4194304
    buffer_load_dwordx4 v77, s[12:15], s62 offen lds
    s_add_u32 m0, s99, 115712
    s_mov_b32 s62, 4227072
    buffer_load_dwordx4 v77, s[12:15], s62 offen lds
    s_add_u32 m0, s99, 116736
    s_mov_b32 s62, 4259840
    buffer_load_dwordx4 v77, s[12:15], s62 offen lds
    s_add_u32 m0, s99, 117760
    s_mov_b32 s62, 4292608
    buffer_load_dwordx4 v77, s[12:15], s62 offen lds
    v_add_u32 v11, 131072, v78
    ds_read_b64_tr_b16 a[80:81], v11 offset:0
    ds_read_b64_tr_b16 a[82:83], v11 offset:1024
    ds_read_b64_tr_b16 a[84:85], v11 offset:8
    ds_read_b64_tr_b16 a[86:87], v11 offset:1032
    ds_read_b64_tr_b16 a[104:105], v11 offset:8192
    ds_read_b64_tr_b16 a[106:107], v11 offset:9216
    ds_read_b64_tr_b16 a[108:109], v11 offset:8200
    ds_read_b64_tr_b16 a[110:111], v11 offset:9224
    s_waitcnt lgkmcnt(0)
    s_waitcnt vmcnt(28)
    s_barrier
    s_add_u32 m0, s99, 131072
    s_mov_b32 s62, 4194304
    buffer_load_dwordx4 v77, s[16:19], s62 offen lds
    s_add_u32 m0, s99, 132096
    s_mov_b32 s62, 4227072
    buffer_load_dwordx4 v77, s[16:19], s62 offen lds
    s_add_u32 m0, s99, 133120
    s_mov_b32 s62, 4259840
    buffer_load_dwordx4 v77, s[16:19], s62 offen lds
    s_add_u32 m0, s99, 134144
    s_mov_b32 s62, 4292608
    buffer_load_dwordx4 v77, s[16:19], s62 offen lds
    v_add_u32 v11, 0, v78
    ds_read_b64_tr_b16 a[112:113], v11 offset:0
    ds_read_b64_tr_b16 a[114:115], v11 offset:1024
    ds_read_b64_tr_b16 a[116:117], v11 offset:8
    ds_read_b64_tr_b16 a[118:119], v11 offset:1032
    ds_read_b64_tr_b16 a[136:137], v11 offset:8192
    ds_read_b64_tr_b16 a[138:139], v11 offset:9216
    ds_read_b64_tr_b16 a[140:141], v11 offset:8200
    ds_read_b64_tr_b16 a[142:143], v11 offset:9224
    s_waitcnt lgkmcnt(0)
    s_waitcnt vmcnt(28)
    s_barrier
    v_add_u32 v11, 16384, v78
    ds_read_b64_tr_b16 a[120:121], v11 offset:0
    ds_read_b64_tr_b16 a[122:123], v11 offset:1024
    ds_read_b64_tr_b16 a[124:125], v11 offset:8
    ds_read_b64_tr_b16 a[126:127], v11 offset:1032
    ds_read_b64_tr_b16 a[144:145], v11 offset:8192
    ds_read_b64_tr_b16 a[146:147], v11 offset:9216
    ds_read_b64_tr_b16 a[148:149], v11 offset:8200
    ds_read_b64_tr_b16 a[150:151], v11 offset:9224
    s_waitcnt lgkmcnt(0)
    s_waitcnt vmcnt(24)
    s_barrier
    v_add_u32 v11, 32768, v78
    ds_read_b64_tr_b16 a[128:129], v11 offset:0
    ds_read_b64_tr_b16 a[130:131], v11 offset:1024
    ds_read_b64_tr_b16 a[132:133], v11 offset:8
    ds_read_b64_tr_b16 a[134:135], v11 offset:1032
    ds_read_b64_tr_b16 a[152:153], v11 offset:8192
    ds_read_b64_tr_b16 a[154:155], v11 offset:9216
    ds_read_b64_tr_b16 a[156:157], v11 offset:8200
    ds_read_b64_tr_b16 a[158:159], v11 offset:9224
    s_waitcnt lgkmcnt(0)
    s_waitcnt vmcnt(20)
    s_barrier
    v_add_u32 v11, 49152, v78
    ds_read_b64_tr_b16 a[160:161], v11 offset:0
    ds_read_b64_tr_b16 a[162:163], v11 offset:1024
    ds_read_b64_tr_b16 a[164:165], v11 offset:8
    ds_read_b64_tr_b16 a[166:167], v11 offset:1032
    ds_read_b64_tr_b16 a[184:185], v11 offset:8192
    ds_read_b64_tr_b16 a[186:187], v11 offset:9216
    ds_read_b64_tr_b16 a[188:189], v11 offset:8200
    ds_read_b64_tr_b16 a[190:191], v11 offset:9224
    s_waitcnt lgkmcnt(0)
    s_waitcnt vmcnt(16)
    s_barrier
    v_add_u32 v11, 65536, v78
    ds_read_b64_tr_b16 a[168:169], v11 offset:0
    ds_read_b64_tr_b16 a[170:171], v11 offset:1024
    ds_read_b64_tr_b16 a[172:173], v11 offset:8
    ds_read_b64_tr_b16 a[174:175], v11 offset:1032
    ds_read_b64_tr_b16 a[192:193], v11 offset:8192
    ds_read_b64_tr_b16 a[194:195], v11 offset:9216
    ds_read_b64_tr_b16 a[196:197], v11 offset:8200
    ds_read_b64_tr_b16 a[198:199], v11 offset:9224
    s_waitcnt lgkmcnt(0)
    s_waitcnt vmcnt(12)
    s_barrier
    v_add_u32 v11, 81920, v78
    ds_read_b64_tr_b16 a[176:177], v11 offset:0
    ds_read_b64_tr_b16 a[178:179], v11 offset:1024
    ds_read_b64_tr_b16 a[180:181], v11 offset:8
    ds_read_b64_tr_b16 a[182:183], v11 offset:1032
    ds_read_b64_tr_b16 a[200:201], v11 offset:8192
    ds_read_b64_tr_b16 a[202:203], v11 offset:9216
    ds_read_b64_tr_b16 a[204:205], v11 offset:8200
    ds_read_b64_tr_b16 a[206:207], v11 offset:9224
    s_waitcnt lgkmcnt(0)
    s_waitcnt vmcnt(8)
    s_barrier
    v_add_u32 v11, 98304, v78
    ds_read_b64_tr_b16 a[208:209], v11 offset:0
    ds_read_b64_tr_b16 a[210:211], v11 offset:1024
    ds_read_b64_tr_b16 a[212:213], v11 offset:8
    ds_read_b64_tr_b16 a[214:215], v11 offset:1032
    ds_read_b64_tr_b16 a[232:233], v11 offset:8192
    ds_read_b64_tr_b16 a[234:235], v11 offset:9216
    ds_read_b64_tr_b16 a[236:237], v11 offset:8200
    ds_read_b64_tr_b16 a[238:239], v11 offset:9224
    s_waitcnt lgkmcnt(0)
    s_waitcnt vmcnt(4)
    s_barrier
    v_add_u32 v11, 114688, v78
    ds_read_b64_tr_b16 a[216:217], v11 offset:0
    ds_read_b64_tr_b16 a[218:219], v11 offset:1024
    ds_read_b64_tr_b16 a[220:221], v11 offset:8
    ds_read_b64_tr_b16 a[222:223], v11 offset:1032
    ds_read_b64_tr_b16 a[240:241], v11 offset:8192
    ds_read_b64_tr_b16 a[242:243], v11 offset:9216
    ds_read_b64_tr_b16 a[244:245], v11 offset:8200
    ds_read_b64_tr_b16 a[246:247], v11 offset:9224
    s_waitcnt lgkmcnt(0)
    s_waitcnt vmcnt(0)
    s_barrier
    v_add_u32 v11, 131072, v78
    ds_read_b64_tr_b16 a[224:225], v11 offset:0
    ds_read_b64_tr_b16 a[226:227], v11 offset:1024
    ds_read_b64_tr_b16 a[228:229], v11 offset:8
    ds_read_b64_tr_b16 a[230:231], v11 offset:1032
    ds_read_b64_tr_b16 a[248:249], v11 offset:8192
    ds_read_b64_tr_b16 a[250:251], v11 offset:9216
    ds_read_b64_tr_b16 a[252:253], v11 offset:8200
    ds_read_b64_tr_b16 a[254:255], v11 offset:9224
    s_waitcnt lgkmcnt(0)
    s_barrier
L_wf_64:
    buffer_load_dword v5, off, s[28:31], 0 offset:144 sc1
    s_waitcnt vmcnt(0)
    v_cmp_eq_u32 vcc, 0, v5
    s_cbranch_vccz L_wfok_65
    s_sleep 2
    s_sub_u32 s37, s37, 1
    s_cbranch_scc0 L_wf_64
    s_mov_b32 s37, 0
L_wfok_65:
    s_mov_b32 s60, 81788928
L_wf_66:
    buffer_load_dword v5, off, s[4:7], s60 offset:128 sc1
    s_waitcnt vmcnt(0)
    v_cmp_eq_u32 vcc, 0, v5
    s_cbranch_vccz L_wfok_67
    s_sleep 2
    s_sub_u32 s37, s37, 1
    s_cbranch_scc0 L_wf_66
    s_mov_b32 s37, 0
L_wfok_67:
    v_lshrrev_b32 v5, 3, v1
    v_xor_b32 v10, v5, v1
    v_and_b32 v10, 7, v10
    v_mul_u32_u24 v9, 1152, v5
    v_lshl_add_u32 v9, v10, 4, v9
    s_mul_i32 s39, s33, 9216
    v_add_u32 v9, s39, v9
    v_and_b32 v5, 7, v1
    v_xor_b32 v10, v2, v5
    v_lshlrev_b32 v10, 4, v10
    v_lshl_add_u32 v10, v5, 7, v10
    v_bfe_u32 v5, v1, 3, 1
    v_mul_u32_u24 v5, 9216, v5
    v_add_u32 v10, v10, v5
    v_xor_b32 v11, 64, v10
    s_mov_b32 s36, s35
    s_mul_i32 s38, s36, 36864
    s_add_u32 s38, s38, 71303168
    s_lshl_b32 s60, s36, 5
    s_add_u32 s60, s60, s34
    s_lshl_b32 s61, s33, 10
    s_lshl_b32 s40, s60, 13
    s_add_u32 s40, s40, s61
    s_add_u32 s40, s40, 33554432
    s_lshl_b32 s41, s60, 14
    s_add_u32 s41, s41, s61
    s_mov_b32 s42, 0x40000000
    s_add_u32 m0, s39, 0
    s_nop 0
    buffer_load_dwordx4 v9, s[4:7], s38 offen offset:0 sc1 lds
    s_add_u32 m0, s39, 896
    s_nop 0
    buffer_load_dwordx4 v9, s[4:7], s38 offen offset:128 sc1 lds
    s_add_u32 m0, s39, 1792
    s_nop 0
    buffer_load_dwordx4 v9, s[4:7], s38 offen offset:256 sc1 lds
    s_add_u32 m0, s39, 2688
    s_nop 0
    buffer_load_dwordx4 v9, s[4:7], s38 offen offset:384 sc1 lds
    s_add_u32 m0, s39, 3584
    s_nop 0
    buffer_load_dwordx4 v9, s[4:7], s38 offen offset:512 sc1 lds
    s_add_u32 m0, s39, 4480
    s_nop 0
    buffer_load_dwordx4 v9, s[4:7], s38 offen offset:640 sc1 lds
    s_add_u32 m0, s39, 5376
    s_nop 0
    buffer_load_dwordx4 v9, s[4:7], s38 offen offset:768 sc1 lds
    s_add_u32 m0, s39, 6272
    s_nop 0
    buffer_load_dwordx4 v9, s[4:7], s38 offen offset:896 sc1 lds
    s_add_u32 m0, s39, 7168
    s_nop 0
    buffer_load_dwordx4 v9, s[4:7], s38 offen offset:1024 sc1 lds
    s_waitcnt vmcnt(0)
L_qkv_68:
    s_cmp_ge_u32 s36, 14
    s_cbranch_scc1 L_q1_70
    s_waitcnt vmcnt(0)
    s_barrier
    s_cmp_lg_u32 s33, 0
    s_cbranch_scc1 L_sf_72
    s_mov_b64 exec, 1
    v_mov_b32 v5, 1
    buffer_store_dword v5, off, s[4:7], s42 sc1
    s_mov_b64 exec, -1
L_sf_72:
    s_branch L_q2_71
L_q1_70:
    s_waitcnt vmcnt(7)
    s_barrier
L_q2_71:
    s_xor_b32 s39, s39, 0x10000
    s_add_u32 s38, s38, 258048
    s_add_u32 m0, s39, 0
    s_nop 0
    buffer_load_dwordx4 v9, s[4:7], s38 offen offset:0 sc1 lds
    s_add_u32 m0, s39, 896
    s_nop 0
    buffer_load_dwordx4 v9, s[4:7], s38 offen offset:128 sc1 lds
    s_add_u32 m0, s39, 1792
    s_nop 0
    buffer_load_dwordx4 v9, s[4:7], s38 offen offset:256 sc1 lds
    s_add_u32 m0, s39, 2688
    s_nop 0
    buffer_load_dwordx4 v9, s[4:7], s38 offen offset:384 sc1 lds
    s_add_u32 m0, s39, 3584
    s_nop 0
    buffer_load_dwordx4 v9, s[4:7], s38 offen offset:512 sc1 lds
    s_add_u32 m0, s39, 4480
    s_nop 0
    buffer_load_dwordx4 v9, s[4:7], s38 offen offset:640 sc1 lds
    s_add_u32 m0, s39, 5376
    s_nop 0
    buffer_load_dwordx4 v9, s[4:7], s38 offen offset:768 sc1 lds
    s_add_u32 m0, s39, 6272
    s_nop 0
    buffer_load_dwordx4 v9, s[4:7], s38 offen offset:896 sc1 lds
    s_add_u32 m0, s39, 7168
    s_nop 0
    buffer_load_dwordx4 v9, s[4:7], s38 offen offset:1024 sc1 lds
    ds_read_b128 v[16:19], v10 offset:0
    ds_read_b128 v[20:23], v10 offset:18432
    s_waitcnt lgkmcnt(0)
    v_mfma_f32_16x16x32_bf16 v[32:35], v[80:83], v[16:19], 0
    ds_read_b128 v[24:27], v11 offset:0
    ds_read_b128 v[28:31], v11 offset:18432
    v_mfma_f32_16x16x32_bf16 v[36:39], v[80:83], v[20:23], 0
    v_mfma_f32_16x16x32_bf16 v[40:43], v[84:87], v[16:19], 0
    v_mfma_f32_16x16x32_bf16 v[44:47], v[84:87], v[20:23], 0
    v_mfma_f32_16x16x32_bf16 v[48:51], v[88:91], v[16:19], 0
    v_mfma_f32_16x16x32_bf16 v[52:55], v[88:91], v[20:23], 0
    v_mfma_f32_16x16x32_bf16 v[56:59], v[92:95], v[16:19], 0
    v_mfma_f32_16x16x32_bf16 v[60:63], v[92:95], v[20:23], 0
    v_mfma_f32_16x16x32_bf16 v[64:67], v[16:19], v[96:99], 0
    v_mfma_f32_16x16x32_bf16 v[68:71], v[20:23], v[96:99], 0
    v_mfma_f32_16x16x32_bf16 v[72:75], v[16:19], v[100:103], 0
    v_mfma_f32_16x16x32_bf16 v[76:79], v[20:23], v[100:103], 0
    s_waitcnt lgkmcnt(0)
    v_mfma_f32_16x16x32_bf16 v[32:35], v[104:107], v[24:27], v[32:35]
    ds_read_b128 v[16:19], v10 offset:1024
    ds_read_b128 v[20:23], v10 offset:19456
    v_mfma_f32_16x16x32_bf16 v[36:39], v[104:107], v[28:31], v[36:39]
    v_mfma_f32_16x16x32_bf16 v[40:43], v[108:111], v[24:27], v[40:43]
    v_mfma_f32_16x16x32_bf16 v[44:47], v[108:111], v[28:31], v[44:47]
    v_mfma_f32_16x16x32_bf16 v[48:51], v[112:115], v[24:27], v[48:51]
    v_mfma_f32_16x16x32_bf16 v[52:55], v[112:115], v[28:31], v[52:55]
    v_mfma_f32_16x16x32_bf16 v[56:59], v[116:119], v[24:27], v[56:59]
    v_mfma_f32_16x16x32_bf16 v[60:63], v[116:119], v[28:31], v[60:63]
    v_mfma_f32_16x16x32_bf16 v[64:67], v[24:27], v[120:123], v[64:67]
    v_mfma_f32_16x16x32_bf16 v[68:71], v[28:31], v[120:123], v[68:71]
    v_mfma_f32_16x16x32_bf16 v[72:75], v[24:27], v[124:127], v[72:75]
    v_mfma_f32_16x16x32_bf16 v[76:79], v[28:31], v[124:127], v[76:79]
    s_waitcnt lgkmcnt(0)
    v_mfma_f32_16x16x32_bf16 v[32:35], v[128:131], v[16:19], v[32:35]
    ds_read_b128 v[24:27], v11 offset:1024
    ds_read_b128 v[28:31], v11 offset:19456
    v_mfma_f32_16x16x32_bf16 v[36:39], v[128:131], v[20:23], v[36:39]
    v_mfma_f32_16x16x32_bf16 v[40:43], v[132:135], v[16:19], v[40:43]
    v_mfma_f32_16x16x32_bf16 v[44:47], v[132:135], v[20:23], v[44:47]
    v_mfma_f32_16x16x32_bf16 v[48:51], v[136:139], v[16:19], v[48:51]
    v_mfma_f32_16x16x32_bf16 v[52:55], v[136:139], v[20:23], v[52:55]
    v_mfma_f32_16x16x32_bf16 v[56:59], v[140:143], v[16:19], v[56:59]
    v_mfma_f32_16x16x32_bf16 v[60:63], v[140:143], v[20:23], v[60:63]
    v_mfma_f32_16x16x32_bf16 v[64:67], v[16:19], v[144:147], v[64:67]
    v_mfma_f32_16x16x32_bf16 v[68:71], v[20:23], v[144:147], v[68:71]
    v_mfma_f32_16x16x32_bf16 v[72:75], v[16:19], v[148:151], v[72:75]
    v_mfma_f32_16x16x32_bf16 v[76:79], v[20:23], v[148:151], v[76:79]
    s_waitcnt lgkmcnt(0)
    v_mfma_f32_16x16x32_bf16 v[32:35], v[152:155], v[24:27], v[32:35]
    ds_read_b128 v[16:19], v10 offset:2048
    ds_read_b128 v[20:23], v10 offset:20480
    v_mfma_f32_16x16x32_bf16 v[36:39], v[152:155], v[28:31], v[36:39]
    v_mfma_f32_16x16x32_bf16 v[40:43], v[156:159], v[24:27], v[40:43]
    v_mfma_f32_16x16x32_bf16 v[44:47], v[156:159], v[28:31], v[44:47]
    v_mfma_f32_16x16x32_bf16 v[48:51], v[160:163], v[24:27], v[48:51]
    v_mfma_f32_16x16x32_bf16 v[52:55], v[160:163], v[28:31], v[52:55]
    v_mfma_f32_16x16x32_bf16 v[56:59], v[164:167], v[24:27], v[56:59]
    v_mfma_f32_16x16x32_bf16 v[60:63], v[164:167], v[28:31], v[60:63]
    v_mfma_f32_16x16x32_bf16 v[64:67], v[24:27], v[168:171], v[64:67]
    v_mfma_f32_16x16x32_bf16 v[68:71], v[28:31], v[168:171], v[68:71]
    v_mfma_f32_16x16x32_bf16 v[72:75], v[24:27], v[172:175], v[72:75]
    v_mfma_f32_16x16x32_bf16 v[76:79], v[28:31], v[172:175], v[76:79]
    s_waitcnt lgkmcnt(0)
    v_mfma_f32_16x16x32_bf16 v[32:35], v[176:179], v[16:19], v[32:35]
    ds_read_b128 v[24:27], v11 offset:2048
    ds_read_b128 v[28:31], v11 offset:20480
    v_mfma_f32_16x16x32_bf16 v[36:39], v[176:179], v[20:23], v[36:39]
    v_mfma_f32_16x16x32_bf16 v[40:43], v[180:183], v[16:19], v[40:43]
    v_mfma_f32_16x16x32_bf16 v[44:47], v[180:183], v[20:23], v[44:47]
    v_mfma_f32_16x16x32_bf16 v[48:51], v[184:187], v[16:19], v[48:51]
    v_mfma_f32_16x16x32_bf16 v[52:55], v[184:187], v[20:23], v[52:55]
    v_mfma_f32_16x16x32_bf16 v[56:59], v[188:191], v[16:19], v[56:59]
    v_mfma_f32_16x16x32_bf16 v[60:63], v[188:191], v[20:23], v[60:63]
    v_mfma_f32_16x16x32_bf16 v[64:67], v[16:19], v[192:195], v[64:67]
    v_mfma_f32_16x16x32_bf16 v[68:71], v[20:23], v[192:195], v[68:71]
    v_mfma_f32_16x16x32_bf16 v[72:75], v[16:19], v[196:199], v[72:75]
    v_mfma_f32_16x16x32_bf16 v[76:79], v[20:23], v[196:199], v[76:79]
    s_waitcnt vmcnt(9)
    s_barrier
    s_cmp_lg_u32 s33, 0
    s_cbranch_scc1 L_sf_73
    s_mov_b64 exec, 1
    v_mov_b32 v5, 1
    buffer_store_dword v5, off, s[4:7], s42 sc1
    s_mov_b64 exec, -1
L_sf_73:
    s_waitcnt lgkmcnt(0)
    v_mfma_f32_16x16x32_bf16 v[32:35], v[200:203], v[24:27], v[32:35]
    ds_read_b128 v[16:19], v10 offset:3072
    ds_read_b128 v[20:23], v10 offset:21504
    v_mfma_f32_16x16x32_bf16 v[36:39], v[200:203], v[28:31], v[36:39]
    v_mfma_f32_16x16x32_bf16 v[40:43], v[204:207], v[24:27], v[40:43]
    v_mfma_f32_16x16x32_bf16 v[44:47], v[204:207], v[28:31], v[44:47]
    v_mfma_f32_16x16x32_bf16 v[48:51], v[208:211], v[24:27], v[48:51]
    v_mfma_f32_16x16x32_bf16 v[52:55], v[208:211], v[28:31], v[52:55]
    v_mfma_f32_16x16x32_bf16 v[56:59], v[212:215], v[24:27], v[56:59]
    v_mfma_f32_16x16x32_bf16 v[60:63], v[212:215], v[28:31], v[60:63]
    v_mfma_f32_16x16x32_bf16 v[64:67], v[24:27], v[216:219], v[64:67]
    v_mfma_f32_16x16x32_bf16 v[68:71], v[28:31], v[216:219], v[68:71]
    v_mfma_f32_16x16x32_bf16 v[72:75], v[24:27], v[220:223], v[72:75]
    v_mfma_f32_16x16x32_bf16 v[76:79], v[28:31], v[220:223], v[76:79]
    s_waitcnt lgkmcnt(0)
    v_mfma_f32_16x16x32_bf16 v[32:35], v[224:227], v[16:19], v[32:35]
    ds_read_b128 v[24:27], v11 offset:3072
    ds_read_b128 v[28:31], v11 offset:21504
    v_mfma_f32_16x16x32_bf16 v[36:39], v[224:227], v[20:23], v[36:39]
    v_mfma_f32_16x16x32_bf16 v[40:43], v[228:231], v[16:19], v[40:43]
    v_mfma_f32_16x16x32_bf16 v[44:47], v[228:231], v[20:23], v[44:47]
    v_mfma_f32_16x16x32_bf16 v[48:51], v[232:235], v[16:19], v[48:51]
    v_mfma_f32_16x16x32_bf16 v[52:55], v[232:235], v[20:23], v[52:55]
    v_mfma_f32_16x16x32_bf16 v[56:59], v[236:239], v[16:19], v[56:59]
    v_mfma_f32_16x16x32_bf16 v[60:63], v[236:239], v[20:23], v[60:63]
    v_mfma_f32_16x16x32_bf16 v[64:67], v[16:19], v[240:243], v[64:67]
    v_mfma_f32_16x16x32_bf16 v[68:71], v[20:23], v[240:243], v[68:71]
    v_mfma_f32_16x16x32_bf16 v[72:75], v[16:19], v[244:247], v[72:75]
    v_mfma_f32_16x16x32_bf16 v[76:79], v[20:23], v[244:247], v[76:79]
    s_waitcnt lgkmcnt(0)
    v_mfma_f32_16x16x32_bf16 v[32:35], v[248:251], v[24:27], v[32:35]
    ds_read_b128 v[16:19], v10 offset:4096
    ds_read_b128 v[20:23], v10 offset:22528
    v_mfma_f32_16x16x32_bf16 v[36:39], v[248:251], v[28:31], v[36:39]
    v_mfma_f32_16x16x32_bf16 v[40:43], v[252:255], v[24:27], v[40:43]
    v_mfma_f32_16x16x32_bf16 v[44:47], v[252:255], v[28:31], v[44:47]
    v_mfma_f32_16x16x32_bf16 v[48:51], a[0:3], v[24:27], v[48:51]
    v_mfma_f32_16x16x32_bf16 v[52:55], a[0:3], v[28:31], v[52:55]
    v_mfma_f32_16x16x32_bf16 v[56:59], a[4:7], v[24:27], v[56:59]
    v_mfma_f32_16x16x32_bf16 v[60:63], a[4:7], v[28:31], v[60:63]
    v_mfma_f32_16x16x32_bf16 v[64:67], v[24:27], a[8:11], v[64:67]
    v_mfma_f32_16x16x32_bf16 v[68:71], v[28:31], a[8:11], v[68:71]
    v_mfma_f32_16x16x32_bf16 v[72:75], v[24:27], a[12:15], v[72:75]
    v_mfma_f32_16x16x32_bf16 v[76:79], v[28:31], a[12:15], v[76:79]
    s_waitcnt lgkmcnt(0)
    v_mfma_f32_16x16x32_bf16 v[32:35], a[16:19], v[16:19], v[32:35]
    ds_read_b128 v[24:27], v11 offset:4096
    ds_read_b128 v[28:31], v11 offset:22528
    v_mfma_f32_16x16x32_bf16 v[36:39], a[16:19], v[20:23], v[36:39]
    v_mfma_f32_16x16x32_bf16 v[40:43], a[20:23], v[16:19], v[40:43]
    v_mfma_f32_16x16x32_bf16 v[44:47], a[20:23], v[20:23], v[44:47]
    v_mfma_f32_16x16x32_bf16 v[48:51], a[24:27], v[16:19], v[48:51]
    v_mfma_f32_16x16x32_bf16 v[52:55], a[24:27], v[20:23], v[52:55]
    v_mfma_f32_16x16x32_bf16 v[56:59], a[28:31], v[16:19], v[56:59]
    v_mfma_f32_16x16x32_bf16 v[60:63], a[28:31], v[20:23], v[60:63]
    v_mfma_f32_16x16x32_bf16 v[64:67], v[16:19], a[32:35], v[64:67]
    v_mfma_f32_16x16x32_bf16 v[68:71], v[20:23], a[32:35], v[68:71]
    v_mfma_f32_16x16x32_bf16 v[72:75], v[16:19], a[36:39], v[72:75]
    v_mfma_f32_16x16x32_bf16 v[76:79], v[20:23], a[36:39], v[76:79]
    s_waitcnt lgkmcnt(0)
    v_mfma_f32_16x16x32_bf16 v[32:35], a[40:43], v[24:27], v[32:35]
    ds_read_b128 v[16:19], v10 offset:5120
    ds_read_b128 v[20:23], v10 offset:23552
    v_mfma_f32_16x16x32_bf16 v[36:39], a[40:43], v[28:31], v[36:39]
    v_mfma_f32_16x16x32_bf16 v[40:43], a[44:47], v[24:27], v[40:43]
    v_mfma_f32_16x16x32_bf16 v[44:47], a[44:47], v[28:31], v[44:47]
    v_mfma_f32_16x16x32_bf16 v[48:51], a[48:51], v[24:27], v[48:51]
    v_mfma_f32_16x16x32_bf16 v[52:55], a[48:51], v[28:31], v[52:55]
    v_mfma_f32_16x16x32_bf16 v[56:59], a[52:55], v[24:27], v[56:59]
    v_mfma_f32_16x16x32_bf16 v[60:63], a[52:55], v[28:31], v[60:63]
    v_mfma_f32_16x16x32_bf16 v[64:67], v[24:27], a[56:59], v[64:67]
    v_mfma_f32_16x16x32_bf16 v[68:71], v[28:31], a[56:59], v[68:71]
    v_mfma_f32_16x16x32_bf16 v[72:75], v[24:27], a[60:63], v[72:75]
    v_mfma_f32_16x16x32_bf16 v[76:79], v[28:31], a[60:63], v[76:79]
    s_waitcnt lgkmcnt(0)
    v_mfma_f32_16x16x32_bf16 v[32:35], a[64:67], v[16:19], v[32:35]
    ds_read_b128 v[24:27], v11 offset:5120
    ds_read_b128 v[28:31], v11 offset:23552
    v_mfma_f32_16x16x32_bf16 v[36:39], a[64:67], v[20:23], v[36:39]
    v_mfma_f32_16x16x32_bf16 v[40:43], a[68:71], v[16:19], v[40:43]
    v_mfma_f32_16x16x32_bf16 v[44:47], a[68:71], v[20:23], v[44:47]
    v_mfma_f32_16x16x32_bf16 v[48:51], a[72:75], v[16:19], v[48:51]
    v_mfma_f32_16x16x32_bf16 v[52:55], a[72:75], v[20:23], v[52:55]
    v_mfma_f32_16x16x32_bf16 v[56:59], a[76:79], v[16:19], v[56:59]
    v_mfma_f32_16x16x32_bf16 v[60:63], a[76:79], v[20:23], v[60:63]
    v_mfma_f32_16x16x32_bf16 v[64:67], v[16:19], a[80:83], v[64:67]
    v_mfma_f32_16x16x32_bf16 v[68:71], v[20:23], a[80:83], v[68:71]
    v_mfma_f32_16x16x32_bf16 v[72:75], v[16:19], a[84:87], v[72:75]
    v_mfma_f32_16x16x32_bf16 v[76:79], v[20:23], a[84:87], v[76:79]
    s_waitcnt lgkmcnt(0)
    v_mfma_f32_16x16x32_bf16 v[32:35], a[88:91], v[24:27], v[32:35]
    ds_read_b128 v[16:19], v10 offset:6144
    ds_read_b128 v[20:23], v10 offset:24576
    v_mfma_f32_16x16x32_bf16 v[36:39], a[88:91], v[28:31], v[36:39]
    v_mfma_f32_16x16x32_bf16 v[40:43], a[92:95], v[24:27], v[40:43]
    v_mfma_f32_16x16x32_bf16 v[44:47], a[92:95], v[28:31], v[44:47]
    v_mfma_f32_16x16x32_bf16 v[48:51], a[96:99], v[24:27], v[48:51]
    v_mfma_f32_16x16x32_bf16 v[52:55], a[96:99], v[28:31], v[52:55]
    v_mfma_f32_16x16x32_bf16 v[56:59], a[100:103], v[24:27], v[56:59]
    v_mfma_f32_16x16x32_bf16 v[60:63], a[100:103], v[28:31], v[60:63]
    v_mfma_f32_16x16x32_bf16 v[64:67], v[24:27], a[104:107], v[64:67]
    v_mfma_f32_16x16x32_bf16 v[68:71], v[28:31], a[104:107], v[68:71]
    v_mfma_f32_16x16x32_bf16 v[72:75], v[24:27], a[108:111], v[72:75]
    v_mfma_f32_16x16x32_bf16 v[76:79], v[28:31], a[108:111], v[76:79]
    s_waitcnt lgkmcnt(0)
    v_mfma_f32_16x16x32_bf16 v[32:35], a[112:115], v[16:19], v[32:35]
    ds_read_b128 v[24:27], v11 offset:6144
    ds_read_b128 v[28:31], v11 offset:24576
    v_mfma_f32_16x16x32_bf16 v[36:39], a[112:115], v[20:23], v[36:39]
    v_mfma_f32_16x16x32_bf16 v[40:43], a[116:119], v[16:19], v[40:43]
    v_mfma_f32_16x16x32_bf16 v[44:47], a[116:119], v[20:23], v[44:47]
    v_mfma_f32_16x16x32_bf16 v[48:51], a[120:123], v[16:19], v[48:51]
    v_mfma_f32_16x16x32_bf16 v[52:55], a[120:123], v[20:23], v[52:55]
    v_mfma_f32_16x16x32_bf16 v[56:59], a[124:127], v[16:19], v[56:59]
    v_mfma_f32_16x16x32_bf16 v[60:63], a[124:127], v[20:23], v[60:63]
    v_mfma_f32_16x16x32_bf16 v[64:67], v[16:19], a[128:131], v[64:67]
    v_mfma_f32_16x16x32_bf16 v[68:71], v[20:23], a[128:131], v[68:71]
    v_mfma_f32_16x16x32_bf16 v[72:75], v[16:19], a[132:135], v[72:75]
    v_mfma_f32_16x16x32_bf16 v[76:79], v[20:23], a[132:135], v[76:79]
    s_waitcnt lgkmcnt(0)
    v_mfma_f32_16x16x32_bf16 v[32:35], a[136:139], v[24:27], v[32:35]
    ds_read_b128 v[16:19], v10 offset:7168
    ds_read_b128 v[20:23], v10 offset:25600
    v_mfma_f32_16x16x32_bf16 v[36:39], a[136:139], v[28:31], v[36:39]
    v_mfma_f32_16x16x32_bf16 v[40:43], a[140:143], v[24:27], v[40:43]
    v_mfma_f32_16x16x32_bf16 v[44:47], a[140:143], v[28:31], v[44:47]
    v_mfma_f32_16x16x32_bf16 v[48:51], a[144:147], v[24:27], v[48:51]
    v_mfma_f32_16x16x32_bf16 v[52:55], a[144:147], v[28:31], v[52:55]
    v_mfma_f32_16x16x32_bf16 v[56:59], a[148:151], v[24:27], v[56:59]
    v_mfma_f32_16x16x32_bf16 v[60:63], a[148:151], v[28:31], v[60:63]
    v_mfma_f32_16x16x32_bf16 v[64:67], v[24:27], a[152:155], v[64:67]
    v_mfma_f32_16x16x32_bf16 v[68:71], v[28:31], a[152:155], v[68:71]
    v_mfma_f32_16x16x32_bf16 v[72:75], v[24:27], a[156:159], v[72:75]
    v_mfma_f32_16x16x32_bf16 v[76:79], v[28:31], a[156:159], v[76:79]
    s_waitcnt lgkmcnt(0)
    v_mfma_f32_16x16x32_bf16 v[32:35], a[160:163], v[16:19], v[32:35]
    ds_read_b128 v[24:27], v11 offset:7168
    ds_read_b128 v[28:31], v11 offset:25600
    v_mfma_f32_16x16x32_bf16 v[36:39], a[160:163], v[20:23], v[36:39]
    v_mfma_f32_16x16x32_bf16 v[40:43], a[164:167], v[16:19], v[40:43]
    v_mfma_f32_16x16x32_bf16 v[44:47], a[164:167], v[20:23], v[44:47]
    v_mfma_f32_16x16x32_bf16 v[48:51], a[168:171], v[16:19], v[48:51]
    v_mfma_f32_16x16x32_bf16 v[52:55], a[168:171], v[20:23], v[52:55]
    v_mfma_f32_16x16x32_bf16 v[56:59], a[172:175], v[16:19], v[56:59]
    v_mfma_f32_16x16x32_bf16 v[60:63], a[172:175], v[20:23], v[60:63]
    v_mfma_f32_16x16x32_bf16 v[64:67], v[16:19], a[176:179], v[64:67]
    v_mfma_f32_16x16x32_bf16 v[68:71], v[20:23], a[176:179], v[68:71]
    v_mfma_f32_16x16x32_bf16 v[72:75], v[16:19], a[180:183], v[72:75]
    v_mfma_f32_16x16x32_bf16 v[76:79], v[20:23], a[180:183], v[76:79]
    s_waitcnt lgkmcnt(0)
    v_mfma_f32_16x16x32_bf16 v[32:35], a[184:187], v[24:27], v[32:35]
    ds_read_b128 v[16:19], v10 offset:8192
    ds_read_b128 v[20:23], v10 offset:26624
    v_mfma_f32_16x16x32_bf16 v[36:39], a[184:187], v[28:31], v[36:39]
    v_mfma_f32_16x16x32_bf16 v[40:43], a[188:191], v[24:27], v[40:43]
    v_mfma_f32_16x16x32_bf16 v[44:47], a[188:191], v[28:31], v[44:47]
    v_mfma_f32_16x16x32_bf16 v[48:51], a[192:195], v[24:27], v[48:51]
    v_mfma_f32_16x16x32_bf16 v[52:55], a[192:195], v[28:31], v[52:55]
    v_mfma_f32_16x16x32_bf16 v[56:59], a[196:199], v[24:27], v[56:59]
    v_mfma_f32_16x16x32_bf16 v[60:63], a[196:199], v[28:31], v[60:63]
    v_mfma_f32_16x16x32_bf16 v[64:67], v[24:27], a[200:203], v[64:67]
    v_mfma_f32_16x16x32_bf16 v[68:71], v[28:31], a[200:203], v[68:71]
    v_mfma_f32_16x16x32_bf16 v[72:75], v[24:27], a[204:207], v[72:75]
    v_mfma_f32_16x16x32_bf16 v[76:79], v[28:31], a[204:207], v[76:79]
    s_waitcnt lgkmcnt(0)
    v_mfma_f32_16x16x32_bf16 v[32:35], a[208:211], v[16:19], v[32:35]
    ds_read_b128 v[24:27], v11 offset:8192
    ds_read_b128 v[28:31], v11 offset:26624
    v_mfma_f32_16x16x32_bf16 v[36:39], a[208:211], v[20:23], v[36:39]
    v_mfma_f32_16x16x32_bf16 v[40:43], a[212:215], v[16:19], v[40:43]
    v_mfma_f32_16x16x32_bf16 v[44:47], a[212:215], v[20:23], v[44:47]
    v_mfma_f32_16x16x32_bf16 v[48:51], a[216:219], v[16:19], v[48:51]
    v_mfma_f32_16x16x32_bf16 v[52:55], a[216:219], v[20:23], v[52:55]
    v_mfma_f32_16x16x32_bf16 v[56:59], a[220:223], v[16:19], v[56:59]
    v_mfma_f32_16x16x32_bf16 v[60:63], a[220:223], v[20:23], v[60:63]
    v_mfma_f32_16x16x32_bf16 v[64:67], v[16:19], a[224:227], v[64:67]
    v_mfma_f32_16x16x32_bf16 v[68:71], v[20:23], a[224:227], v[68:71]
    v_mfma_f32_16x16x32_bf16 v[72:75], v[16:19], a[228:231], v[72:75]
    v_mfma_f32_16x16x32_bf16 v[76:79], v[20:23], a[228:231], v[76:79]
    s_waitcnt lgkmcnt(0)
    v_mfma_f32_16x16x32_bf16 v[32:35], a[232:235], v[24:27], v[32:35]
    v_mfma_f32_16x16x32_bf16 v[36:39], a[232:235], v[28:31], v[36:39]
    v_mfma_f32_16x16x32_bf16 v[40:43], a[236:239], v[24:27], v[40:43]
    v_mfma_f32_16x16x32_bf16 v[44:47], a[236:239], v[28:31], v[44:47]
    v_mfma_f32_16x16x32_bf16 v[48:51], a[240:243], v[24:27], v[48:51]
    v_mfma_f32_16x16x32_bf16 v[52:55], a[240:243], v[28:31], v[52:55]
    v_mfma_f32_16x16x32_bf16 v[56:59], a[244:247], v[24:27], v[56:59]
    v_mfma_f32_16x16x32_bf16 v[60:63], a[244:247], v[28:31], v[60:63]
    v_mfma_f32_16x16x32_bf16 v[64:67], v[24:27], a[248:251], v[64:67]
    v_mfma_f32_16x16x32_bf16 v[68:71], v[28:31], a[248:251], v[68:71]
    v_mfma_f32_16x16x32_bf16 v[72:75], v[24:27], a[252:255], v[72:75]
    v_mfma_f32_16x16x32_bf16 v[76:79], v[28:31], a[252:255], v[76:79]
    v_xor_b32 v10, 0x10000, v10
    v_xor_b32 v11, 0x10000, v11
    s_lshl_b32 s42, s34, 8
    s_lshl_b32 s60, s36, 2
    s_add_u32 s42, s42, s60
    s_add_u32 s42, s42, 81789952
    s_add_u32 s60, s40, 4096
    s_add_u32 s61, s41, 4096
    s_lshl_b32 s62, s33, 10
    s_add_u32 s62, s62, s41
    s_add_u32 s62, s62, 8192
    v_cvt_pk_bf16_f32 v32, v32, v40
    v_cvt_pk_bf16_f32 v33, v33, v41
    v_cvt_pk_bf16_f32 v34, v34, v42
    v_cvt_pk_bf16_f32 v35, v35, v43
    buffer_store_dwordx4 v[32:35], v0, s[4:7], s40 offen sc1
    v_cvt_pk_bf16_f32 v36, v36, v44
    v_cvt_pk_bf16_f32 v37, v37, v45
    v_cvt_pk_bf16_f32 v38, v38, v46
    v_cvt_pk_bf16_f32 v39, v39, v47
    buffer_store_dwordx4 v[36:39], v0, s[4:7], s60 offen sc1
    v_cvt_pk_bf16_f32 v48, v48, v56
    v_cvt_pk_bf16_f32 v49, v49, v57
    v_cvt_pk_bf16_f32 v50, v50, v58
    v_cvt_pk_bf16_f32 v51, v51, v59
    buffer_store_dwordx4 v[48:51], v0, s[4:7], s41 offen sc1
    v_cvt_pk_bf16_f32 v52, v52, v60
    v_cvt_pk_bf16_f32 v53, v53, v61
    v_cvt_pk_bf16_f32 v54, v54, v62
    v_cvt_pk_bf16_f32 v55, v55, v63
    buffer_store_dwordx4 v[52:55], v0, s[4:7], s61 offen sc1
    v_cvt_pk_bf16_f32 v64, v64, v65
    v_cvt_pk_bf16_f32 v65, v66, v67
    v_cvt_pk_bf16_f32 v66, v68, v69
    v_cvt_pk_bf16_f32 v67, v70, v71
    buffer_store_dwordx4 v[64:67], v0, s[4:7], s62 offen offset:0 sc1
    v_cvt_pk_bf16_f32 v72, v72, v73
    v_cvt_pk_bf16_f32 v73, v74, v75
    v_cvt_pk_bf16_f32 v74, v76, v77
    v_cvt_pk_bf16_f32 v75, v78, v79
    buffer_store_dwordx4 v[72:75], v0, s[4:7], s62 offen offset:1024 sc1
    v_mov_b64 v[16:17], -1
    v_mov_b64 v[18:19], -1
    s_sub_u32 s60, s40, 33554432
    s_lshl_b32 s61, s33, 10
    s_add_u32 s60, s60, s61
    s_lshr_b32 s60, s60, 1
    s_add_u32 s60, s60, 50331648
    buffer_store_dwordx4 v[16:19], v0, s[4:7], s60 offen sc1
    s_add_u32 s40, s40, 1835008
    s_add_u32 s41, s41, 3670016
    s_add_u32 s36, s36, 7
    s_cmp_lt_u32 s36, 64
    s_cbranch_scc1 L_qkv_68
    s_waitcnt vmcnt(0)
    s_barrier
    s_cmp_lg_u32 s33, 0
    s_cbranch_scc1 L_sf_74
    s_mov_b64 exec, 1
    v_mov_b32 v5, 1
    buffer_store_dword v5, off, s[4:7], s42 sc1
    s_mov_b64 exec, -1
L_sf_74:
    s_cmp_ge_u32 s32, 80
    s_cbranch_scc1 L_roleC_75
    s_cmp_ge_u32 s32, 64
    s_cbranch_scc1 L_roleB_76
    s_lshr_b32 s34, s32, 2
    s_and_b32 s35, s32, 3
    s_mul_i32 s61, s34, 294912
    v_lshrrev_b32 v5, 3, v1
    v_mul_u32_u24 v9, 1152, v5
    v_and_b32 v5, 7, v1
    v_lshl_add_u32 v9, v5, 4, v9
    s_mul_i32 s63, s33, 36864
    s_add_u32 s63, s63, s61
    v_add_u32 v9, s63, v9
    v_lshl_add_u32 v10, v2, 4, v3
    v_lshlrev_b32 v10, 7, v10
    v_lshl_add_u32 v10, v4, 3, v10
    s_lshl_b32 s63, s33, 5
    v_add_u32 v10, s63, v10
    s_lshl_b32 s99, s33, 12
    s_add_u32 m0, s99, 0
    s_mov_b32 s62, 0
    buffer_load_dwordx4 v9, s[20:23], s62 offen lds
    s_add_u32 m0, s99, 1024
    s_mov_b32 s62, 9216
    buffer_load_dwordx4 v9, s[20:23], s62 offen lds
    s_add_u32 m0, s99, 2048
    s_mov_b32 s62, 18432
    buffer_load_dwordx4 v9, s[20:23], s62 offen lds
    s_add_u32 m0, s99, 3072
    s_mov_b32 s62, 27648
    buffer_load_dwordx4 v9, s[20:23], s62 offen lds
    s_add_u32 m0, s99, 16384
    s_mov_b32 s62, 128
    buffer_load_dwordx4 v9, s[20:23], s62 offen lds
    s_add_u32 m0, s99, 17408
    s_mov_b32 s62, 9344
    buffer_load_dwordx4 v9, s[20:23], s62 offen lds
    s_add_u32 m0, s99, 18432
    s_mov_b32 s62, 18560
    buffer_load_dwordx4 v9, s[20:23], s62 offen lds
    s_add_u32 m0, s99, 19456
    s_mov_b32 s62, 27776
    buffer_load_dwordx4 v9, s[20:23], s62 offen lds
    s_waitcnt vmcnt(4)
    s_barrier
    s_add_u32 m0, s99, 32768
    s_mov_b32 s62, 256
    buffer_load_dwordx4 v9, s[20:23], s62 offen lds
    s_add_u32 m0, s99, 33792
    s_mov_b32 s62, 9472
    buffer_load_dwordx4 v9, s[20:23], s62 offen lds
    s_add_u32 m0, s99, 34816
    s_mov_b32 s62, 18688
    buffer_load_dwordx4 v9, s[20:23], s62 offen lds
    s_add_u32 m0, s99, 35840
    s_mov_b32 s62, 27904
    buffer_load_dwordx4 v9, s[20:23], s62 offen lds
    v_add_u32 v11, 0, v10
    ds_read_b64_tr_b16 v[224:225], v11 offset:0
    ds_read_b64_tr_b16 v[226:227], v11 offset:512
    ds_read_b64_tr_b16 v[228:229], v11 offset:1024
    ds_read_b64_tr_b16 v[230:231], v11 offset:1536
    ds_read_b64_tr_b16 v[232:233], v11 offset:8192
    ds_read_b64_tr_b16 v[234:235], v11 offset:8704
    ds_read_b64_tr_b16 v[236:237], v11 offset:9216
    ds_read_b64_tr_b16 v[238:239], v11 offset:9728
    s_waitcnt lgkmcnt(0)
    s_waitcnt vmcnt(4)
    s_barrier
    s_add_u32 m0, s99, 49152
    s_mov_b32 s62, 384
    buffer_load_dwordx4 v9, s[20:23], s62 offen lds
    s_add_u32 m0, s99, 50176
    s_mov_b32 s62, 9600
    buffer_load_dwordx4 v9, s[20:23], s62 offen lds
    s_add_u32 m0, s99, 51200
    s_mov_b32 s62, 18816
    buffer_load_dwordx4 v9, s[20:23], s62 offen lds
    s_add_u32 m0, s99, 52224
    s_mov_b32 s62, 28032
    buffer_load_dwordx4 v9, s[20:23], s62 offen lds
    v_add_u32 v11, 16384, v10
    ds_read_b64_tr_b16 a[0:1], v11 offset:0
    ds_read_b64_tr_b16 a[2:3], v11 offset:512
    ds_read_b64_tr_b16 a[4:5], v11 offset:1024
    ds_read_b64_tr_b16 a[6:7], v11 offset:1536
    ds_read_b64_tr_b16 a[8:9], v11 offset:8192
    ds_read_b64_tr_b16 a[10:11], v11 offset:8704
    ds_read_b64_tr_b16 a[12:13], v11 offset:9216
    ds_read_b64_tr_b16 a[14:15], v11 offset:9728
    s_waitcnt lgkmcnt(0)
    s_waitcnt vmcnt(4)
    s_barrier
    s_add_u32 m0, s99, 65536
    s_mov_b32 s62, 512
    buffer_load_dwordx4 v9, s[20:23], s62 offen lds
    s_add_u32 m0, s99, 66560
    s_mov_b32 s62, 9728
    buffer_load_dwordx4 v9, s[20:23], s62 offen lds
    s_add_u32 m0, s99, 67584
    s_mov_b32 s62, 18944
    buffer_load_dwordx4 v9, s[20:23], s62 offen lds
    s_add_u32 m0, s99, 68608
    s_mov_b32 s62, 28160
    buffer_load_dwordx4 v9, s[20:23], s62 offen lds
    v_add_u32 v11, 32768, v10
    ds_read_b64_tr_b16 a[32:33], v11 offset:0
    ds_read_b64_tr_b16 a[34:35], v11 offset:512
    ds_read_b64_tr_b16 a[36:37], v11 offset:1024
    ds_read_b64_tr_b16 a[38:39], v11 offset:1536
    ds_read_b64_tr_b16 a[40:41], v11 offset:8192
    ds_read_b64_tr_b16 a[42:43], v11 offset:8704
    ds_read_b64_tr_b16 a[44:45], v11 offset:9216
    ds_read_b64_tr_b16 a[46:47], v11 offset:9728
    s_waitcnt lgkmcnt(0)
    s_waitcnt vmcnt(4)
    s_barrier
    s_add_u32 m0, s99, 81920
    s_mov_b32 s62, 640
    buffer_load_dwordx4 v9, s[20:23], s62 offen lds
    s_add_u32 m0, s99, 82944
    s_mov_b32 s62, 9856
    buffer_load_dwordx4 v9, s[20:23], s62 offen lds
    s_add_u32 m0, s99, 83968
    s_mov_b32 s62, 19072
    buffer_load_dwordx4 v9, s[20:23], s62 offen lds
    s_add_u32 m0, s99, 84992
    s_mov_b32 s62, 28288
    buffer_load_dwordx4 v9, s[20:23], s62 offen lds
    v_add_u32 v11, 49152, v10
    ds_read_b64_tr_b16 a[64:65], v11 offset:0
    ds_read_b64_tr_b16 a[66:67], v11 offset:512
    ds_read_b64_tr_b16 a[68:69], v11 offset:1024
    ds_read_b64_tr_b16 a[70:71], v11 offset:1536
    ds_read_b64_tr_b16 a[72:73], v11 offset:8192
    ds_read_b64_tr_b16 a[74:75], v11 offset:8704
    ds_read_b64_tr_b16 a[76:77], v11 offset:9216
    ds_read_b64_tr_b16 a[78:79], v11 offset:9728
    s_waitcnt lgkmcnt(0)
    s_waitcnt vmcnt(4)
    s_barrier
    s_add_u32 m0, s99, 98304
    s_mov_b32 s62, 768
    buffer_load_dwordx4 v9, s[20:23], s62 offen lds
    s_add_u32 m0, s99, 99328
    s_mov_b32 s62, 9984
    buffer_load_dwordx4 v9, s[20:23], s62 offen lds
    s_add_u32 m0, s99, 100352
    s_mov_b32 s62, 19200
    buffer_load_dwordx4 v9, s[20:23], s62 offen lds
    s_add_u32 m0, s99, 101376
    s_mov_b32 s62, 28416
    buffer_load_dwordx4 v9, s[20:23], s62 offen lds
    v_add_u32 v11, 65536, v10
    ds_read_b64_tr_b16 a[96:97], v11 offset:0
    ds_read_b64_tr_b16 a[98:99], v11 offset:512
    ds_read_b64_tr_b16 a[100:101], v11 offset:1024
    ds_read_b64_tr_b16 a[102:103], v11 offset:1536
    ds_read_b64_tr_b16 a[104:105], v11 offset:8192
    ds_read_b64_tr_b16 a[106:107], v11 offset:8704
    ds_read_b64_tr_b16 a[108:109], v11 offset:9216
    ds_read_b64_tr_b16 a[110:111], v11 offset:9728
    s_waitcnt lgkmcnt(0)
    s_waitcnt vmcnt(4)
    s_barrier
    s_add_u32 m0, s99, 114688
    s_mov_b32 s62, 896
    buffer_load_dwordx4 v9, s[20:23], s62 offen lds
    s_add_u32 m0, s99, 115712
    s_mov_b32 s62, 10112
    buffer_load_dwordx4 v9, s[20:23], s62 offen lds
    s_add_u32 m0, s99, 116736
    s_mov_b32 s62, 19328
    buffer_load_dwordx4 v9, s[20:23], s62 offen lds
    s_add_u32 m0, s99, 117760
    s_mov_b32 s62, 28544
    buffer_load_dwordx4 v9, s[20:23], s62 offen lds
    v_add_u32 v11, 81920, v10
    ds_read_b64_tr_b16 a[128:129], v11 offset:0
    ds_read_b64_tr_b16 a[130:131], v11 offset:512
    ds_read_b64_tr_b16 a[132:133], v11 offset:1024
    ds_read_b64_tr_b16 a[134:135], v11 offset:1536
    ds_read_b64_tr_b16 a[136:137], v11 offset:8192
    ds_read_b64_tr_b16 a[138:139], v11 offset:8704
    ds_read_b64_tr_b16 a[140:141], v11 offset:9216
    ds_read_b64_tr_b16 a[142:143], v11 offset:9728
    s_waitcnt lgkmcnt(0)
    s_waitcnt vmcnt(4)
    s_barrier
    s_add_u32 m0, s99, 131072
    s_mov_b32 s62, 1024
    buffer_load_dwordx4 v9, s[20:23], s62 offen lds
    s_add_u32 m0, s99, 132096
    s_mov_b32 s62, 10240
    buffer_load_dwordx4 v9, s[20:23], s62 offen lds
    s_add_u32 m0, s99, 133120
    s_mov_b32 s62, 19456
    buffer_load_dwordx4 v9, s[20:23], s62 offen lds
    s_add_u32 m0, s99, 134144
    s_mov_b32 s62, 28672
    buffer_load_dwordx4 v9, s[20:23], s62 offen lds
    v_add_u32 v11, 98304, v10
    ds_read_b64_tr_b16 a[160:161], v11 offset:0
    ds_read_b64_tr_b16 a[162:163], v11 offset:512
    ds_read_b64_tr_b16 a[164:165], v11 offset:1024
    ds_read_b64_tr_b16 a[166:167], v11 offset:1536
    ds_read_b64_tr_b16 a[168:169], v11 offset:8192
    ds_read_b64_tr_b16 a[170:171], v11 offset:8704
    ds_read_b64_tr_b16 a[172:173], v11 offset:9216
    ds_read_b64_tr_b16 a[174:175], v11 offset:9728
    s_waitcnt lgkmcnt(0)
    s_waitcnt vmcnt(4)
    s_barrier
    s_add_u32 m0, s99, 0
    s_mov_b32 s62, 147456
    buffer_load_dwordx4 v9, s[20:23], s62 offen lds
    s_add_u32 m0, s99, 1024
    s_mov_b32 s62, 156672
    buffer_load_dwordx4 v9, s[20:23], s62 offen lds
    s_add_u32 m0, s99, 2048
    s_mov_b32 s62, 165888
    buffer_load_dwordx4 v9, s[20:23], s62 offen lds
    s_add_u32 m0, s99, 3072
    s_mov_b32 s62, 175104
    buffer_load_dwordx4 v9, s[20:23], s62 offen lds
    v_add_u32 v11, 114688, v10
    ds_read_b64_tr_b16 a[192:193], v11 offset:0
    ds_read_b64_tr_b16 a[194:195], v11 offset:512
    ds_read_b64_tr_b16 a[196:197], v11 offset:1024
    ds_read_b64_tr_b16 a[198:199], v11 offset:1536
    ds_read_b64_tr_b16 a[200:201], v11 offset:8192
    ds_read_b64_tr_b16 a[202:203], v11 offset:8704
    ds_read_b64_tr_b16 a[204:205], v11 offset:9216
    ds_read_b64_tr_b16 a[206:207], v11 offset:9728
    s_waitcnt lgkmcnt(0)
    s_waitcnt vmcnt(4)
    s_barrier
    s_add_u32 m0, s99, 16384
    s_mov_b32 s62, 147584
    buffer_load_dwordx4 v9, s[20:23], s62 offen lds
    s_add_u32 m0, s99, 17408
    s_mov_b32 s62, 156800
    buffer_load_dwordx4 v9, s[20:23], s62 offen lds
    s_add_u32 m0, s99, 18432
    s_mov_b32 s62, 166016
    buffer_load_dwordx4 v9, s[20:23], s62 offen lds
    s_add_u32 m0, s99, 19456
    s_mov_b32 s62, 175232
    buffer_load_dwordx4 v9, s[20:23], s62 offen lds
    v_add_u32 v11, 131072, v10
    ds_read_b64_tr_b16 a[224:225], v11 offset:0
    ds_read_b64_tr_b16 a[226:227], v11 offset:512
    ds_read_b64_tr_b16 a[228:229], v11 offset:1024
    ds_read_b64_tr_b16 a[230:231], v11 offset:1536
    ds_read_b64_tr_b16 a[232:233], v11 offset:8192
    ds_read_b64_tr_b16 a[234:235], v11 offset:8704
    ds_read_b64_tr_b16 a[236:237], v11 offset:9216
    ds_read_b64_tr_b16 a[238:239], v11 offset:9728
    s_waitcnt lgkmcnt(0)
    s_waitcnt vmcnt(4)
    s_barrier
    s_add_u32 m0, s99, 32768
    s_mov_b32 s62, 147712
    buffer_load_dwordx4 v9, s[20:23], s62 offen lds
    s_add_u32 m0, s99, 33792
    s_mov_b32 s62, 156928
    buffer_load_dwordx4 v9, s[20:23], s62 offen lds
    s_add_u32 m0, s99, 34816
    s_mov_b32 s62, 166144
    buffer_load_dwordx4 v9, s[20:23], s62 offen lds
    s_add_u32 m0, s99, 35840
    s_mov_b32 s62, 175360
    buffer_load_dwordx4 v9, s[20:23], s62 offen lds
    v_add_u32 v11, 0, v10
    ds_read_b64_tr_b16 v[240:241], v11 offset:0
    ds_read_b64_tr_b16 v[242:243], v11 offset:512
    ds_read_b64_tr_b16 v[244:245], v11 offset:1024
    ds_read_b64_tr_b16 v[246:247], v11 offset:1536
    ds_read_b64_tr_b16 v[248:249], v11 offset:8192
    ds_read_b64_tr_b16 v[250:251], v11 offset:8704
    ds_read_b64_tr_b16 v[252:253], v11 offset:9216
    ds_read_b64_tr_b16 v[254:255], v11 offset:9728
    s_waitcnt lgkmcnt(0)
    s_waitcnt vmcnt(4)
    s_barrier
    s_add_u32 m0, s99, 49152
    s_mov_b32 s62, 147840
    buffer_load_dwordx4 v9, s[20:23], s62 offen lds
    s_add_u32 m0, s99, 50176
    s_mov_b32 s62, 157056
    buffer_load_dwordx4 v9, s[20:23], s62 offen lds
    s_add_u32 m0, s99, 51200
    s_mov_b32 s62, 166272
    buffer_load_dwordx4 v9, s[20:23], s62 offen lds
    s_add_u32 m0, s99, 52224
    s_mov_b32 s62, 175488
    buffer_load_dwordx4 v9, s[20:23], s62 offen lds
    v_add_u32 v11, 16384, v10
    ds_read_b64_tr_b16 a[16:17], v11 offset:0
    ds_read_b64_tr_b16 a[18:19], v11 offset:512
    ds_read_b64_tr_b16 a[20:21], v11 offset:1024
    ds_read_b64_tr_b16 a[22:23], v11 offset:1536
    ds_read_b64_tr_b16 a[24:25], v11 offset:8192
    ds_read_b64_tr_b16 a[26:27], v11 offset:8704
    ds_read_b64_tr_b16 a[28:29], v11 offset:9216
    ds_read_b64_tr_b16 a[30:31], v11 offset:9728
    s_waitcnt lgkmcnt(0)
    s_waitcnt vmcnt(4)
    s_barrier
    s_add_u32 m0, s99, 65536
    s_mov_b32 s62, 147968
    buffer_load_dwordx4 v9, s[20:23], s62 offen lds
    s_add_u32 m0, s99, 66560
    s_mov_b32 s62, 157184
    buffer_load_dwordx4 v9, s[20:23], s62 offen lds
    s_add_u32 m0, s99, 67584
    s_mov_b32 s62, 166400
    buffer_load_dwordx4 v9, s[20:23], s62 offen lds
    s_add_u32 m0, s99, 68608
    s_mov_b32 s62, 175616
    buffer_load_dwordx4 v9, s[20:23], s62 offen lds
    v_add_u32 v11, 32768, v10
    ds_read_b64_tr_b16 a[48:49], v11 offset:0
    ds_read_b64_tr_b16 a[50:51], v11 offset:512
    ds_read_b64_tr_b16 a[52:53], v11 offset:1024
    ds_read_b64_tr_b16 a[54:55], v11 offset:1536
    ds_read_b64_tr_b16 a[56:57], v11 offset:8192
    ds_read_b64_tr_b16 a[58:59], v11 offset:8704
    ds_read_b64_tr_b16 a[60:61], v11 offset:9216
    ds_read_b64_tr_b16 a[62:63], v11 offset:9728
    s_waitcnt lgkmcnt(0)
    s_waitcnt vmcnt(4)
    s_barrier
    s_add_u32 m0, s99, 81920
    s_mov_b32 s62, 148096
    buffer_load_dwordx4 v9, s[20:23], s62 offen lds
    s_add_u32 m0, s99, 82944
    s_mov_b32 s62, 157312
    buffer_load_dwordx4 v9, s[20:23], s62 offen lds
    s_add_u32 m0, s99, 83968
    s_mov_b32 s62, 166528
    buffer_load_dwordx4 v9, s[20:23], s62 offen lds
    s_add_u32 m0, s99, 84992
    s_mov_b32 s62, 175744
    buffer_load_dwordx4 v9, s[20:23], s62 offen lds
    v_add_u32 v11, 49152, v10
    ds_read_b64_tr_b16 a[80:81], v11 offset:0
    ds_read_b64_tr_b16 a[82:83], v11 offset:512
    ds_read_b64_tr_b16 a[84:85], v11 offset:1024
    ds_read_b64_tr_b16 a[86:87], v11 offset:1536
    ds_read_b64_tr_b16 a[88:89], v11 offset:8192
    ds_read_b64_tr_b16 a[90:91], v11 offset:8704
    ds_read_b64_tr_b16 a[92:93], v11 offset:9216
    ds_read_b64_tr_b16 a[94:95], v11 offset:9728
    s_waitcnt lgkmcnt(0)
    s_waitcnt vmcnt(4)
    s_barrier
    s_add_u32 m0, s99, 98304
    s_mov_b32 s62, 148224
    buffer_load_dwordx4 v9, s[20:23], s62 offen lds
    s_add_u32 m0, s99, 99328
    s_mov_b32 s62, 157440
    buffer_load_dwordx4 v9, s[20:23], s62 offen lds
    s_add_u32 m0, s99, 100352
    s_mov_b32 s62, 166656
    buffer_load_dwordx4 v9, s[20:23], s62 offen lds
    s_add_u32 m0, s99, 101376
    s_mov_b32 s62, 175872
    buffer_load_dwordx4 v9, s[20:23], s62 offen lds
    v_add_u32 v11, 65536, v10
    ds_read_b64_tr_b16 a[112:113], v11 offset:0
    ds_read_b64_tr_b16 a[114:115], v11 offset:512
    ds_read_b64_tr_b16 a[116:117], v11 offset:1024
    ds_read_b64_tr_b16 a[118:119], v11 offset:1536
    ds_read_b64_tr_b16 a[120:121], v11 offset:8192
    ds_read_b64_tr_b16 a[122:123], v11 offset:8704
    ds_read_b64_tr_b16 a[124:125], v11 offset:9216
    ds_read_b64_tr_b16 a[126:127], v11 offset:9728
    s_waitcnt lgkmcnt(0)
    s_waitcnt vmcnt(4)
    s_barrier
    s_add_u32 m0, s99, 114688
    s_mov_b32 s62, 148352
    buffer_load_dwordx4 v9, s[20:23], s62 offen lds
    s_add_u32 m0, s99, 115712
    s_mov_b32 s62, 157568
    buffer_load_dwordx4 v9, s[20:23], s62 offen lds
    s_add_u32 m0, s99, 116736
    s_mov_b32 s62, 166784
    buffer_load_dwordx4 v9, s[20:23], s62 offen lds
    s_add_u32 m0, s99, 117760
    s_mov_b32 s62, 176000
    buffer_load_dwordx4 v9, s[20:23], s62 offen lds
    v_add_u32 v11, 81920, v10
    ds_read_b64_tr_b16 a[144:145], v11 offset:0
    ds_read_b64_tr_b16 a[146:147], v11 offset:512
    ds_read_b64_tr_b16 a[148:149], v11 offset:1024
    ds_read_b64_tr_b16 a[150:151], v11 offset:1536
    ds_read_b64_tr_b16 a[152:153], v11 offset:8192
    ds_read_b64_tr_b16 a[154:155], v11 offset:8704
    ds_read_b64_tr_b16 a[156:157], v11 offset:9216
    ds_read_b64_tr_b16 a[158:159], v11 offset:9728
    s_waitcnt lgkmcnt(0)
    s_waitcnt vmcnt(4)
    s_barrier
    s_add_u32 m0, s99, 131072
    s_mov_b32 s62, 148480
    buffer_load_dwordx4 v9, s[20:23], s62 offen lds
    s_add_u32 m0, s99, 132096
    s_mov_b32 s62, 157696
    buffer_load_dwordx4 v9, s[20:23], s62 offen lds
    s_add_u32 m0, s99, 133120
    s_mov_b32 s62, 166912
    buffer_load_dwordx4 v9, s[20:23], s62 offen lds
    s_add_u32 m0, s99, 134144
    s_mov_b32 s62, 176128
    buffer_load_dwordx4 v9, s[20:23], s62 offen lds
    v_add_u32 v11, 98304, v10
    ds_read_b64_tr_b16 a[176:177], v11 offset:0
    ds_read_b64_tr_b16 a[178:179], v11 offset:512
    ds_read_b64_tr_b16 a[180:181], v11 offset:1024
    ds_read_b64_tr_b16 a[182:183], v11 offset:1536
    ds_read_b64_tr_b16 a[184:185], v11 offset:8192
    ds_read_b64_tr_b16 a[186:187], v11 offset:8704
    ds_read_b64_tr_b16 a[188:189], v11 offset:9216
    ds_read_b64_tr_b16 a[190:191], v11 offset:9728
    s_waitcnt lgkmcnt(0)
    s_waitcnt vmcnt(4)
    s_barrier
    v_add_u32 v11, 114688, v10
    ds_read_b64_tr_b16 a[208:209], v11 offset:0
    ds_read_b64_tr_b16 a[210:211], v11 offset:512
    ds_read_b64_tr_b16 a[212:213], v11 offset:1024
    ds_read_b64_tr_b16 a[214:215], v11 offset:1536
    ds_read_b64_tr_b16 a[216:217], v11 offset:8192
    ds_read_b64_tr_b16 a[218:219], v11 offset:8704
    ds_read_b64_tr_b16 a[220:221], v11 offset:9216
    ds_read_b64_tr_b16 a[222:223], v11 offset:9728
    s_waitcnt lgkmcnt(0)
    s_waitcnt vmcnt(0)
    s_barrier
    v_add_u32 v11, 131072, v10
    ds_read_b64_tr_b16 a[240:241], v11 offset:0
    ds_read_b64_tr_b16 a[242:243], v11 offset:512
    ds_read_b64_tr_b16 a[244:245], v11 offset:1024
    ds_read_b64_tr_b16 a[246:247], v11 offset:1536
    ds_read_b64_tr_b16 a[248:249], v11 offset:8192
    ds_read_b64_tr_b16 a[250:251], v11 offset:8704
    ds_read_b64_tr_b16 a[252:253], v11 offset:9216
    ds_read_b64_tr_b16 a[254:255], v11 offset:9728
    s_waitcnt lgkmcnt(0)
    s_barrier
    v_lshlrev_b32 v10, 2, v1
    v_lshrrev_b32 v5, 1, v2
    v_lshlrev_b32 v9, 10, v5
    v_and_b32 v5, 1, v4
    v_lshl_add_u32 v9, v5, 8, v9
    v_lshl_add_u32 v9, v3, 6, v9
    v_and_b32 v5, 1, v2
    v_lshl_add_u32 v9, v5, 5, v9
    s_and_b32 s60, s33, 1
    s_lshl_b32 s61, s60, 13
    s_lshr_b32 s62, s33, 1
    s_lshl_b32 s63, s62, 12
    s_add_u32 s61, s61, s63
    v_add_u32 v11, s61, v0
    v_and_b32 v17, 15, v1
    s_lshl_b32 s61, s60, 4
    v_add_u32 v17, s61, v17
    v_lshlrev_b32 v18, 2, v2
    v_sub_u32 v17, v17, v18
    v_cmp_le_i32 s[44:45], 0, v17
    v_cmp_le_i32 s[46:47], 1, v17
    v_cmp_le_i32 s[48:49], 2, v17
    v_cmp_le_i32 s[50:51], 3, v17
    v_cmp_le_i32 s[52:53], 16, v17
    v_cmp_le_i32 s[54:55], 17, v17
    v_cmp_le_i32 s[56:57], 18, v17
    v_cmp_le_i32 s[58:59], 19, v17
    v_mov_b32 v16, 0xce6e6b28
    v_and_b32 v5, 15, v1
    v_mul_u32_u24 v12, 1168, v5
    v_lshl_add_u32 v12, v2, 3, v12
    s_lshl_b32 s61, s33, 5
    s_add_u32 s61, s61, 16384
    v_add_u32 v12, s61, v12
    v_lshrrev_b32 v17, 3, v1
    v_and_b32 v18, 7, v1
    v_lshlrev_b32 v18, 4, v18
    s_lshl_b32 s61, s33, 3
    v_add_u32 v17, s61, v17
    v_mul_u32_u24 v13, 1168, v17
    v_add_u32 v13, v13, v18
    v_add_u32 v13, 16384, v13
    v_mul_u32_u24 v14, 18432, v17
    v_add_u32 v14, v14, v18
    s_mul_i32 s61, s34, 1152
    v_add_u32 v14, s61, v14
    s_lshl_b32 s38, s34, 1
    s_lshr_b32 s60, s33, 1
    s_add_u32 s38, s38, s60
    s_mov_b32 s36, s35
    s_lshl_b32 s60, s38, 8
    s_add_u32 s60, s60, 81789952
L_wf_77:
    buffer_load_dword v5, v10, s[4:7], s60 offen offset:0 sc1
    s_waitcnt vmcnt(0)
    v_cmp_eq_u32 vcc, 0, v5
    s_cbranch_vccz L_wfok_78
    s_sleep 2
    s_sub_u32 s37, s37, 1
    s_cbranch_scc0 L_wf_77
    s_mov_b32 s37, 0
L_wfok_78:
    s_lshl_b32 s39, s36, 5
    s_add_u32 s39, s39, s38
    v_mov_b64 v[20:21], -1
    v_mov_b64 v[22:23], -1
    s_add_u32 s60, s35, 56
    s_mul_i32 s60, s60, 589824
    s_add_u32 s60, s60, 83886080
    buffer_store_dwordx4 v[20:23], v14, s[4:7], s60 offen offset:0 sc1
    buffer_store_dwordx4 v[20:23], v14, s[4:7], s60 offen offset:128 sc1
    buffer_store_dwordx4 v[20:23], v14, s[4:7], s60 offen offset:256 sc1
    buffer_store_dwordx4 v[20:23], v14, s[4:7], s60 offen offset:384 sc1
    buffer_store_dwordx4 v[20:23], v14, s[4:7], s60 offen offset:512 sc1
    buffer_store_dwordx4 v[20:23], v14, s[4:7], s60 offen offset:640 sc1
    buffer_store_dwordx4 v[20:23], v14, s[4:7], s60 offen offset:768 sc1
    buffer_store_dwordx4 v[20:23], v14, s[4:7], s60 offen offset:896 sc1
    buffer_store_dwordx4 v[20:23], v14, s[4:7], s60 offen offset:1024 sc1
    s_add_u32 s60, s35, 60
    s_mul_i32 s60, s60, 589824
    s_add_u32 s60, s60, 83886080
    buffer_store_dwordx4 v[20:23], v14, s[4:7], s60 offen offset:0 sc1
    buffer_store_dwordx4 v[20:23], v14, s[4:7], s60 offen offset:128 sc1
    buffer_store_dwordx4 v[20:23], v14, s[4:7], s60 offen offset:256 sc1
    buffer_store_dwordx4 v[20:23], v14, s[4:7], s60 offen offset:384 sc1
    buffer_store_dwordx4 v[20:23], v14, s[4:7], s60 offen offset:512 sc1
    buffer_store_dwordx4 v[20:23], v14, s[4:7], s60 offen offset:640 sc1
    buffer_store_dwordx4 v[20:23], v14, s[4:7], s60 offen offset:768 sc1
    buffer_store_dwordx4 v[20:23], v14, s[4:7], s60 offen offset:896 sc1
    buffer_store_dwordx4 v[20:23], v14, s[4:7], s60 offen offset:1024 sc1
L_apf_79:
    s_lshl_b32 s60, s39, 13
    s_and_b32 s61, s33, 1
    s_lshl_b32 s61, s61, 12
    s_add_u32 s60, s60, s61
    s_add_u32 s60, s60, 33554432
    buffer_load_dwordx4 v[64:67], v0, s[4:7], s60 offen offset:0 sc1
    buffer_load_dwordx4 v[68:71], v0, s[4:7], s60 offen offset:1024 sc1
    buffer_load_dwordx4 v[72:75], v0, s[4:7], s60 offen offset:2048 sc1
    buffer_load_dwordx4 v[76:79], v0, s[4:7], s60 offen offset:3072 sc1
    s_lshl_b32 s60, s39, 14
    buffer_load_dwordx4 v[80:83], v0, s[4:7], s60 offen offset:0 sc1
    buffer_load_dwordx4 v[84:87], v0, s[4:7], s60 offen offset:1024 sc1
    buffer_load_dwordx4 v[88:91], v0, s[4:7], s60 offen offset:2048 sc1
    buffer_load_dwordx4 v[92:95], v0, s[4:7], s60 offen offset:3072 sc1
    s_add_u32 s60, s60, 4096
    buffer_load_dwordx4 v[96:99], v0, s[4:7], s60 offen offset:0 sc1
    buffer_load_dwordx4 v[100:103], v0, s[4:7], s60 offen offset:1024 sc1
    buffer_load_dwordx4 v[104:107], v0, s[4:7], s60 offen offset:2048 sc1
    buffer_load_dwordx4 v[108:111], v0, s[4:7], s60 offen offset:3072 sc1
    s_add_u32 s60, s60, 4096
    buffer_load_dwordx4 v[112:115], v0, s[4:7], s60 offen offset:0 sc1
    buffer_load_dwordx4 v[116:119], v0, s[4:7], s60 offen offset:1024 sc1
    buffer_load_dwordx4 v[120:123], v0, s[4:7], s60 offen offset:2048 sc1
    buffer_load_dwordx4 v[124:127], v0, s[4:7], s60 offen offset:3072 sc1
    s_add_u32 s60, s60, 4096
    buffer_load_dwordx4 v[128:131], v0, s[4:7], s60 offen offset:0 sc1
    buffer_load_dwordx4 v[132:135], v0, s[4:7], s60 offen offset:1024 sc1
    buffer_load_dwordx4 v[136:139], v0, s[4:7], s60 offen offset:2048 sc1
    buffer_load_dwordx4 v[140:143], v0, s[4:7], s60 offen offset:3072 sc1
L_atop_80:
    s_waitcnt vmcnt(0)
    v_mfma_f32_16x16x32_bf16 v[176:179], v[80:83], v[64:67], 0
    v_mfma_f32_16x16x32_bf16 v[180:183], v[96:99], v[64:67], 0
    v_mfma_f32_16x16x32_bf16 v[176:179], v[84:87], v[68:71], v[176:179]
    v_mfma_f32_16x16x32_bf16 v[180:183], v[100:103], v[68:71], v[180:183]
    v_mfma_f32_16x16x32_bf16 v[176:179], v[88:91], v[72:75], v[176:179]
    v_mfma_f32_16x16x32_bf16 v[180:183], v[104:107], v[72:75], v[180:183]
    v_mfma_f32_16x16x32_bf16 v[176:179], v[92:95], v[76:79], v[176:179]
    v_mfma_f32_16x16x32_bf16 v[180:183], v[108:111], v[76:79], v[180:183]
    v_mov_b32 v161, 0
    v_mov_b32 v163, 0
    v_mov_b32 v165, 0
    v_mov_b32 v167, 0
    v_mov_b32 v169, 0
    v_mov_b32 v171, 0
    v_mov_b32 v173, 0
    v_mov_b32 v175, 0
    s_lshl_b32 s41, s39, 12
    s_add_u32 s41, s41, 50331648
    v_cvt_pk_bf16_f32 v177, v176, v177
    v_lshlrev_b32 v176, 16, v177
    v_and_b32 v177, 0xffff0000, v177
    v_cvt_pk_bf16_f32 v179, v178, v179
    v_lshlrev_b32 v178, 16, v179
    v_and_b32 v179, 0xffff0000, v179
    v_cvt_pk_bf16_f32 v181, v180, v181
    v_lshlrev_b32 v180, 16, v181
    v_and_b32 v181, 0xffff0000, v181
    v_cvt_pk_bf16_f32 v183, v182, v183
    v_lshlrev_b32 v182, 16, v183
    v_and_b32 v183, 0xffff0000, v183
    v_mul_f32 v176, 0x3db504f3, v176
    v_mul_f32 v177, 0x3db504f3, v177
    v_mul_f32 v178, 0x3db504f3, v178
    v_mul_f32 v179, 0x3db504f3, v179
    v_mul_f32 v180, 0x3db504f3, v180
    v_mul_f32 v181, 0x3db504f3, v181
    v_mul_f32 v182, 0x3db504f3, v182
    v_mul_f32 v183, 0x3db504f3, v183
    v_cvt_pk_bf16_f32 v177, v176, v177
    v_lshlrev_b32 v176, 16, v177
    v_and_b32 v177, 0xffff0000, v177
    v_cvt_pk_bf16_f32 v179, v178, v179
    v_lshlrev_b32 v178, 16, v179
    v_and_b32 v179, 0xffff0000, v179
    v_cvt_pk_bf16_f32 v181, v180, v181
    v_lshlrev_b32 v180, 16, v181
    v_and_b32 v181, 0xffff0000, v181
    v_cvt_pk_bf16_f32 v183, v182, v183
    v_lshlrev_b32 v182, 16, v183
    v_and_b32 v183, 0xffff0000, v183
    v_cndmask_b32 v176, v16, v176, s[44:45]
    v_cndmask_b32 v177, v16, v177, s[46:47]
    v_cndmask_b32 v178, v16, v178, s[48:49]
    v_cndmask_b32 v179, v16, v179, s[50:51]
    v_cndmask_b32 v180, v16, v180, s[52:53]
    v_cndmask_b32 v181, v16, v181, s[54:55]
    v_cndmask_b32 v182, v16, v182, s[56:57]
    v_cndmask_b32 v183, v16, v183, s[58:59]
    v_max3_f32 v17, v176, v177, v178
    v_max3_f32 v17, v17, v179, v180
    v_max3_f32 v17, v17, v181, v182
    v_max_f32 v17, v17, v183
    s_lshl_b32 s60, s39, 7
    s_add_u32 s60, s60, 81847296
L_wf_84:
    buffer_load_dword v5, off, s[4:7], s60 offset:0 sc1
    s_waitcnt vmcnt(0)
    v_cmp_eq_u32 vcc, 0, v5
    s_cbranch_vccz L_wfok_85
    s_sleep 2
    s_sub_u32 s37, s37, 1
    s_cbranch_scc0 L_wf_84
    s_mov_b32 s37, 0
L_wfok_85:
L_full_82:
L_full_82_r:
    buffer_load_dwordx4 v[144:147], v9, s[4:7], s41 offen offset:0 sc1
    buffer_load_dwordx4 v[148:151], v9, s[4:7], s41 offen offset:16 sc1
    buffer_load_dwordx4 v[152:155], v9, s[4:7], s41 offen offset:2048 sc1
    buffer_load_dwordx4 v[156:159], v9, s[4:7], s41 offen offset:2064 sc1
    buffer_load_dword v160, v10, s[4:7], s41 offen offset:512 sc1
    buffer_load_dword v162, v10, s[4:7], s41 offen offset:768 sc1
    buffer_load_dword v164, v10, s[4:7], s41 offen offset:1536 sc1
    buffer_load_dword v166, v10, s[4:7], s41 offen offset:1792 sc1
    buffer_load_dword v168, v10, s[4:7], s41 offen offset:2560 sc1
    buffer_load_dword v170, v10, s[4:7], s41 offen offset:2816 sc1
    buffer_load_dword v172, v10, s[4:7], s41 offen offset:3584 sc1
    buffer_load_dword v174, v10, s[4:7], s41 offen offset:3840 sc1
    s_waitcnt vmcnt(8)
    v_mfma_f32_16x16x32_bf16 v[184:187], v[144:147], v[64:67], 0
    v_max_u32 v5, v144, v145
    v_max3_u32 v5, v5, v146, v147
    v_mfma_f32_16x16x32_bf16 v[184:187], v[148:151], v[68:71], v[184:187]
    v_max3_u32 v5, v5, v148, v149
    v_max3_u32 v5, v5, v150, v151
    v_mfma_f32_16x16x32_bf16 v[184:187], v[152:155], v[72:75], v[184:187]
    v_max3_u32 v5, v5, v152, v153
    v_max3_u32 v5, v5, v154, v155
    v_mfma_f32_16x16x32_bf16 v[184:187], v[156:159], v[76:79], v[184:187]
    v_max3_u32 v5, v5, v156, v157
    v_max3_u32 v5, v5, v158, v159
    s_waitcnt vmcnt(0)
    v_max3_u32 v5, v5, v160, v162
    v_max3_u32 v5, v5, v164, v166
    v_max3_u32 v5, v5, v168, v170
    v_max3_u32 v5, v5, v172, v174
    v_cmp_eq_u32 vcc, -1, v5
    s_cbranch_vccz L_pubok_83
    s_sub_u32 s37, s37, 1
    s_cbranch_scc0 L_full_82_r
    s_mov_b32 s37, 0
L_pubok_83:
    v_cvt_pk_bf16_f32 v185, v184, v185
    v_lshlrev_b32 v184, 16, v185
    v_and_b32 v185, 0xffff0000, v185
    v_mul_f32 v184, 0x3db504f3, v184
    v_mul_f32 v185, 0x3db504f3, v185
    v_cvt_pk_bf16_f32 v185, v184, v185
    v_lshlrev_b32 v184, 16, v185
    v_and_b32 v185, 0xffff0000, v185
    v_max3_f32 v17, v17, v184, v185
    v_mov_b32 v18, v17
    s_nop 1
    v_permlane32_swap_b32 v17, v18
    v_max_f32 v17, v17, v18
    v_mov_b32 v18, v17
    s_nop 1
    v_permlane16_swap_b32 v17, v18
    v_max_f32 v17, v17, v18
    v_sub_f32 v176, v176, v17
    v_sub_f32 v177, v177, v17
    v_sub_f32 v178, v178, v17
    v_sub_f32 v179, v179, v17
    v_sub_f32 v180, v180, v17
    v_sub_f32 v181, v181, v17
    v_sub_f32 v182, v182, v17
    v_sub_f32 v183, v183, v17
    v_sub_f32 v184, v184, v17
    v_sub_f32 v185, v185, v17
    v_mul_f32 v176, 0x3fb8aa3b, v176
    v_mul_f32 v177, 0x3fb8aa3b, v177
    v_mul_f32 v178, 0x3fb8aa3b, v178
    v_mul_f32 v179, 0x3fb8aa3b, v179
    v_mul_f32 v180, 0x3fb8aa3b, v180
    v_mul_f32 v181, 0x3fb8aa3b, v181
    v_mul_f32 v182, 0x3fb8aa3b, v182
    v_mul_f32 v183, 0x3fb8aa3b, v183
    v_mul_f32 v184, 0x3fb8aa3b, v184
    v_mul_f32 v185, 0x3fb8aa3b, v185
    v_exp_f32 v176, v176
    v_exp_f32 v177, v177
    v_exp_f32 v178, v178
    v_exp_f32 v179, v179
    v_exp_f32 v180, v180
    v_exp_f32 v181, v181
    v_exp_f32 v182, v182
    v_exp_f32 v183, v183
    v_exp_f32 v184, v184
    v_exp_f32 v185, v185
    v_add_f32 v17, v176, v177
    v_add_f32 v17, v17, v178
    v_add_f32 v17, v17, v179
    v_add_f32 v17, v17, v180
    v_add_f32 v17, v17, v181
    v_add_f32 v17, v17, v182
    v_add_f32 v17, v17, v183
    v_add_f32 v17, v17, v184
    v_add_f32 v17, v17, v185
    v_mov_b32 v18, v17
    s_nop 1
    v_permlane32_swap_b32 v17, v18
    v_add_f32 v17, v17, v18
    v_mov_b32 v18, v17
    s_nop 1
    v_permlane16_swap_b32 v17, v18
    v_add_f32 v17, v17, v18
    v_rcp_f32 v17, v17
    s_nop 0
    v_mul_f32 v176, v176, v17
    v_mul_f32 v177, v177, v17
    v_mul_f32 v178, v178, v17
    v_mul_f32 v179, v179, v17
    v_mul_f32 v180, v180, v17
    v_mul_f32 v181, v181, v17
    v_mul_f32 v182, v182, v17
    v_mul_f32 v183, v183, v17
    v_mul_f32 v184, v184, v17
    v_mul_f32 v185, v185, v17
    v_cvt_pk_bf16_f32 v176, v176, v177
    v_cvt_pk_bf16_f32 v177, v178, v179
    v_cvt_pk_bf16_f32 v178, v180, v181
    v_cvt_pk_bf16_f32 v179, v182, v183
    v_cvt_pk_bf16_f32 v184, v184, v185
    v_mov_b32 v185, 0
    s_nop 1
    v_mfma_f32_16x16x32_bf16 v[188:191], v[112:115], v[176:179], 0
    v_mfma_f32_16x16x32_bf16 v[192:195], v[116:119], v[176:179], 0
    v_mfma_f32_16x16x16_bf16 v[188:191], v[160:161], v[184:185], v[188:191]
    v_mfma_f32_16x16x16_bf16 v[192:195], v[162:163], v[184:185], v[192:195]
    v_mfma_f32_16x16x32_bf16 v[196:199], v[120:123], v[176:179], 0
    v_mfma_f32_16x16x32_bf16 v[200:203], v[124:127], v[176:179], 0
    v_mfma_f32_16x16x16_bf16 v[196:199], v[164:165], v[184:185], v[196:199]
    v_mfma_f32_16x16x16_bf16 v[200:203], v[166:167], v[184:185], v[200:203]
    v_mfma_f32_16x16x32_bf16 v[204:207], v[128:131], v[176:179], 0
    v_mfma_f32_16x16x32_bf16 v[208:211], v[132:135], v[176:179], 0
    v_mfma_f32_16x16x16_bf16 v[204:207], v[168:169], v[184:185], v[204:207]
    v_mfma_f32_16x16x16_bf16 v[208:211], v[170:171], v[184:185], v[208:211]
    v_cvt_pk_bf16_f32 v188, v188, v189
    v_cvt_pk_bf16_f32 v189, v190, v191
    v_cvt_pk_bf16_f32 v190, v192, v193
    v_cvt_pk_bf16_f32 v191, v194, v195
    ds_write_b128 v11, v[188:191] offset:0
    v_mfma_f32_16x16x32_bf16 v[212:215], v[136:139], v[176:179], 0
    v_mfma_f32_16x16x32_bf16 v[216:219], v[140:143], v[176:179], 0
    v_mfma_f32_16x16x16_bf16 v[212:215], v[172:173], v[184:185], v[212:215]
    v_mfma_f32_16x16x16_bf16 v[216:219], v[174:175], v[184:185], v[216:219]
    v_cvt_pk_bf16_f32 v196, v196, v197
    v_cvt_pk_bf16_f32 v197, v198, v199
    v_cvt_pk_bf16_f32 v198, v200, v201
    v_cvt_pk_bf16_f32 v199, v202, v203
    ds_write_b128 v11, v[196:199] offset:1024
    v_cvt_pk_bf16_f32 v204, v204, v205
    v_cvt_pk_bf16_f32 v205, v206, v207
    v_cvt_pk_bf16_f32 v206, v208, v209
    v_cvt_pk_bf16_f32 v207, v210, v211
    ds_write_b128 v11, v[204:207] offset:2048
    v_cvt_pk_bf16_f32 v212, v212, v213
    v_cvt_pk_bf16_f32 v213, v214, v215
    v_cvt_pk_bf16_f32 v214, v216, v217
    v_cvt_pk_bf16_f32 v215, v218, v219
    ds_write_b128 v11, v[212:215] offset:3072
    s_mul_i32 s40, s36, 589824
    s_add_u32 s40, s40, 83886080
    s_waitcnt lgkmcnt(0)
    s_barrier
    ds_read_b128 v[144:147], v0 offset:0
    ds_read_b128 v[148:151], v0 offset:8192
    ds_read_b128 v[152:155], v0 offset:1024
    ds_read_b128 v[156:159], v0 offset:9216
    ds_read_b128 v[160:163], v0 offset:2048
    ds_read_b128 v[164:167], v0 offset:10240
    ds_read_b128 v[168:171], v0 offset:3072
    ds_read_b128 v[172:175], v0 offset:11264
    ds_read_b128 v[176:179], v0 offset:4096
    ds_read_b128 v[180:183], v0 offset:12288
    ds_read_b128 v[184:187], v0 offset:5120
    ds_read_b128 v[188:191], v0 offset:13312
    ds_read_b128 v[192:195], v0 offset:6144
    ds_read_b128 v[196:199], v0 offset:14336
    ds_read_b128 v[200:203], v0 offset:7168
    ds_read_b128 v[204:207], v0 offset:15360
    s_add_u32 s39, s39, 128
    s_waitcnt lgkmcnt(15)
    v_mfma_f32_16x16x32_bf16 v[20:23], v[224:227], v[144:147], 0
    s_waitcnt lgkmcnt(14)
    v_mfma_f32_16x16x32_bf16 v[24:27], v[224:227], v[148:151], 0
    s_waitcnt lgkmcnt(13)
    v_mfma_f32_16x16x32_bf16 v[20:23], v[228:231], v[152:155], v[20:23]
    s_waitcnt lgkmcnt(12)
    v_mfma_f32_16x16x32_bf16 v[24:27], v[228:231], v[156:159], v[24:27]
    s_waitcnt lgkmcnt(11)
    v_mfma_f32_16x16x32_bf16 v[20:23], v[232:235], v[160:163], v[20:23]
    s_waitcnt lgkmcnt(10)
    v_mfma_f32_16x16x32_bf16 v[24:27], v[232:235], v[164:167], v[24:27]
    s_waitcnt lgkmcnt(9)
    v_mfma_f32_16x16x32_bf16 v[20:23], v[236:239], v[168:171], v[20:23]
    s_waitcnt lgkmcnt(8)
    v_mfma_f32_16x16x32_bf16 v[24:27], v[236:239], v[172:175], v[24:27]
    s_waitcnt lgkmcnt(7)
    v_mfma_f32_16x16x32_bf16 v[20:23], v[240:243], v[176:179], v[20:23]
    s_waitcnt lgkmcnt(6)
    v_mfma_f32_16x16x32_bf16 v[24:27], v[240:243], v[180:183], v[24:27]
    s_waitcnt lgkmcnt(5)
    v_mfma_f32_16x16x32_bf16 v[20:23], v[244:247], v[184:187], v[20:23]
    s_waitcnt lgkmcnt(4)
    v_mfma_f32_16x16x32_bf16 v[24:27], v[244:247], v[188:191], v[24:27]
    s_waitcnt lgkmcnt(3)
    v_mfma_f32_16x16x32_bf16 v[20:23], v[248:251], v[192:195], v[20:23]
    s_waitcnt lgkmcnt(2)
    v_mfma_f32_16x16x32_bf16 v[24:27], v[248:251], v[196:199], v[24:27]
    s_waitcnt lgkmcnt(1)
    v_mfma_f32_16x16x32_bf16 v[20:23], v[252:255], v[200:203], v[20:23]
    s_waitcnt lgkmcnt(0)
    v_mfma_f32_16x16x32_bf16 v[24:27], v[252:255], v[204:207], v[24:27]
    s_cmp_ge_u32 s36, 32
    s_cbranch_scc1 L_nopf_86
    s_lshl_b32 s60, s39, 13
    s_and_b32 s61, s33, 1
    s_lshl_b32 s61, s61, 12
    s_add_u32 s60, s60, s61
    s_add_u32 s60, s60, 33554432
    buffer_load_dwordx4 v[64:67], v0, s[4:7], s60 offen offset:0 sc1
    buffer_load_dwordx4 v[68:71], v0, s[4:7], s60 offen offset:1024 sc1
    buffer_load_dwordx4 v[72:75], v0, s[4:7], s60 offen offset:2048 sc1
    buffer_load_dwordx4 v[76:79], v0, s[4:7], s60 offen offset:3072 sc1
    s_lshl_b32 s60, s39, 14
    buffer_load_dwordx4 v[80:83], v0, s[4:7], s60 offen offset:0 sc1
    buffer_load_dwordx4 v[84:87], v0, s[4:7], s60 offen offset:1024 sc1
    buffer_load_dwordx4 v[88:91], v0, s[4:7], s60 offen offset:2048 sc1
    buffer_load_dwordx4 v[92:95], v0, s[4:7], s60 offen offset:3072 sc1
    s_add_u32 s60, s60, 4096
    buffer_load_dwordx4 v[96:99], v0, s[4:7], s60 offen offset:0 sc1
    buffer_load_dwordx4 v[100:103], v0, s[4:7], s60 offen offset:1024 sc1
    buffer_load_dwordx4 v[104:107], v0, s[4:7], s60 offen offset:2048 sc1
    buffer_load_dwordx4 v[108:111], v0, s[4:7], s60 offen offset:3072 sc1
    s_add_u32 s60, s60, 4096
    buffer_load_dwordx4 v[112:115], v0, s[4:7], s60 offen offset:0 sc1
    buffer_load_dwordx4 v[116:119], v0, s[4:7], s60 offen offset:1024 sc1
    buffer_load_dwordx4 v[120:123], v0, s[4:7], s60 offen offset:2048 sc1
    buffer_load_dwordx4 v[124:127], v0, s[4:7], s60 offen offset:3072 sc1
    s_add_u32 s60, s60, 4096
    buffer_load_dwordx4 v[128:131], v0, s[4:7], s60 offen offset:0 sc1
    buffer_load_dwordx4 v[132:135], v0, s[4:7], s60 offen offset:1024 sc1
    buffer_load_dwordx4 v[136:139], v0, s[4:7], s60 offen offset:2048 sc1
    buffer_load_dwordx4 v[140:143], v0, s[4:7], s60 offen offset:3072 sc1
L_nopf_86:
    v_mfma_f32_16x16x32_bf16 v[28:31], a[0:3], v[144:147], 0
    v_mfma_f32_16x16x32_bf16 v[32:35], a[0:3], v[148:151], 0
    v_mfma_f32_16x16x32_bf16 v[28:31], a[4:7], v[152:155], v[28:31]
    v_mfma_f32_16x16x32_bf16 v[32:35], a[4:7], v[156:159], v[32:35]
    v_mfma_f32_16x16x32_bf16 v[28:31], a[8:11], v[160:163], v[28:31]
    v_mfma_f32_16x16x32_bf16 v[32:35], a[8:11], v[164:167], v[32:35]
    v_mfma_f32_16x16x32_bf16 v[28:31], a[12:15], v[168:171], v[28:31]
    v_mfma_f32_16x16x32_bf16 v[32:35], a[12:15], v[172:175], v[32:35]
    v_cvt_pk_bf16_f32 v20, v20, v21
    v_cvt_pk_bf16_f32 v21, v22, v23
    v_mfma_f32_16x16x32_bf16 v[28:31], a[16:19], v[176:179], v[28:31]
    ds_write_b64 v12, v[20:21] offset:0
    v_cvt_pk_bf16_f32 v24, v24, v25
    v_cvt_pk_bf16_f32 v25, v26, v27
    v_mfma_f32_16x16x32_bf16 v[32:35], a[16:19], v[180:183], v[32:35]
    ds_write_b64 v12, v[24:25] offset:18688
    v_mfma_f32_16x16x32_bf16 v[28:31], a[20:23], v[184:187], v[28:31]
    v_mfma_f32_16x16x32_bf16 v[32:35], a[20:23], v[188:191], v[32:35]
    v_mfma_f32_16x16x32_bf16 v[28:31], a[24:27], v[192:195], v[28:31]
    v_mfma_f32_16x16x32_bf16 v[32:35], a[24:27], v[196:199], v[32:35]
    v_mfma_f32_16x16x32_bf16 v[28:31], a[28:31], v[200:203], v[28:31]
    v_mfma_f32_16x16x32_bf16 v[32:35], a[28:31], v[204:207], v[32:35]
    s_waitcnt lgkmcnt(0)
    s_barrier
    ds_read_b128 v[44:47], v13 offset:0
    v_mfma_f32_16x16x32_bf16 v[36:39], a[32:35], v[144:147], 0
    v_mfma_f32_16x16x32_bf16 v[40:43], a[32:35], v[148:151], 0
    v_mfma_f32_16x16x32_bf16 v[36:39], a[36:39], v[152:155], v[36:39]
    v_mfma_f32_16x16x32_bf16 v[40:43], a[36:39], v[156:159], v[40:43]
    v_mfma_f32_16x16x32_bf16 v[36:39], a[40:43], v[160:163], v[36:39]
    v_mfma_f32_16x16x32_bf16 v[40:43], a[40:43], v[164:167], v[40:43]
    s_waitcnt lgkmcnt(0)
    buffer_store_dwordx4 v[44:47], v14, s[4:7], s40 offen offset:0 sc1
    v_mfma_f32_16x16x32_bf16 v[36:39], a[44:47], v[168:171], v[36:39]
    v_mfma_f32_16x16x32_bf16 v[40:43], a[44:47], v[172:175], v[40:43]
    v_cvt_pk_bf16_f32 v28, v28, v29
    v_cvt_pk_bf16_f32 v29, v30, v31
    v_mfma_f32_16x16x32_bf16 v[36:39], a[48:51], v[176:179], v[36:39]
    ds_write_b64 v12, v[28:29] offset:128
    v_cvt_pk_bf16_f32 v32, v32, v33
    v_cvt_pk_bf16_f32 v33, v34, v35
    v_mfma_f32_16x16x32_bf16 v[40:43], a[48:51], v[180:183], v[40:43]
    ds_write_b64 v12, v[32:33] offset:18816
    v_mfma_f32_16x16x32_bf16 v[36:39], a[52:55], v[184:187], v[36:39]
    v_mfma_f32_16x16x32_bf16 v[40:43], a[52:55], v[188:191], v[40:43]
    v_mfma_f32_16x16x32_bf16 v[36:39], a[56:59], v[192:195], v[36:39]
    v_mfma_f32_16x16x32_bf16 v[40:43], a[56:59], v[196:199], v[40:43]
    v_mfma_f32_16x16x32_bf16 v[36:39], a[60:63], v[200:203], v[36:39]
    v_mfma_f32_16x16x32_bf16 v[40:43], a[60:63], v[204:207], v[40:43]
    s_waitcnt lgkmcnt(0)
    s_barrier
    ds_read_b128 v[48:51], v13 offset:128
    v_mfma_f32_16x16x32_bf16 v[20:23], a[64:67], v[144:147], 0
    v_mfma_f32_16x16x32_bf16 v[24:27], a[64:67], v[148:151], 0
    v_mfma_f32_16x16x32_bf16 v[20:23], a[68:71], v[152:155], v[20:23]
    v_mfma_f32_16x16x32_bf16 v[24:27], a[68:71], v[156:159], v[24:27]
    v_mfma_f32_16x16x32_bf16 v[20:23], a[72:75], v[160:163], v[20:23]
    v_mfma_f32_16x16x32_bf16 v[24:27], a[72:75], v[164:167], v[24:27]
    s_waitcnt lgkmcnt(0)
    buffer_store_dwordx4 v[48:51], v14, s[4:7], s40 offen offset:128 sc1
    v_mfma_f32_16x16x32_bf16 v[20:23], a[76:79], v[168:171], v[20:23]
    v_mfma_f32_16x16x32_bf16 v[24:27], a[76:79], v[172:175], v[24:27]
    v_cvt_pk_bf16_f32 v36, v36, v37
    v_cvt_pk_bf16_f32 v37, v38, v39
    v_mfma_f32_16x16x32_bf16 v[20:23], a[80:83], v[176:179], v[20:23]
    ds_write_b64 v12, v[36:37] offset:256
    v_cvt_pk_bf16_f32 v40, v40, v41
    v_cvt_pk_bf16_f32 v41, v42, v43
    v_mfma_f32_16x16x32_bf16 v[24:27], a[80:83], v[180:183], v[24:27]
    ds_write_b64 v12, v[40:41] offset:18944
    v_mfma_f32_16x16x32_bf16 v[20:23], a[84:87], v[184:187], v[20:23]
    v_mfma_f32_16x16x32_bf16 v[24:27], a[84:87], v[188:191], v[24:27]
    v_mfma_f32_16x16x32_bf16 v[20:23], a[88:91], v[192:195], v[20:23]
    v_mfma_f32_16x16x32_bf16 v[24:27], a[88:91], v[196:199], v[24:27]
    v_mfma_f32_16x16x32_bf16 v[20:23], a[92:95], v[200:203], v[20:23]
    v_mfma_f32_16x16x32_bf16 v[24:27], a[92:95], v[204:207], v[24:27]
    s_waitcnt lgkmcnt(0)
    s_barrier
    ds_read_b128 v[44:47], v13 offset:256
    v_mfma_f32_16x16x32_bf16 v[28:31], a[96:99], v[144:147], 0
    v_mfma_f32_16x16x32_bf16 v[32:35], a[96:99], v[148:151], 0
    v_mfma_f32_16x16x32_bf16 v[28:31], a[100:103], v[152:155], v[28:31]
    v_mfma_f32_16x16x32_bf16 v[32:35], a[100:103], v[156:159], v[32:35]
    v_mfma_f32_16x16x32_bf16 v[28:31], a[104:107], v[160:163], v[28:31]
    v_mfma_f32_16x16x32_bf16 v[32:35], a[104:107], v[164:167], v[32:35]
    s_waitcnt lgkmcnt(0)
    buffer_store_dwordx4 v[44:47], v14, s[4:7], s40 offen offset:256 sc1
    v_mfma_f32_16x16x32_bf16 v[28:31], a[108:111], v[168:171], v[28:31]
    v_mfma_f32_16x16x32_bf16 v[32:35], a[108:111], v[172:175], v[32:35]
    v_cvt_pk_bf16_f32 v20, v20, v21
    v_cvt_pk_bf16_f32 v21, v22, v23
    v_mfma_f32_16x16x32_bf16 v[28:31], a[112:115], v[176:179], v[28:31]
    ds_write_b64 v12, v[20:21] offset:384
    v_cvt_pk_bf16_f32 v24, v24, v25
    v_cvt_pk_bf16_f32 v25, v26, v27
    v_mfma_f32_16x16x32_bf16 v[32:35], a[112:115], v[180:183], v[32:35]
    ds_write_b64 v12, v[24:25] offset:19072
    v_mfma_f32_16x16x32_bf16 v[28:31], a[116:119], v[184:187], v[28:31]
    v_mfma_f32_16x16x32_bf16 v[32:35], a[116:119], v[188:191], v[32:35]
    v_mfma_f32_16x16x32_bf16 v[28:31], a[120:123], v[192:195], v[28:31]
    v_mfma_f32_16x16x32_bf16 v[32:35], a[120:123], v[196:199], v[32:35]
    v_mfma_f32_16x16x32_bf16 v[28:31], a[124:127], v[200:203], v[28:31]
    v_mfma_f32_16x16x32_bf16 v[32:35], a[124:127], v[204:207], v[32:35]
    s_waitcnt lgkmcnt(0)
    s_barrier
    ds_read_b128 v[48:51], v13 offset:384
    v_mfma_f32_16x16x32_bf16 v[36:39], a[128:131], v[144:147], 0
    v_mfma_f32_16x16x32_bf16 v[40:43], a[128:131], v[148:151], 0
    v_mfma_f32_16x16x32_bf16 v[36:39], a[132:135], v[152:155], v[36:39]
    v_mfma_f32_16x16x32_bf16 v[40:43], a[132:135], v[156:159], v[40:43]
    v_mfma_f32_16x16x32_bf16 v[36:39], a[136:139], v[160:163], v[36:39]
    v_mfma_f32_16x16x32_bf16 v[40:43], a[136:139], v[164:167], v[40:43]
    s_waitcnt lgkmcnt(0)
    buffer_store_dwordx4 v[48:51], v14, s[4:7], s40 offen offset:384 sc1
    v_mfma_f32_16x16x32_bf16 v[36:39], a[140:143], v[168:171], v[36:39]
    v_mfma_f32_16x16x32_bf16 v[40:43], a[140:143], v[172:175], v[40:43]
    v_cvt_pk_bf16_f32 v28, v28, v29
    v_cvt_pk_bf16_f32 v29, v30, v31
    v_mfma_f32_16x16x32_bf16 v[36:39], a[144:147], v[176:179], v[36:39]
    ds_write_b64 v12, v[28:29] offset:512
    v_cvt_pk_bf16_f32 v32, v32, v33
    v_cvt_pk_bf16_f32 v33, v34, v35
    v_mfma_f32_16x16x32_bf16 v[40:43], a[144:147], v[180:183], v[40:43]
    ds_write_b64 v12, v[32:33] offset:19200
    v_mfma_f32_16x16x32_bf16 v[36:39], a[148:151], v[184:187], v[36:39]
    v_mfma_f32_16x16x32_bf16 v[40:43], a[148:151], v[188:191], v[40:43]
    v_mfma_f32_16x16x32_bf16 v[36:39], a[152:155], v[192:195], v[36:39]
    v_mfma_f32_16x16x32_bf16 v[40:43], a[152:155], v[196:199], v[40:43]
    v_mfma_f32_16x16x32_bf16 v[36:39], a[156:159], v[200:203], v[36:39]
    v_mfma_f32_16x16x32_bf16 v[40:43], a[156:159], v[204:207], v[40:43]
    s_waitcnt lgkmcnt(0)
    s_barrier
    ds_read_b128 v[44:47], v13 offset:512
    v_mfma_f32_16x16x32_bf16 v[20:23], a[160:163], v[144:147], 0
    v_mfma_f32_16x16x32_bf16 v[24:27], a[160:163], v[148:151], 0
    v_mfma_f32_16x16x32_bf16 v[20:23], a[164:167], v[152:155], v[20:23]
    v_mfma_f32_16x16x32_bf16 v[24:27], a[164:167], v[156:159], v[24:27]
    v_mfma_f32_16x16x32_bf16 v[20:23], a[168:171], v[160:163], v[20:23]
    v_mfma_f32_16x16x32_bf16 v[24:27], a[168:171], v[164:167], v[24:27]
    s_waitcnt lgkmcnt(0)
    buffer_store_dwordx4 v[44:47], v14, s[4:7], s40 offen offset:512 sc1
    v_mfma_f32_16x16x32_bf16 v[20:23], a[172:175], v[168:171], v[20:23]
    v_mfma_f32_16x16x32_bf16 v[24:27], a[172:175], v[172:175], v[24:27]
    v_cvt_pk_bf16_f32 v36, v36, v37
    v_cvt_pk_bf16_f32 v37, v38, v39
    v_mfma_f32_16x16x32_bf16 v[20:23], a[176:179], v[176:179], v[20:23]
    ds_write_b64 v12, v[36:37] offset:640
    v_cvt_pk_bf16_f32 v40, v40, v41
    v_cvt_pk_bf16_f32 v41, v42, v43
    v_mfma_f32_16x16x32_bf16 v[24:27], a[176:179], v[180:183], v[24:27]
    ds_write_b64 v12, v[40:41] offset:19328
    v_mfma_f32_16x16x32_bf16 v[20:23], a[180:183], v[184:187], v[20:23]
    v_mfma_f32_16x16x32_bf16 v[24:27], a[180:183], v[188:191], v[24:27]
    v_mfma_f32_16x16x32_bf16 v[20:23], a[184:187], v[192:195], v[20:23]
    v_mfma_f32_16x16x32_bf16 v[24:27], a[184:187], v[196:199], v[24:27]
    v_mfma_f32_16x16x32_bf16 v[20:23], a[188:191], v[200:203], v[20:23]
    v_mfma_f32_16x16x32_bf16 v[24:27], a[188:191], v[204:207], v[24:27]
    s_waitcnt lgkmcnt(0)
    s_barrier
    ds_read_b128 v[48:51], v13 offset:640
    v_mfma_f32_16x16x32_bf16 v[28:31], a[192:195], v[144:147], 0
    v_mfma_f32_16x16x32_bf16 v[32:35], a[192:195], v[148:151], 0
    v_mfma_f32_16x16x32_bf16 v[28:31], a[196:199], v[152:155], v[28:31]
    v_mfma_f32_16x16x32_bf16 v[32:35], a[196:199], v[156:159], v[32:35]
    v_mfma_f32_16x16x32_bf16 v[28:31], a[200:203], v[160:163], v[28:31]
    v_mfma_f32_16x16x32_bf16 v[32:35], a[200:203], v[164:167], v[32:35]
    s_waitcnt lgkmcnt(0)
    buffer_store_dwordx4 v[48:51], v14, s[4:7], s40 offen offset:640 sc1
    v_mfma_f32_16x16x32_bf16 v[28:31], a[204:207], v[168:171], v[28:31]
    v_mfma_f32_16x16x32_bf16 v[32:35], a[204:207], v[172:175], v[32:35]
    v_cvt_pk_bf16_f32 v20, v20, v21
    v_cvt_pk_bf16_f32 v21, v22, v23
    v_mfma_f32_16x16x32_bf16 v[28:31], a[208:211], v[176:179], v[28:31]
    ds_write_b64 v12, v[20:21] offset:768
    v_cvt_pk_bf16_f32 v24, v24, v25
    v_cvt_pk_bf16_f32 v25, v26, v27
    v_mfma_f32_16x16x32_bf16 v[32:35], a[208:211], v[180:183], v[32:35]
    ds_write_b64 v12, v[24:25] offset:19456
    v_mfma_f32_16x16x32_bf16 v[28:31], a[212:215], v[184:187], v[28:31]
    v_mfma_f32_16x16x32_bf16 v[32:35], a[212:215], v[188:191], v[32:35]
    v_mfma_f32_16x16x32_bf16 v[28:31], a[216:219], v[192:195], v[28:31]
    v_mfma_f32_16x16x32_bf16 v[32:35], a[216:219], v[196:199], v[32:35]
    v_mfma_f32_16x16x32_bf16 v[28:31], a[220:223], v[200:203], v[28:31]
    v_mfma_f32_16x16x32_bf16 v[32:35], a[220:223], v[204:207], v[32:35]
    s_waitcnt lgkmcnt(0)
    s_barrier
    ds_read_b128 v[44:47], v13 offset:768
    v_mfma_f32_16x16x32_bf16 v[36:39], a[224:227], v[144:147], 0
    v_mfma_f32_16x16x32_bf16 v[40:43], a[224:227], v[148:151], 0
    v_mfma_f32_16x16x32_bf16 v[36:39], a[228:231], v[152:155], v[36:39]
    v_mfma_f32_16x16x32_bf16 v[40:43], a[228:231], v[156:159], v[40:43]
    v_mfma_f32_16x16x32_bf16 v[36:39], a[232:235], v[160:163], v[36:39]
    v_mfma_f32_16x16x32_bf16 v[40:43], a[232:235], v[164:167], v[40:43]
    s_waitcnt lgkmcnt(0)
    buffer_store_dwordx4 v[44:47], v14, s[4:7], s40 offen offset:768 sc1
    v_mfma_f32_16x16x32_bf16 v[36:39], a[236:239], v[168:171], v[36:39]
    v_mfma_f32_16x16x32_bf16 v[40:43], a[236:239], v[172:175], v[40:43]
    v_cvt_pk_bf16_f32 v28, v28, v29
    v_cvt_pk_bf16_f32 v29, v30, v31
    v_mfma_f32_16x16x32_bf16 v[36:39], a[240:243], v[176:179], v[36:39]
    ds_write_b64 v12, v[28:29] offset:896
    v_cvt_pk_bf16_f32 v32, v32, v33
    v_cvt_pk_bf16_f32 v33, v34, v35
    v_mfma_f32_16x16x32_bf16 v[40:43], a[240:243], v[180:183], v[40:43]
    ds_write_b64 v12, v[32:33] offset:19584
    v_mfma_f32_16x16x32_bf16 v[36:39], a[244:247], v[184:187], v[36:39]
    v_mfma_f32_16x16x32_bf16 v[40:43], a[244:247], v[188:191], v[40:43]
    v_mfma_f32_16x16x32_bf16 v[36:39], a[248:251], v[192:195], v[36:39]
    v_mfma_f32_16x16x32_bf16 v[40:43], a[248:251], v[196:199], v[40:43]
    v_mfma_f32_16x16x32_bf16 v[36:39], a[252:255], v[200:203], v[36:39]
    v_mfma_f32_16x16x32_bf16 v[40:43], a[252:255], v[204:207], v[40:43]
    s_waitcnt lgkmcnt(0)
    s_barrier
    ds_read_b128 v[48:51], v13 offset:896
    s_nop 3
    v_cvt_pk_bf16_f32 v36, v36, v37
    v_cvt_pk_bf16_f32 v37, v38, v39
    v_cvt_pk_bf16_f32 v40, v40, v41
    v_cvt_pk_bf16_f32 v41, v42, v43
    ds_write_b64 v12, v[36:37] offset:1024
    ds_write_b64 v12, v[40:41] offset:19712
    s_waitcnt lgkmcnt(2)
    buffer_store_dwordx4 v[48:51], v14, s[4:7], s40 offen offset:896 sc1
    s_waitcnt lgkmcnt(0)
    s_barrier
    ds_read_b128 v[44:47], v13 offset:1024
    s_waitcnt lgkmcnt(0)
    buffer_store_dwordx4 v[44:47], v14, s[4:7], s40 offen offset:1024 sc1
    s_waitcnt vmcnt(0)
    s_barrier
    s_lshl_b32 s60, s36, 8
    s_add_u32 s60, s60, 81798144
    s_cmp_lg_u32 s33, 0
    s_cbranch_scc1 L_ar_87
    s_mov_b64 exec, 1
    v_mov_b32 v5, 1
    buffer_atomic_add v5, off, s[4:7], s60 sc0
    s_waitcnt vmcnt(0)
    v_cmpx_eq_u32 vcc, 15, v5
    s_cbranch_execz L_ar_87_x
    buffer_store_dword v5, off, s[4:7], s60 offset:128 sc1
L_ar_87_x:
    s_mov_b64 exec, -1
L_ar_87:
    s_add_u32 s36, s36, 4
    s_cmp_lt_u32 s36, 36
    s_cbranch_scc1 L_atop_80
    s_cmp_lt_u32 s36, 64
    s_cbranch_scc1 L_apf_79
    s_endpgm
L_roleB_76:
    v_lshlrev_b32 v17, 1, v7
    v_lshlrev_b32 v18, 1, v8
    s_mov_b32 s62, 80744960
    buffer_load_dwordx4 v[20:23], v17, s[4:7], s62 offen offset:0 sc1
    buffer_load_dwordx4 v[24:27], v17, s[4:7], s62 offen offset:1024 sc1
    buffer_load_dwordx4 v[28:31], v18, s[4:7], s62 offen offset:2048 sc1
    v_lshlrev_b32 v17, 1, v7
    v_lshlrev_b32 v18, 1, v8
    s_mov_b32 s62, 80747264
    buffer_load_dwordx4 v[32:35], v17, s[4:7], s62 offen offset:0 sc1
    buffer_load_dwordx4 v[36:39], v17, s[4:7], s62 offen offset:1024 sc1
    buffer_load_dwordx4 v[40:43], v18, s[4:7], s62 offen offset:2048 sc1
    v_lshlrev_b32 v17, 1, v7
    v_lshlrev_b32 v18, 1, v8
    s_mov_b32 s62, 80749568
    buffer_load_dwordx4 v[44:47], v17, s[4:7], s62 offen offset:0 sc1
    buffer_load_dwordx4 v[48:51], v17, s[4:7], s62 offen offset:1024 sc1
    buffer_load_dwordx4 v[52:55], v18, s[4:7], s62 offen offset:2048 sc1
    v_and_b32 v5, 1, v1
    v_lshlrev_b32 v5, 4, v5
    v_mov_b32 v56, 0x3f80
    v_lshlrev_b32 v5, v5, v56
    v_cndmask_b32 v56, 0, v5, s[80:81]
    v_cndmask_b32 v57, 0, v5, s[82:83]
    v_cndmask_b32 v58, 0, v5, s[84:85]
    v_cndmask_b32 v59, 0, v5, s[86:87]
    v_and_b32 v5, 1, v1
    v_lshlrev_b32 v5, 4, v5
    v_mov_b32 v60, 0x3f80
    v_lshlrev_b32 v5, v5, v60
    v_cndmask_b32 v60, 0, v5, s[88:89]
    v_cndmask_b32 v61, 0, v5, s[90:91]
    v_cndmask_b32 v62, 0, v5, s[92:93]
    v_cndmask_b32 v63, 0, v5, s[94:95]
    v_lshrrev_b32 v17, 3, v1
    v_and_b32 v18, 7, v1
    v_lshlrev_b32 v18, 4, v18
    v_mul_u32_u24 v15, 1152, v17
    v_add_u32 v15, v15, v18
    s_waitcnt vmcnt(0)
    v_add_f32 v44, 1.0, v44
    v_add_f32 v45, 1.0, v45
    v_add_f32 v46, 1.0, v46
    v_add_f32 v47, 1.0, v47
    v_add_f32 v48, 1.0, v48
    v_add_f32 v49, 1.0, v49
    v_add_f32 v50, 1.0, v50
    v_add_f32 v51, 1.0, v51
    v_add_f32 v52, 1.0, v52
    v_add_f32 v53, 1.0, v53
    v_add_f32 v54, 1.0, v54
    v_add_f32 v55, 1.0, v55
    v_cvt_pk_bf16_f32 v45, v44, v45
    v_lshlrev_b32 v44, 16, v45
    v_and_b32 v45, 0xffff0000, v45
    v_cvt_pk_bf16_f32 v47, v46, v47
    v_lshlrev_b32 v46, 16, v47
    v_and_b32 v47, 0xffff0000, v47
    v_cvt_pk_bf16_f32 v49, v48, v49
    v_lshlrev_b32 v48, 16, v49
    v_and_b32 v49, 0xffff0000, v49
    v_cvt_pk_bf16_f32 v51, v50, v51
    v_lshlrev_b32 v50, 16, v51
    v_and_b32 v51, 0xffff0000, v51
    v_cvt_pk_bf16_f32 v53, v52, v53
    v_lshlrev_b32 v52, 16, v53
    v_and_b32 v53, 0xffff0000, v53
    v_cvt_pk_bf16_f32 v55, v54, v55
    v_lshlrev_b32 v54, 16, v55
    v_and_b32 v55, 0xffff0000, v55
    s_sub_u32 s43, s32, 64
    s_lshl_b32 s43, s43, 1
    s_and_b32 s60, s33, 1
    s_add_u32 s43, s43, s60
    s_lshr_b32 s36, s33, 1
    v_and_b32 v6, 15, v1
    v_lshlrev_b32 v6, 2, v6
    v_mov_b32 v64, -1
    v_mov_b32 v65, -1
    v_mov_b32 v66, -1
    v_mov_b32 v67, -1
    v_mov_b32 v68, -1
    v_mov_b32 v69, -1
    s_add_u32 s60, s36, 56
    s_lshl_b32 s60, s60, 5
    s_add_u32 s60, s60, s43
    s_mul_i32 s60, s60, 1152
    s_add_u32 s60, s60, 74448896
    buffer_store_dwordx2 v[64:65], v7, s[4:7], s60 offen offset:0 sc1
    buffer_store_dwordx2 v[66:67], v7, s[4:7], s60 offen offset:512 sc1
    buffer_store_dwordx2 v[68:69], v8, s[4:7], s60 offen offset:1024 sc1
    s_add_u32 s60, s60, 3145728
    buffer_store_dwordx2 v[64:65], v7, s[4:7], s60 offen offset:0 sc1
    buffer_store_dwordx2 v[66:67], v7, s[4:7], s60 offen offset:512 sc1
    buffer_store_dwordx2 v[68:69], v8, s[4:7], s60 offen offset:1024 sc1
    s_add_u32 s60, s36, 58
    s_lshl_b32 s60, s60, 5
    s_add_u32 s60, s60, s43
    s_mul_i32 s60, s60, 1152
    s_add_u32 s60, s60, 74448896
    buffer_store_dwordx2 v[64:65], v7, s[4:7], s60 offen offset:0 sc1
    buffer_store_dwordx2 v[66:67], v7, s[4:7], s60 offen offset:512 sc1
    buffer_store_dwordx2 v[68:69], v8, s[4:7], s60 offen offset:1024 sc1
    s_add_u32 s60, s60, 3145728
    buffer_store_dwordx2 v[64:65], v7, s[4:7], s60 offen offset:0 sc1
    buffer_store_dwordx2 v[66:67], v7, s[4:7], s60 offen offset:512 sc1
    buffer_store_dwordx2 v[68:69], v8, s[4:7], s60 offen offset:1024 sc1
    s_add_u32 s60, s36, 60
    s_lshl_b32 s60, s60, 5
    s_add_u32 s60, s60, s43
    s_mul_i32 s60, s60, 1152
    s_add_u32 s60, s60, 74448896
    buffer_store_dwordx2 v[64:65], v7, s[4:7], s60 offen offset:0 sc1
    buffer_store_dwordx2 v[66:67], v7, s[4:7], s60 offen offset:512 sc1
    buffer_store_dwordx2 v[68:69], v8, s[4:7], s60 offen offset:1024 sc1
    s_add_u32 s60, s60, 3145728
    buffer_store_dwordx2 v[64:65], v7, s[4:7], s60 offen offset:0 sc1
    buffer_store_dwordx2 v[66:67], v7, s[4:7], s60 offen offset:512 sc1
    buffer_store_dwordx2 v[68:69], v8, s[4:7], s60 offen offset:1024 sc1
    s_add_u32 s60, s36, 62
    s_lshl_b32 s60, s60, 5
    s_add_u32 s60, s60, s43
    s_mul_i32 s60, s60, 1152
    s_add_u32 s60, s60, 74448896
    buffer_store_dwordx2 v[64:65], v7, s[4:7], s60 offen offset:0 sc1
    buffer_store_dwordx2 v[66:67], v7, s[4:7], s60 offen offset:512 sc1
    buffer_store_dwordx2 v[68:69], v8, s[4:7], s60 offen offset:1024 sc1
    s_add_u32 s60, s60, 3145728
    buffer_store_dwordx2 v[64:65], v7, s[4:7], s60 offen offset:0 sc1
    buffer_store_dwordx2 v[66:67], v7, s[4:7], s60 offen offset:512 sc1
    buffer_store_dwordx2 v[68:69], v8, s[4:7], s60 offen offset:1024 sc1
    v_and_b32 v6, 15, v1
    v_mul_u32_u24 v6, 1152, v6
L_btop_88:
    s_lshl_b32 s60, s36, 5
    s_add_u32 s40, s60, s43
    s_mul_i32 s41, s40, 1152
    buffer_load_dwordx2 v[216:217], v7, s[24:27], s41 offen offset:0
    buffer_load_dwordx2 v[218:219], v7, s[24:27], s41 offen offset:512
    buffer_load_dwordx2 v[220:221], v8, s[24:27], s41 offen offset:1024
    s_lshl_b32 s60, s36, 8
    s_add_u32 s60, s60, 81798144
    s_mul_i32 s38, s40, 18432
    s_add_u32 s38, s38, 83886080
    s_add_u32 s39, s38, 9216
    s_cmp_ge_u32 s36, 56
    s_cbranch_scc1 L_bcan_89
L_wf_92:
    buffer_load_dword v5, off, s[4:7], s60 offset:128 sc1
    s_waitcnt vmcnt(0)
    v_cmp_eq_u32 vcc, 0, v5
    s_cbranch_vccz L_wfok_93
    s_sleep 2
    s_sub_u32 s37, s37, 1
    s_cbranch_scc0 L_wf_92
    s_mov_b32 s37, 0
L_wfok_93:
    s_branch L_bgo_90
L_bcan_89:
L_cn_94:
    buffer_load_dword v5, v6, s[4:7], s38 offen offset:124 sc1
    s_waitcnt vmcnt(0)
    v_cmp_eq_u32 vcc, -1, v5
    s_cbranch_vccz L_cnok_95
    s_sleep 1
    s_sub_u32 s37, s37, 1
    s_cbranch_scc0 L_cn_94
    s_mov_b32 s37, 0
L_cnok_95:
L_bgo_90:
L_bre_91:
    buffer_load_dwordx4 v[64:67], v15, s[4:7], s38 offen offset:0 sc1
    buffer_load_dwordx4 v[68:71], v15, s[4:7], s39 offen offset:0 sc1
    buffer_load_dwordx4 v[72:75], v15, s[4:7], s38 offen offset:128 sc1
    buffer_load_dwordx4 v[76:79], v15, s[4:7], s39 offen offset:128 sc1
    buffer_load_dwordx4 v[80:83], v15, s[4:7], s38 offen offset:256 sc1
    buffer_load_dwordx4 v[84:87], v15, s[4:7], s39 offen offset:256 sc1
    buffer_load_dwordx4 v[88:91], v15, s[4:7], s38 offen offset:384 sc1
    buffer_load_dwordx4 v[92:95], v15, s[4:7], s39 offen offset:384 sc1
    buffer_load_dwordx4 v[96:99], v15, s[4:7], s38 offen offset:512 sc1
    buffer_load_dwordx4 v[100:103], v15, s[4:7], s39 offen offset:512 sc1
    buffer_load_dwordx4 v[104:107], v15, s[4:7], s38 offen offset:640 sc1
    buffer_load_dwordx4 v[108:111], v15, s[4:7], s39 offen offset:640 sc1
    buffer_load_dwordx4 v[112:115], v15, s[4:7], s38 offen offset:768 sc1
    buffer_load_dwordx4 v[116:119], v15, s[4:7], s39 offen offset:768 sc1
    buffer_load_dwordx4 v[120:123], v15, s[4:7], s38 offen offset:896 sc1
    buffer_load_dwordx4 v[124:127], v15, s[4:7], s39 offen offset:896 sc1
    buffer_load_dwordx4 v[128:131], v15, s[4:7], s38 offen offset:1024 sc1
    buffer_load_dwordx4 v[132:135], v15, s[4:7], s39 offen offset:1024 sc1
    v_and_b32 v225, 0xffff0000, v216
    v_lshlrev_b32 v224, 16, v216
    v_and_b32 v227, 0xffff0000, v217
    v_lshlrev_b32 v226, 16, v217
    v_and_b32 v229, 0xffff0000, v218
    v_lshlrev_b32 v228, 16, v218
    v_and_b32 v231, 0xffff0000, v219
    v_lshlrev_b32 v230, 16, v219
    v_and_b32 v233, 0xffff0000, v220
    v_lshlrev_b32 v232, 16, v220
    v_and_b32 v235, 0xffff0000, v221
    v_lshlrev_b32 v234, 16, v221
    s_waitcnt vmcnt(16)
    v_mfma_f32_16x16x32_bf16 v[176:179], v[56:59], v[64:67], 0
    v_max_u32 v5, v64, v65
    v_max3_u32 v5, v5, v66, v67
    v_mfma_f32_16x16x32_bf16 v[176:179], v[56:59], v[68:71], v[176:179]
    v_max3_u32 v5, v5, v68, v69
    v_max3_u32 v5, v5, v70, v71
    s_waitcnt vmcnt(14)
    v_mfma_f32_16x16x32_bf16 v[176:179], v[60:63], v[72:75], v[176:179]
    v_max3_u32 v5, v5, v72, v73
    v_max3_u32 v5, v5, v74, v75
    v_mfma_f32_16x16x32_bf16 v[176:179], v[60:63], v[76:79], v[176:179]
    v_max3_u32 v5, v5, v76, v77
    v_max3_u32 v5, v5, v78, v79
    s_waitcnt vmcnt(12)
    v_mfma_f32_16x16x32_bf16 v[180:183], v[56:59], v[80:83], 0
    v_max3_u32 v5, v5, v80, v81
    v_max3_u32 v5, v5, v82, v83
    v_mfma_f32_16x16x32_bf16 v[180:183], v[56:59], v[84:87], v[180:183]
    v_max3_u32 v5, v5, v84, v85
    v_max3_u32 v5, v5, v86, v87
    s_waitcnt vmcnt(10)
    v_mfma_f32_16x16x32_bf16 v[180:183], v[60:63], v[88:91], v[180:183]
    v_max3_u32 v5, v5, v88, v89
    v_max3_u32 v5, v5, v90, v91
    v_mfma_f32_16x16x32_bf16 v[180:183], v[60:63], v[92:95], v[180:183]
    v_max3_u32 v5, v5, v92, v93
    v_max3_u32 v5, v5, v94, v95
    s_waitcnt vmcnt(8)
    v_mfma_f32_16x16x32_bf16 v[184:187], v[56:59], v[96:99], 0
    v_max3_u32 v5, v5, v96, v97
    v_max3_u32 v5, v5, v98, v99
    v_mfma_f32_16x16x32_bf16 v[184:187], v[56:59], v[100:103], v[184:187]
    v_max3_u32 v5, v5, v100, v101
    v_max3_u32 v5, v5, v102, v103
    s_waitcnt vmcnt(6)
    v_mfma_f32_16x16x32_bf16 v[184:187], v[60:63], v[104:107], v[184:187]
    v_max3_u32 v5, v5, v104, v105
    v_max3_u32 v5, v5, v106, v107
    v_mfma_f32_16x16x32_bf16 v[184:187], v[60:63], v[108:111], v[184:187]
    v_max3_u32 v5, v5, v108, v109
    v_max3_u32 v5, v5, v110, v111
    s_waitcnt vmcnt(4)
    v_mfma_f32_16x16x32_bf16 v[188:191], v[56:59], v[112:115], 0
    v_max3_u32 v5, v5, v112, v113
    v_max3_u32 v5, v5, v114, v115
    v_mfma_f32_16x16x32_bf16 v[188:191], v[56:59], v[116:119], v[188:191]
    v_max3_u32 v5, v5, v116, v117
    v_max3_u32 v5, v5, v118, v119
    s_waitcnt vmcnt(2)
    v_mfma_f32_16x16x32_bf16 v[188:191], v[60:63], v[120:123], v[188:191]
    v_max3_u32 v5, v5, v120, v121
    v_max3_u32 v5, v5, v122, v123
    v_mfma_f32_16x16x32_bf16 v[188:191], v[60:63], v[124:127], v[188:191]
    v_max3_u32 v5, v5, v124, v125
    v_max3_u32 v5, v5, v126, v127
    s_waitcnt vmcnt(0)
    v_mfma_f32_16x16x32_bf16 v[192:195], v[56:59], v[128:131], 0
    v_max3_u32 v5, v5, v128, v129
    v_max3_u32 v5, v5, v130, v131
    v_mfma_f32_16x16x32_bf16 v[192:195], v[56:59], v[132:135], v[192:195]
    v_max3_u32 v5, v5, v132, v133
    v_max3_u32 v5, v5, v134, v135
    v_cmp_eq_u32 vcc, -1, v5
    s_cbranch_vccz L_sok_96
    s_sub_u32 s37, s37, 1
    s_cbranch_scc0 L_bre_91
    s_mov_b32 s37, 0
L_sok_96:
    v_mov_b32 v204, 0
    v_mov_b32 v205, 0
    v_mov_b32 v206, 0
    v_mov_b32 v207, 0
    s_nop 3
    v_add_f32_dpp v196, v176, v176 row_ror:8 row_mask:0xf bank_mask:0x3
    v_add_f32_dpp v197, v177, v177 row_ror:8 row_mask:0xf bank_mask:0x3
    v_add_f32_dpp v198, v178, v178 row_ror:8 row_mask:0xf bank_mask:0x3
    v_add_f32_dpp v199, v179, v179 row_ror:8 row_mask:0xf bank_mask:0x3
    v_add_f32_dpp v196, v180, v180 row_ror:8 row_mask:0xf bank_mask:0xc
    v_add_f32_dpp v197, v181, v181 row_ror:8 row_mask:0xf bank_mask:0xc
    v_add_f32_dpp v198, v182, v182 row_ror:8 row_mask:0xf bank_mask:0xc
    v_add_f32_dpp v199, v183, v183 row_ror:8 row_mask:0xf bank_mask:0xc
    v_add_f32_dpp v200, v184, v184 row_ror:8 row_mask:0xf bank_mask:0x3
    v_add_f32_dpp v201, v185, v185 row_ror:8 row_mask:0xf bank_mask:0x3
    v_add_f32_dpp v202, v186, v186 row_ror:8 row_mask:0xf bank_mask:0x3
    v_add_f32_dpp v203, v187, v187 row_ror:8 row_mask:0xf bank_mask:0x3
    v_add_f32_dpp v200, v188, v188 row_ror:8 row_mask:0xf bank_mask:0xc
    v_add_f32_dpp v201, v189, v189 row_ror:8 row_mask:0xf bank_mask:0xc
    v_add_f32_dpp v202, v190, v190 row_ror:8 row_mask:0xf bank_mask:0xc
    v_add_f32_dpp v203, v191, v191 row_ror:8 row_mask:0xf bank_mask:0xc
    v_add_f32_dpp v204, v192, v192 row_ror:8 row_mask:0xf bank_mask:0x3
    v_add_f32_dpp v205, v193, v193 row_ror:8 row_mask:0xf bank_mask:0x3
    v_add_f32_dpp v206, v194, v194 row_ror:8 row_mask:0xf bank_mask:0x3
    v_add_f32_dpp v207, v195, v195 row_ror:8 row_mask:0xf bank_mask:0x3
    v_fmac_f32 v224, v196, v20
    v_fmac_f32 v225, v197, v21
    v_cvt_pk_bf16_f32 v216, v224, v225
    v_and_b32 v197, 0xffff0000, v216
    v_lshlrev_b32 v196, 16, v216
    v_fmac_f32 v226, v198, v22
    v_fmac_f32 v227, v199, v23
    v_cvt_pk_bf16_f32 v217, v226, v227
    v_and_b32 v199, 0xffff0000, v217
    v_lshlrev_b32 v198, 16, v217
    v_fmac_f32 v228, v200, v24
    v_fmac_f32 v229, v201, v25
    v_cvt_pk_bf16_f32 v218, v228, v229
    v_and_b32 v201, 0xffff0000, v218
    v_lshlrev_b32 v200, 16, v218
    v_fmac_f32 v230, v202, v26
    v_fmac_f32 v231, v203, v27
    v_cvt_pk_bf16_f32 v219, v230, v231
    v_and_b32 v203, 0xffff0000, v219
    v_lshlrev_b32 v202, 16, v219
    v_fmac_f32 v232, v204, v28
    v_fmac_f32 v233, v205, v29
    v_cvt_pk_bf16_f32 v220, v232, v233
    v_and_b32 v205, 0xffff0000, v220
    v_lshlrev_b32 v204, 16, v220
    v_fmac_f32 v234, v206, v30
    v_fmac_f32 v235, v207, v31
    v_cvt_pk_bf16_f32 v221, v234, v235
    v_and_b32 v207, 0xffff0000, v221
    v_lshlrev_b32 v206, 16, v221
    s_add_u32 s60, s41, 77594624
    buffer_store_dwordx2 v[216:217], v7, s[4:7], s60 offen offset:0 sc1
    buffer_store_dwordx2 v[218:219], v7, s[4:7], s60 offen offset:512 sc1
    buffer_store_dwordx2 v[220:221], v8, s[4:7], s60 offen offset:1024 sc1
    v_add_f32 v160, v196, v197
    v_add_f32 v160, v160, v198
    v_add_f32 v160, v160, v199
    v_add_f32 v160, v160, v200
    v_add_f32 v160, v160, v201
    v_add_f32 v160, v160, v202
    v_add_f32 v160, v160, v203
    v_add_f32 v160, v160, v204
    v_add_f32 v160, v160, v205
    v_add_f32 v160, v160, v206
    v_add_f32 v160, v160, v207
    s_nop 1
    v_add_f32_dpp v160, v160, v160 row_ror:8 row_mask:0xf bank_mask:0xf
    s_nop 1
    v_add_f32_dpp v160, v160, v160 row_ror:4 row_mask:0xf bank_mask:0xf
    s_nop 1
    v_add_f32_dpp v160, v160, v160 row_ror:2 row_mask:0xf bank_mask:0xf
    s_nop 1
    v_add_f32_dpp v160, v160, v160 row_ror:1 row_mask:0xf bank_mask:0xf
    v_mov_b32 v162, v160
    s_nop 1
    v_permlane16_swap_b32 v160, v162
    v_add_f32 v160, v160, v162
    v_mov_b32 v162, v160
    s_nop 1
    v_permlane32_swap_b32 v160, v162
    v_add_f32 v160, v160, v162
    v_mul_f32 v160, 0x3ae38e39, v160
    v_sub_f32 v144, v196, v160
    v_sub_f32 v145, v197, v160
    v_sub_f32 v146, v198, v160
    v_sub_f32 v147, v199, v160
    v_sub_f32 v148, v200, v160
    v_sub_f32 v149, v201, v160
    v_sub_f32 v150, v202, v160
    v_sub_f32 v151, v203, v160
    v_sub_f32 v152, v204, v160
    v_sub_f32 v153, v205, v160
    v_sub_f32 v154, v206, v160
    v_sub_f32 v155, v207, v160
    v_mul_f32 v161, v152, v152
    v_fmac_f32 v161, v153, v153
    v_fmac_f32 v161, v154, v154
    v_fmac_f32 v161, v155, v155
    v_cndmask_b32 v161, 0, v161, s[64:65]
    v_fmac_f32 v161, v144, v144
    v_fmac_f32 v161, v145, v145
    v_fmac_f32 v161, v146, v146
    v_fmac_f32 v161, v147, v147
    v_fmac_f32 v161, v148, v148
    v_fmac_f32 v161, v149, v149
    v_fmac_f32 v161, v150, v150
    v_fmac_f32 v161, v151, v151
    s_nop 1
    v_add_f32_dpp v161, v161, v161 row_ror:8 row_mask:0xf bank_mask:0xf
    s_nop 1
    v_add_f32_dpp v161, v161, v161 row_ror:4 row_mask:0xf bank_mask:0xf
    s_nop 1
    v_add_f32_dpp v161, v161, v161 row_ror:2 row_mask:0xf bank_mask:0xf
    s_nop 1
    v_add_f32_dpp v161, v161, v161 row_ror:1 row_mask:0xf bank_mask:0xf
    v_mov_b32 v162, v161
    s_nop 1
    v_permlane16_swap_b32 v161, v162
    v_add_f32 v161, v161, v162
    v_mov_b32 v162, v161
    s_nop 1
    v_permlane32_swap_b32 v161, v162
    v_add_f32 v161, v161, v162
    v_mul_f32 v161, 0x3ae38e39, v161
    v_cvt_pk_bf16_f32 v161, v160, v161
    v_lshlrev_b32 v160, 16, v161
    v_and_b32 v161, 0xffff0000, v161
    v_add_f32 v161, 0x3727c5ac, v161
    v_cvt_pk_bf16_f32 v161, v161, v161
    v_and_b32 v161, 0xffff0000, v161
    v_sqrt_f32 v161, v161
    s_nop 0
    v_cvt_pk_bf16_f32 v161, v161, v161
    v_and_b32 v161, 0xffff0000, v161
    v_rcp_f32 v161, v161
    s_nop 0
    v_sub_f32 v196, v196, v160
    v_mul_f32 v196, v196, v161
    v_fma_f32 v196, v196, v44, v32
    v_sub_f32 v197, v197, v160
    v_mul_f32 v197, v197, v161
    v_fma_f32 v197, v197, v45, v33
    v_sub_f32 v198, v198, v160
    v_mul_f32 v198, v198, v161
    v_fma_f32 v198, v198, v46, v34
    v_sub_f32 v199, v199, v160
    v_mul_f32 v199, v199, v161
    v_fma_f32 v199, v199, v47, v35
    v_sub_f32 v200, v200, v160
    v_mul_f32 v200, v200, v161
    v_fma_f32 v200, v200, v48, v36
    v_sub_f32 v201, v201, v160
    v_mul_f32 v201, v201, v161
    v_fma_f32 v201, v201, v49, v37
    v_sub_f32 v202, v202, v160
    v_mul_f32 v202, v202, v161
    v_fma_f32 v202, v202, v50, v38
    v_sub_f32 v203, v203, v160
    v_mul_f32 v203, v203, v161
    v_fma_f32 v203, v203, v51, v39
    v_sub_f32 v204, v204, v160
    v_mul_f32 v204, v204, v161
    v_fma_f32 v204, v204, v52, v40
    v_sub_f32 v205, v205, v160
    v_mul_f32 v205, v205, v161
    v_fma_f32 v205, v205, v53, v41
    v_sub_f32 v206, v206, v160
    v_mul_f32 v206, v206, v161
    v_fma_f32 v206, v206, v54, v42
    v_sub_f32 v207, v207, v160
    v_mul_f32 v207, v207, v161
    v_fma_f32 v207, v207, v55, v43
    v_cvt_pk_bf16_f32 v164, v196, v197
    v_cvt_pk_bf16_f32 v165, v198, v199
    v_cvt_pk_bf16_f32 v166, v200, v201
    v_cvt_pk_bf16_f32 v167, v202, v203
    v_cvt_pk_bf16_f32 v168, v204, v205
    v_cvt_pk_bf16_f32 v169, v206, v207
    s_add_u32 s60, s41, 74448896
    buffer_store_dwordx2 v[164:165], v7, s[4:7], s60 offen offset:0 sc1
    buffer_store_dwordx2 v[166:167], v7, s[4:7], s60 offen offset:512 sc1
    buffer_store_dwordx2 v[168:169], v8, s[4:7], s60 offen offset:1024 sc1
    s_waitcnt vmcnt(0)
    s_lshl_b32 s60, s36, 8
    s_add_u32 s60, s60, 81814528
    s_mov_b64 exec, 1
    v_mov_b32 v5, 1
    buffer_atomic_add v5, off, s[4:7], s60 sc0
    s_waitcnt vmcnt(0)
    v_cmpx_eq_u32 vcc, 31, v5
    s_cbranch_execz L_ar_97_x
    buffer_store_dword v5, off, s[4:7], s60 offset:128 sc1
L_ar_97_x:
    s_mov_b64 exec, -1
L_ar_97:
    s_add_u32 s36, s36, 2
    s_cmp_lt_u32 s36, 64
    s_cbranch_scc1 L_btop_88
    s_endpgm
L_roleC_75:
    s_sub_u32 s60, s32, 80
    s_lshr_b32 s34, s60, 2
    s_and_b32 s35, s60, 3
    s_load_dwordx2 s[8:9], s[0:1], 64
    s_waitcnt lgkmcnt(0)
    s_and_b32 s9, s9, 0xffff
    s_mov_b32 s10, 5308416
    s_mov_b32 s11, 0x20000
    s_load_dwordx2 s[12:13], s[0:1], 72
    s_waitcnt lgkmcnt(0)
    s_and_b32 s13, s13, 0xffff
    s_mov_b32 s14, 5308416
    s_mov_b32 s15, 0x20000
    s_load_dwordx2 s[16:17], s[0:1], 80
    s_waitcnt lgkmcnt(0)
    s_and_b32 s17, s17, 0xffff
    s_mov_b32 s18, 5308416
    s_mov_b32 s19, 0x20000
    s_load_dwordx2 s[20:21], s[0:1], 104
    s_waitcnt lgkmcnt(0)
    s_and_b32 s21, s21, 0xffff
    s_mov_b32 s22, 2359296
    s_mov_b32 s23, 0x20000
    s_lshl_b32 s61, s34, 8
    v_lshlrev_b32 v5, 2, v2
    v_sub_u32 v5, v1, v5
    v_and_b32 v5, 15, v5
    v_lshlrev_b32 v5, 4, v5
    v_mul_u32_u24 v9, 9216, v2
    v_add_u32 v9, v9, v5
    s_mul_i32 s63, s33, 147456
    s_add_u32 s63, s63, s61
    v_add_u32 v9, s63, v9
    s_lshl_b32 s61, s33, 2
    v_mul_u32_u24 v5, 1, v4
    v_lshl_add_u32 v5, v3, 2, v5
    v_add_u32 v5, s61, v5
    v_and_b32 v5, 15, v5
    v_lshlrev_b32 v5, 4, v5
    v_lshl_add_u32 v10, v2, 3, v3
    v_lshl_add_u32 v10, v10, 8, v5
    s_mul_i32 s61, s34, 147456
    v_lshrrev_b32 v5, 3, v1
    v_mul_u32_u24 v12, 1152, v5
    v_and_b32 v5, 7, v1
    v_lshl_add_u32 v12, v5, 4, v12
    s_mul_i32 s63, s33, 36864
    s_add_u32 s63, s63, s61
    v_add_u32 v12, s63, v12
    v_lshl_add_u32 v13, v2, 3, v3
    v_lshlrev_b32 v13, 7, v13
    v_lshl_add_u32 v13, v4, 3, v13
    s_lshl_b32 s63, s33, 5
    v_add_u32 v13, s63, v13
    s_lshl_b32 s99, s33, 12
    s_add_u32 m0, s99, 0
    s_mov_b32 s62, 0
    buffer_load_dwordx4 v9, s[8:11], s62 offen lds
    s_add_u32 m0, s99, 1024
    s_mov_b32 s62, 36864
    buffer_load_dwordx4 v9, s[8:11], s62 offen lds
    s_add_u32 m0, s99, 2048
    s_mov_b32 s62, 73728
    buffer_load_dwordx4 v9, s[8:11], s62 offen lds
    s_add_u32 m0, s99, 3072
    s_mov_b32 s62, 110592
    buffer_load_dwordx4 v9, s[8:11], s62 offen lds
    s_add_u32 m0, s99, 16384
    s_mov_b32 s62, 0
    buffer_load_dwordx4 v9, s[12:15], s62 offen lds
    s_add_u32 m0, s99, 17408
    s_mov_b32 s62, 36864
    buffer_load_dwordx4 v9, s[12:15], s62 offen lds
    s_add_u32 m0, s99, 18432
    s_mov_b32 s62, 73728
    buffer_load_dwordx4 v9, s[12:15], s62 offen lds
    s_add_u32 m0, s99, 19456
    s_mov_b32 s62, 110592
    buffer_load_dwordx4 v9, s[12:15], s62 offen lds
    s_waitcnt vmcnt(4)
    s_barrier
    s_add_u32 m0, s99, 32768
    s_mov_b32 s62, 589824
    buffer_load_dwordx4 v9, s[8:11], s62 offen lds
    s_add_u32 m0, s99, 33792
    s_mov_b32 s62, 626688
    buffer_load_dwordx4 v9, s[8:11], s62 offen lds
    s_add_u32 m0, s99, 34816
    s_mov_b32 s62, 663552
    buffer_load_dwordx4 v9, s[8:11], s62 offen lds
    s_add_u32 m0, s99, 35840
    s_mov_b32 s62, 700416
    buffer_load_dwordx4 v9, s[8:11], s62 offen lds
    v_add_u32 v11, 0, v10
    ds_read_b64_tr_b16 v[80:81], v11 offset:0
    ds_read_b64_tr_b16 v[82:83], v11 offset:1024
    ds_read_b64_tr_b16 v[84:85], v11 offset:8
    ds_read_b64_tr_b16 v[86:87], v11 offset:1032
    ds_read_b64_tr_b16 v[96:97], v11 offset:8192
    ds_read_b64_tr_b16 v[98:99], v11 offset:9216
    ds_read_b64_tr_b16 v[100:101], v11 offset:8200
    ds_read_b64_tr_b16 v[102:103], v11 offset:9224
    s_waitcnt lgkmcnt(0)
    s_waitcnt vmcnt(4)
    s_barrier
    s_add_u32 m0, s99, 49152
    s_mov_b32 s62, 589824
    buffer_load_dwordx4 v9, s[12:15], s62 offen lds
    s_add_u32 m0, s99, 50176
    s_mov_b32 s62, 626688
    buffer_load_dwordx4 v9, s[12:15], s62 offen lds
    s_add_u32 m0, s99, 51200
    s_mov_b32 s62, 663552
    buffer_load_dwordx4 v9, s[12:15], s62 offen lds
    s_add_u32 m0, s99, 52224
    s_mov_b32 s62, 700416
    buffer_load_dwordx4 v9, s[12:15], s62 offen lds
    v_add_u32 v11, 16384, v10
    ds_read_b64_tr_b16 v[88:89], v11 offset:0
    ds_read_b64_tr_b16 v[90:91], v11 offset:1024
    ds_read_b64_tr_b16 v[92:93], v11 offset:8
    ds_read_b64_tr_b16 v[94:95], v11 offset:1032
    ds_read_b64_tr_b16 v[104:105], v11 offset:8192
    ds_read_b64_tr_b16 v[106:107], v11 offset:9216
    ds_read_b64_tr_b16 v[108:109], v11 offset:8200
    ds_read_b64_tr_b16 v[110:111], v11 offset:9224
    s_waitcnt lgkmcnt(0)
    s_waitcnt vmcnt(4)
    s_barrier
    s_add_u32 m0, s99, 65536
    s_mov_b32 s62, 1179648
    buffer_load_dwordx4 v9, s[8:11], s62 offen lds
    s_add_u32 m0, s99, 66560
    s_mov_b32 s62, 1216512
    buffer_load_dwordx4 v9, s[8:11], s62 offen lds
    s_add_u32 m0, s99, 67584
    s_mov_b32 s62, 1253376
    buffer_load_dwordx4 v9, s[8:11], s62 offen lds
    s_add_u32 m0, s99, 68608
    s_mov_b32 s62, 1290240
    buffer_load_dwordx4 v9, s[8:11], s62 offen lds
    v_add_u32 v11, 32768, v10
    ds_read_b64_tr_b16 v[112:113], v11 offset:0
    ds_read_b64_tr_b16 v[114:115], v11 offset:1024
    ds_read_b64_tr_b16 v[116:117], v11 offset:8
    ds_read_b64_tr_b16 v[118:119], v11 offset:1032
    ds_read_b64_tr_b16 v[128:129], v11 offset:8192
    ds_read_b64_tr_b16 v[130:131], v11 offset:9216
    ds_read_b64_tr_b16 v[132:133], v11 offset:8200
    ds_read_b64_tr_b16 v[134:135], v11 offset:9224
    s_waitcnt lgkmcnt(0)
    s_waitcnt vmcnt(4)
    s_barrier
    s_add_u32 m0, s99, 81920
    s_mov_b32 s62, 1179648
    buffer_load_dwordx4 v9, s[12:15], s62 offen lds
    s_add_u32 m0, s99, 82944
    s_mov_b32 s62, 1216512
    buffer_load_dwordx4 v9, s[12:15], s62 offen lds
    s_add_u32 m0, s99, 83968
    s_mov_b32 s62, 1253376
    buffer_load_dwordx4 v9, s[12:15], s62 offen lds
    s_add_u32 m0, s99, 84992
    s_mov_b32 s62, 1290240
    buffer_load_dwordx4 v9, s[12:15], s62 offen lds
    v_add_u32 v11, 49152, v10
    ds_read_b64_tr_b16 v[120:121], v11 offset:0
    ds_read_b64_tr_b16 v[122:123], v11 offset:1024
    ds_read_b64_tr_b16 v[124:125], v11 offset:8
    ds_read_b64_tr_b16 v[126:127], v11 offset:1032
    ds_read_b64_tr_b16 v[136:137], v11 offset:8192
    ds_read_b64_tr_b16 v[138:139], v11 offset:9216
    ds_read_b64_tr_b16 v[140:141], v11 offset:8200
    ds_read_b64_tr_b16 v[142:143], v11 offset:9224
    s_waitcnt lgkmcnt(0)
    s_waitcnt vmcnt(4)
    s_barrier
    s_add_u32 m0, s99, 98304
    s_mov_b32 s62, 1769472
    buffer_load_dwordx4 v9, s[8:11], s62 offen lds
    s_add_u32 m0, s99, 99328
    s_mov_b32 s62, 1806336
    buffer_load_dwordx4 v9, s[8:11], s62 offen lds
    s_add_u32 m0, s99, 100352
    s_mov_b32 s62, 1843200
    buffer_load_dwordx4 v9, s[8:11], s62 offen lds
    s_add_u32 m0, s99, 101376
    s_mov_b32 s62, 1880064
    buffer_load_dwordx4 v9, s[8:11], s62 offen lds
    v_add_u32 v11, 65536, v10
    ds_read_b64_tr_b16 v[144:145], v11 offset:0
    ds_read_b64_tr_b16 v[146:147], v11 offset:1024
    ds_read_b64_tr_b16 v[148:149], v11 offset:8
    ds_read_b64_tr_b16 v[150:151], v11 offset:1032
    ds_read_b64_tr_b16 v[160:161], v11 offset:8192
    ds_read_b64_tr_b16 v[162:163], v11 offset:9216
    ds_read_b64_tr_b16 v[164:165], v11 offset:8200
    ds_read_b64_tr_b16 v[166:167], v11 offset:9224
    s_waitcnt lgkmcnt(0)
    s_waitcnt vmcnt(4)
    s_barrier
    s_add_u32 m0, s99, 114688
    s_mov_b32 s62, 1769472
    buffer_load_dwordx4 v9, s[12:15], s62 offen lds
    s_add_u32 m0, s99, 115712
    s_mov_b32 s62, 1806336
    buffer_load_dwordx4 v9, s[12:15], s62 offen lds
    s_add_u32 m0, s99, 116736
    s_mov_b32 s62, 1843200
    buffer_load_dwordx4 v9, s[12:15], s62 offen lds
    s_add_u32 m0, s99, 117760
    s_mov_b32 s62, 1880064
    buffer_load_dwordx4 v9, s[12:15], s62 offen lds
    v_add_u32 v11, 81920, v10
    ds_read_b64_tr_b16 v[152:153], v11 offset:0
    ds_read_b64_tr_b16 v[154:155], v11 offset:1024
    ds_read_b64_tr_b16 v[156:157], v11 offset:8
    ds_read_b64_tr_b16 v[158:159], v11 offset:1032
    ds_read_b64_tr_b16 v[168:169], v11 offset:8192
    ds_read_b64_tr_b16 v[170:171], v11 offset:9216
    ds_read_b64_tr_b16 v[172:173], v11 offset:8200
    ds_read_b64_tr_b16 v[174:175], v11 offset:9224
    s_waitcnt lgkmcnt(0)
    s_waitcnt vmcnt(4)
    s_barrier
    s_add_u32 m0, s99, 131072
    s_mov_b32 s62, 2359296
    buffer_load_dwordx4 v9, s[8:11], s62 offen lds
    s_add_u32 m0, s99, 132096
    s_mov_b32 s62, 2396160
    buffer_load_dwordx4 v9, s[8:11], s62 offen lds
    s_add_u32 m0, s99, 133120
    s_mov_b32 s62, 2433024
    buffer_load_dwordx4 v9, s[8:11], s62 offen lds
    s_add_u32 m0, s99, 134144
    s_mov_b32 s62, 2469888
    buffer_load_dwordx4 v9, s[8:11], s62 offen lds
    v_add_u32 v11, 98304, v10
    ds_read_b64_tr_b16 v[176:177], v11 offset:0
    ds_read_b64_tr_b16 v[178:179], v11 offset:1024
    ds_read_b64_tr_b16 v[180:181], v11 offset:8
    ds_read_b64_tr_b16 v[182:183], v11 offset:1032
    ds_read_b64_tr_b16 v[192:193], v11 offset:8192
    ds_read_b64_tr_b16 v[194:195], v11 offset:9216
    ds_read_b64_tr_b16 v[196:197], v11 offset:8200
    ds_read_b64_tr_b16 v[198:199], v11 offset:9224
    s_waitcnt lgkmcnt(0)
    s_waitcnt vmcnt(4)
    s_barrier
    s_add_u32 m0, s99, 0
    s_mov_b32 s62, 2359296
    buffer_load_dwordx4 v9, s[12:15], s62 offen lds
    s_add_u32 m0, s99, 1024
    s_mov_b32 s62, 2396160
    buffer_load_dwordx4 v9, s[12:15], s62 offen lds
    s_add_u32 m0, s99, 2048
    s_mov_b32 s62, 2433024
    buffer_load_dwordx4 v9, s[12:15], s62 offen lds
    s_add_u32 m0, s99, 3072
    s_mov_b32 s62, 2469888
    buffer_load_dwordx4 v9, s[12:15], s62 offen lds
    v_add_u32 v11, 114688, v10
    ds_read_b64_tr_b16 v[184:185], v11 offset:0
    ds_read_b64_tr_b16 v[186:187], v11 offset:1024
    ds_read_b64_tr_b16 v[188:189], v11 offset:8
    ds_read_b64_tr_b16 v[190:191], v11 offset:1032
    ds_read_b64_tr_b16 v[200:201], v11 offset:8192
    ds_read_b64_tr_b16 v[202:203], v11 offset:9216
    ds_read_b64_tr_b16 v[204:205], v11 offset:8200
    ds_read_b64_tr_b16 v[206:207], v11 offset:9224
    s_waitcnt lgkmcnt(0)
    s_waitcnt vmcnt(4)
    s_barrier
    s_add_u32 m0, s99, 16384
    s_mov_b32 s62, 2949120
    buffer_load_dwordx4 v9, s[8:11], s62 offen lds
    s_add_u32 m0, s99, 17408
    s_mov_b32 s62, 2985984
    buffer_load_dwordx4 v9, s[8:11], s62 offen lds
    s_add_u32 m0, s99, 18432
    s_mov_b32 s62, 3022848
    buffer_load_dwordx4 v9, s[8:11], s62 offen lds
    s_add_u32 m0, s99, 19456
    s_mov_b32 s62, 3059712
    buffer_load_dwordx4 v9, s[8:11], s62 offen lds
    v_add_u32 v11, 131072, v10
    ds_read_b64_tr_b16 v[208:209], v11 offset:0
    ds_read_b64_tr_b16 v[210:211], v11 offset:1024
    ds_read_b64_tr_b16 v[212:213], v11 offset:8
    ds_read_b64_tr_b16 v[214:215], v11 offset:1032
    ds_read_b64_tr_b16 v[224:225], v11 offset:8192
    ds_read_b64_tr_b16 v[226:227], v11 offset:9216
    ds_read_b64_tr_b16 v[228:229], v11 offset:8200
    ds_read_b64_tr_b16 v[230:231], v11 offset:9224
    s_waitcnt lgkmcnt(0)
    s_waitcnt vmcnt(4)
    s_barrier
    s_add_u32 m0, s99, 32768
    s_mov_b32 s62, 2949120
    buffer_load_dwordx4 v9, s[12:15], s62 offen lds
    s_add_u32 m0, s99, 33792
    s_mov_b32 s62, 2985984
    buffer_load_dwordx4 v9, s[12:15], s62 offen lds
    s_add_u32 m0, s99, 34816
    s_mov_b32 s62, 3022848
    buffer_load_dwordx4 v9, s[12:15], s62 offen lds
    s_add_u32 m0, s99, 35840
    s_mov_b32 s62, 3059712
    buffer_load_dwordx4 v9, s[12:15], s62 offen lds
    v_add_u32 v11, 0, v10
    ds_read_b64_tr_b16 v[216:217], v11 offset:0
    ds_read_b64_tr_b16 v[218:219], v11 offset:1024
    ds_read_b64_tr_b16 v[220:221], v11 offset:8
    ds_read_b64_tr_b16 v[222:223], v11 offset:1032
    ds_read_b64_tr_b16 v[232:233], v11 offset:8192
    ds_read_b64_tr_b16 v[234:235], v11 offset:9216
    ds_read_b64_tr_b16 v[236:237], v11 offset:8200
    ds_read_b64_tr_b16 v[238:239], v11 offset:9224
    s_waitcnt lgkmcnt(0)
    s_waitcnt vmcnt(4)
    s_barrier
    s_add_u32 m0, s99, 49152
    s_mov_b32 s62, 3538944
    buffer_load_dwordx4 v9, s[8:11], s62 offen lds
    s_add_u32 m0, s99, 50176
    s_mov_b32 s62, 3575808
    buffer_load_dwordx4 v9, s[8:11], s62 offen lds
    s_add_u32 m0, s99, 51200
    s_mov_b32 s62, 3612672
    buffer_load_dwordx4 v9, s[8:11], s62 offen lds
    s_add_u32 m0, s99, 52224
    s_mov_b32 s62, 3649536
    buffer_load_dwordx4 v9, s[8:11], s62 offen lds
    v_add_u32 v11, 16384, v10
    ds_read_b64_tr_b16 v[240:241], v11 offset:0
    ds_read_b64_tr_b16 v[242:243], v11 offset:1024
    ds_read_b64_tr_b16 v[244:245], v11 offset:8
    ds_read_b64_tr_b16 v[246:247], v11 offset:1032
    ds_read_b64_tr_b16 a[0:1], v11 offset:8192
    ds_read_b64_tr_b16 a[2:3], v11 offset:9216
    ds_read_b64_tr_b16 a[4:5], v11 offset:8200
    ds_read_b64_tr_b16 a[6:7], v11 offset:9224
    s_waitcnt lgkmcnt(0)
    s_waitcnt vmcnt(4)
    s_barrier
    s_add_u32 m0, s99, 65536
    s_mov_b32 s62, 3538944
    buffer_load_dwordx4 v9, s[12:15], s62 offen lds
    s_add_u32 m0, s99, 66560
    s_mov_b32 s62, 3575808
    buffer_load_dwordx4 v9, s[12:15], s62 offen lds
    s_add_u32 m0, s99, 67584
    s_mov_b32 s62, 3612672
    buffer_load_dwordx4 v9, s[12:15], s62 offen lds
    s_add_u32 m0, s99, 68608
    s_mov_b32 s62, 3649536
    buffer_load_dwordx4 v9, s[12:15], s62 offen lds
    v_add_u32 v11, 32768, v10
    ds_read_b64_tr_b16 v[248:249], v11 offset:0
    ds_read_b64_tr_b16 v[250:251], v11 offset:1024
    ds_read_b64_tr_b16 v[252:253], v11 offset:8
    ds_read_b64_tr_b16 v[254:255], v11 offset:1032
    ds_read_b64_tr_b16 a[8:9], v11 offset:8192
    ds_read_b64_tr_b16 a[10:11], v11 offset:9216
    ds_read_b64_tr_b16 a[12:13], v11 offset:8200
    ds_read_b64_tr_b16 a[14:15], v11 offset:9224
    s_waitcnt lgkmcnt(0)
    s_waitcnt vmcnt(4)
    s_barrier
    s_add_u32 m0, s99, 81920
    s_mov_b32 s62, 4128768
    buffer_load_dwordx4 v9, s[8:11], s62 offen lds
    s_add_u32 m0, s99, 82944
    s_mov_b32 s62, 4165632
    buffer_load_dwordx4 v9, s[8:11], s62 offen lds
    s_add_u32 m0, s99, 83968
    s_mov_b32 s62, 4202496
    buffer_load_dwordx4 v9, s[8:11], s62 offen lds
    s_add_u32 m0, s99, 84992
    s_mov_b32 s62, 4239360
    buffer_load_dwordx4 v9, s[8:11], s62 offen lds
    v_add_u32 v11, 49152, v10
    ds_read_b64_tr_b16 a[16:17], v11 offset:0
    ds_read_b64_tr_b16 a[18:19], v11 offset:1024
    ds_read_b64_tr_b16 a[20:21], v11 offset:8
    ds_read_b64_tr_b16 a[22:23], v11 offset:1032
    ds_read_b64_tr_b16 a[32:33], v11 offset:8192
    ds_read_b64_tr_b16 a[34:35], v11 offset:9216
    ds_read_b64_tr_b16 a[36:37], v11 offset:8200
    ds_read_b64_tr_b16 a[38:39], v11 offset:9224
    s_waitcnt lgkmcnt(0)
    s_waitcnt vmcnt(4)
    s_barrier
    s_add_u32 m0, s99, 98304
    s_mov_b32 s62, 4128768
    buffer_load_dwordx4 v9, s[12:15], s62 offen lds
    s_add_u32 m0, s99, 99328
    s_mov_b32 s62, 4165632
    buffer_load_dwordx4 v9, s[12:15], s62 offen lds
    s_add_u32 m0, s99, 100352
    s_mov_b32 s62, 4202496
    buffer_load_dwordx4 v9, s[12:15], s62 offen lds
    s_add_u32 m0, s99, 101376
    s_mov_b32 s62, 4239360
    buffer_load_dwordx4 v9, s[12:15], s62 offen lds
    v_add_u32 v11, 65536, v10
    ds_read_b64_tr_b16 a[24:25], v11 offset:0
    ds_read_b64_tr_b16 a[26:27], v11 offset:1024
    ds_read_b64_tr_b16 a[28:29], v11 offset:8
    ds_read_b64_tr_b16 a[30:31], v11 offset:1032
    ds_read_b64_tr_b16 a[40:41], v11 offset:8192
    ds_read_b64_tr_b16 a[42:43], v11 offset:9216
    ds_read_b64_tr_b16 a[44:45], v11 offset:8200
    ds_read_b64_tr_b16 a[46:47], v11 offset:9224
    s_waitcnt lgkmcnt(0)
    s_waitcnt vmcnt(4)
    s_barrier
    s_add_u32 m0, s99, 114688
    s_mov_b32 s62, 4718592
    buffer_load_dwordx4 v9, s[8:11], s62 offen lds
    s_add_u32 m0, s99, 115712
    s_mov_b32 s62, 4755456
    buffer_load_dwordx4 v9, s[8:11], s62 offen lds
    s_add_u32 m0, s99, 116736
    s_mov_b32 s62, 4792320
    buffer_load_dwordx4 v9, s[8:11], s62 offen lds
    s_add_u32 m0, s99, 117760
    s_mov_b32 s62, 4829184
    buffer_load_dwordx4 v9, s[8:11], s62 offen lds
    v_add_u32 v11, 81920, v10
    ds_read_b64_tr_b16 a[48:49], v11 offset:0
    ds_read_b64_tr_b16 a[50:51], v11 offset:1024
    ds_read_b64_tr_b16 a[52:53], v11 offset:8
    ds_read_b64_tr_b16 a[54:55], v11 offset:1032
    ds_read_b64_tr_b16 a[64:65], v11 offset:8192
    ds_read_b64_tr_b16 a[66:67], v11 offset:9216
    ds_read_b64_tr_b16 a[68:69], v11 offset:8200
    ds_read_b64_tr_b16 a[70:71], v11 offset:9224
    s_waitcnt lgkmcnt(0)
    s_waitcnt vmcnt(4)
    s_barrier
    s_add_u32 m0, s99, 131072
    s_mov_b32 s62, 4718592
    buffer_load_dwordx4 v9, s[12:15], s62 offen lds
    s_add_u32 m0, s99, 132096
    s_mov_b32 s62, 4755456
    buffer_load_dwordx4 v9, s[12:15], s62 offen lds
    s_add_u32 m0, s99, 133120
    s_mov_b32 s62, 4792320
    buffer_load_dwordx4 v9, s[12:15], s62 offen lds
    s_add_u32 m0, s99, 134144
    s_mov_b32 s62, 4829184
    buffer_load_dwordx4 v9, s[12:15], s62 offen lds
    v_add_u32 v11, 98304, v10
    ds_read_b64_tr_b16 a[56:57], v11 offset:0
    ds_read_b64_tr_b16 a[58:59], v11 offset:1024
    ds_read_b64_tr_b16 a[60:61], v11 offset:8
    ds_read_b64_tr_b16 a[62:63], v11 offset:1032
    ds_read_b64_tr_b16 a[72:73], v11 offset:8192
    ds_read_b64_tr_b16 a[74:75], v11 offset:9216
    ds_read_b64_tr_b16 a[76:77], v11 offset:8200
    ds_read_b64_tr_b16 a[78:79], v11 offset:9224
    s_waitcnt lgkmcnt(0)
    s_waitcnt vmcnt(4)
    s_barrier
    s_add_u32 m0, s99, 0
    s_mov_b32 s62, 0
    buffer_load_dwordx4 v12, s[16:19], s62 offen lds
    s_add_u32 m0, s99, 1024
    s_mov_b32 s62, 9216
    buffer_load_dwordx4 v12, s[16:19], s62 offen lds
    s_add_u32 m0, s99, 2048
    s_mov_b32 s62, 18432
    buffer_load_dwordx4 v12, s[16:19], s62 offen lds
    s_add_u32 m0, s99, 3072
    s_mov_b32 s62, 27648
    buffer_load_dwordx4 v12, s[16:19], s62 offen lds
    v_add_u32 v11, 114688, v10
    ds_read_b64_tr_b16 a[80:81], v11 offset:0
    ds_read_b64_tr_b16 a[82:83], v11 offset:1024
    ds_read_b64_tr_b16 a[84:85], v11 offset:8
    ds_read_b64_tr_b16 a[86:87], v11 offset:1032
    ds_read_b64_tr_b16 a[96:97], v11 offset:8192
    ds_read_b64_tr_b16 a[98:99], v11 offset:9216
    ds_read_b64_tr_b16 a[100:101], v11 offset:8200
    ds_read_b64_tr_b16 a[102:103], v11 offset:9224
    s_waitcnt lgkmcnt(0)
    s_waitcnt vmcnt(4)
    s_barrier
    s_add_u32 m0, s99, 16384
    s_mov_b32 s62, 128
    buffer_load_dwordx4 v12, s[16:19], s62 offen lds
    s_add_u32 m0, s99, 17408
    s_mov_b32 s62, 9344
    buffer_load_dwordx4 v12, s[16:19], s62 offen lds
    s_add_u32 m0, s99, 18432
    s_mov_b32 s62, 18560
    buffer_load_dwordx4 v12, s[16:19], s62 offen lds
    s_add_u32 m0, s99, 19456
    s_mov_b32 s62, 27776
    buffer_load_dwordx4 v12, s[16:19], s62 offen lds
    v_add_u32 v11, 131072, v10
    ds_read_b64_tr_b16 a[88:89], v11 offset:0
    ds_read_b64_tr_b16 a[90:91], v11 offset:1024
    ds_read_b64_tr_b16 a[92:93], v11 offset:8
    ds_read_b64_tr_b16 a[94:95], v11 offset:1032
    ds_read_b64_tr_b16 a[104:105], v11 offset:8192
    ds_read_b64_tr_b16 a[106:107], v11 offset:9216
    ds_read_b64_tr_b16 a[108:109], v11 offset:8200
    ds_read_b64_tr_b16 a[110:111], v11 offset:9224
    s_waitcnt lgkmcnt(0)
    s_waitcnt vmcnt(4)
    s_barrier
    s_add_u32 m0, s99, 32768
    s_mov_b32 s62, 256
    buffer_load_dwordx4 v12, s[16:19], s62 offen lds
    s_add_u32 m0, s99, 33792
    s_mov_b32 s62, 9472
    buffer_load_dwordx4 v12, s[16:19], s62 offen lds
    s_add_u32 m0, s99, 34816
    s_mov_b32 s62, 18688
    buffer_load_dwordx4 v12, s[16:19], s62 offen lds
    s_add_u32 m0, s99, 35840
    s_mov_b32 s62, 27904
    buffer_load_dwordx4 v12, s[16:19], s62 offen lds
    v_add_u32 v11, 0, v13
    ds_read_b64_tr_b16 a[112:113], v11 offset:0
    ds_read_b64_tr_b16 a[114:115], v11 offset:512
    ds_read_b64_tr_b16 a[116:117], v11 offset:4096
    ds_read_b64_tr_b16 a[118:119], v11 offset:4608
    ds_read_b64_tr_b16 a[120:121], v11 offset:8192
    ds_read_b64_tr_b16 a[122:123], v11 offset:8704
    ds_read_b64_tr_b16 a[124:125], v11 offset:12288
    ds_read_b64_tr_b16 a[126:127], v11 offset:12800
    s_waitcnt lgkmcnt(0)
    s_waitcnt vmcnt(4)
    s_barrier
    s_add_u32 m0, s99, 49152
    s_mov_b32 s62, 384
    buffer_load_dwordx4 v12, s[16:19], s62 offen lds
    s_add_u32 m0, s99, 50176
    s_mov_b32 s62, 9600
    buffer_load_dwordx4 v12, s[16:19], s62 offen lds
    s_add_u32 m0, s99, 51200
    s_mov_b32 s62, 18816
    buffer_load_dwordx4 v12, s[16:19], s62 offen lds
    s_add_u32 m0, s99, 52224
    s_mov_b32 s62, 28032
    buffer_load_dwordx4 v12, s[16:19], s62 offen lds
    v_add_u32 v11, 16384, v13
    ds_read_b64_tr_b16 a[128:129], v11 offset:0
    ds_read_b64_tr_b16 a[130:131], v11 offset:512
    ds_read_b64_tr_b16 a[132:133], v11 offset:4096
    ds_read_b64_tr_b16 a[134:135], v11 offset:4608
    ds_read_b64_tr_b16 a[136:137], v11 offset:8192
    ds_read_b64_tr_b16 a[138:139], v11 offset:8704
    ds_read_b64_tr_b16 a[140:141], v11 offset:12288
    ds_read_b64_tr_b16 a[142:143], v11 offset:12800
    s_waitcnt lgkmcnt(0)
    s_waitcnt vmcnt(4)
    s_barrier
    s_add_u32 m0, s99, 65536
    s_mov_b32 s62, 512
    buffer_load_dwordx4 v12, s[16:19], s62 offen lds
    s_add_u32 m0, s99, 66560
    s_mov_b32 s62, 9728
    buffer_load_dwordx4 v12, s[16:19], s62 offen lds
    s_add_u32 m0, s99, 67584
    s_mov_b32 s62, 18944
    buffer_load_dwordx4 v12, s[16:19], s62 offen lds
    s_add_u32 m0, s99, 68608
    s_mov_b32 s62, 28160
    buffer_load_dwordx4 v12, s[16:19], s62 offen lds
    v_add_u32 v11, 32768, v13
    ds_read_b64_tr_b16 a[144:145], v11 offset:0
    ds_read_b64_tr_b16 a[146:147], v11 offset:512
    ds_read_b64_tr_b16 a[148:149], v11 offset:4096
    ds_read_b64_tr_b16 a[150:151], v11 offset:4608
    ds_read_b64_tr_b16 a[152:153], v11 offset:8192
    ds_read_b64_tr_b16 a[154:155], v11 offset:8704
    ds_read_b64_tr_b16 a[156:157], v11 offset:12288
    ds_read_b64_tr_b16 a[158:159], v11 offset:12800
    s_waitcnt lgkmcnt(0)
    s_waitcnt vmcnt(4)
    s_barrier
    s_add_u32 m0, s99, 81920
    s_mov_b32 s62, 640
    buffer_load_dwordx4 v12, s[16:19], s62 offen lds
    s_add_u32 m0, s99, 82944
    s_mov_b32 s62, 9856
    buffer_load_dwordx4 v12, s[16:19], s62 offen lds
    s_add_u32 m0, s99, 83968
    s_mov_b32 s62, 19072
    buffer_load_dwordx4 v12, s[16:19], s62 offen lds
    s_add_u32 m0, s99, 84992
    s_mov_b32 s62, 28288
    buffer_load_dwordx4 v12, s[16:19], s62 offen lds
    v_add_u32 v11, 49152, v13
    ds_read_b64_tr_b16 a[160:161], v11 offset:0
    ds_read_b64_tr_b16 a[162:163], v11 offset:512
    ds_read_b64_tr_b16 a[164:165], v11 offset:4096
    ds_read_b64_tr_b16 a[166:167], v11 offset:4608
    ds_read_b64_tr_b16 a[168:169], v11 offset:8192
    ds_read_b64_tr_b16 a[170:171], v11 offset:8704
    ds_read_b64_tr_b16 a[172:173], v11 offset:12288
    ds_read_b64_tr_b16 a[174:175], v11 offset:12800
    s_waitcnt lgkmcnt(0)
    s_waitcnt vmcnt(4)
    s_barrier
    s_add_u32 m0, s99, 98304
    s_mov_b32 s62, 768
    buffer_load_dwordx4 v12, s[16:19], s62 offen lds
    s_add_u32 m0, s99, 99328
    s_mov_b32 s62, 9984
    buffer_load_dwordx4 v12, s[16:19], s62 offen lds
    s_add_u32 m0, s99, 100352
    s_mov_b32 s62, 19200
    buffer_load_dwordx4 v12, s[16:19], s62 offen lds
    s_add_u32 m0, s99, 101376
    s_mov_b32 s62, 28416
    buffer_load_dwordx4 v12, s[16:19], s62 offen lds
    v_add_u32 v11, 65536, v13
    ds_read_b64_tr_b16 a[176:177], v11 offset:0
    ds_read_b64_tr_b16 a[178:179], v11 offset:512
    ds_read_b64_tr_b16 a[180:181], v11 offset:4096
    ds_read_b64_tr_b16 a[182:183], v11 offset:4608
    ds_read_b64_tr_b16 a[184:185], v11 offset:8192
    ds_read_b64_tr_b16 a[186:187], v11 offset:8704
    ds_read_b64_tr_b16 a[188:189], v11 offset:12288
    ds_read_b64_tr_b16 a[190:191], v11 offset:12800
    s_waitcnt lgkmcnt(0)
    s_waitcnt vmcnt(4)
    s_barrier
    s_add_u32 m0, s99, 114688
    s_mov_b32 s62, 896
    buffer_load_dwordx4 v12, s[16:19], s62 offen lds
    s_add_u32 m0, s99, 115712
    s_mov_b32 s62, 10112
    buffer_load_dwordx4 v12, s[16:19], s62 offen lds
    s_add_u32 m0, s99, 116736
    s_mov_b32 s62, 19328
    buffer_load_dwordx4 v12, s[16:19], s62 offen lds
    s_add_u32 m0, s99, 117760
    s_mov_b32 s62, 28544
    buffer_load_dwordx4 v12, s[16:19], s62 offen lds
    v_add_u32 v11, 81920, v13
    ds_read_b64_tr_b16 a[192:193], v11 offset:0
    ds_read_b64_tr_b16 a[194:195], v11 offset:512
    ds_read_b64_tr_b16 a[196:197], v11 offset:4096
    ds_read_b64_tr_b16 a[198:199], v11 offset:4608
    ds_read_b64_tr_b16 a[200:201], v11 offset:8192
    ds_read_b64_tr_b16 a[202:203], v11 offset:8704
    ds_read_b64_tr_b16 a[204:205], v11 offset:12288
    ds_read_b64_tr_b16 a[206:207], v11 offset:12800
    s_waitcnt lgkmcnt(0)
    s_waitcnt vmcnt(4)
    s_barrier
    s_add_u32 m0, s99, 131072
    s_mov_b32 s62, 1024
    buffer_load_dwordx4 v12, s[16:19], s62 offen lds
    s_add_u32 m0, s99, 132096
    s_mov_b32 s62, 10240
    buffer_load_dwordx4 v12, s[16:19], s62 offen lds
    s_add_u32 m0, s99, 133120
    s_mov_b32 s62, 19456
    buffer_load_dwordx4 v12, s[16:19], s62 offen lds
    s_add_u32 m0, s99, 134144
    s_mov_b32 s62, 28672
    buffer_load_dwordx4 v12, s[16:19], s62 offen lds
    v_add_u32 v11, 98304, v13
    ds_read_b64_tr_b16 a[208:209], v11 offset:0
    ds_read_b64_tr_b16 a[210:211], v11 offset:512
    ds_read_b64_tr_b16 a[212:213], v11 offset:4096
    ds_read_b64_tr_b16 a[214:215], v11 offset:4608
    ds_read_b64_tr_b16 a[216:217], v11 offset:8192
    ds_read_b64_tr_b16 a[218:219], v11 offset:8704
    ds_read_b64_tr_b16 a[220:221], v11 offset:12288
    ds_read_b64_tr_b16 a[222:223], v11 offset:12800
    s_waitcnt lgkmcnt(0)
    s_waitcnt vmcnt(4)
    s_barrier
    v_add_u32 v11, 114688, v13
    ds_read_b64_tr_b16 a[224:225], v11 offset:0
    ds_read_b64_tr_b16 a[226:227], v11 offset:512
    ds_read_b64_tr_b16 a[228:229], v11 offset:4096
    ds_read_b64_tr_b16 a[230:231], v11 offset:4608
    ds_read_b64_tr_b16 a[232:233], v11 offset:8192
    ds_read_b64_tr_b16 a[234:235], v11 offset:8704
    ds_read_b64_tr_b16 a[236:237], v11 offset:12288
    ds_read_b64_tr_b16 a[238:239], v11 offset:12800
    s_waitcnt lgkmcnt(0)
    s_waitcnt vmcnt(0)
    s_barrier
    v_add_u32 v11, 131072, v13
    ds_read_b64_tr_b16 a[240:241], v11 offset:0
    ds_read_b64_tr_b16 a[242:243], v11 offset:512
    ds_read_b64_tr_b16 a[244:245], v11 offset:4096
    ds_read_b64_tr_b16 a[246:247], v11 offset:4608
    ds_read_b64_tr_b16 a[248:249], v11 offset:8192
    ds_read_b64_tr_b16 a[250:251], v11 offset:8704
    ds_read_b64_tr_b16 a[252:253], v11 offset:12288
    ds_read_b64_tr_b16 a[254:255], v11 offset:12800
    s_waitcnt lgkmcnt(0)
    s_barrier
    v_lshrrev_b32 v5, 3, v1
    v_xor_b32 v7, v5, v1
    v_and_b32 v7, 7, v7
    v_mul_u32_u24 v9, 1152, v5
    v_lshl_add_u32 v9, v7, 4, v9
    s_mul_i32 s39, s33, 9216
    v_add_u32 v9, s39, v9
    v_and_b32 v5, 7, v1
    v_xor_b32 v7, v2, v5
    v_lshlrev_b32 v7, 4, v7
    v_lshl_add_u32 v7, v5, 7, v7
    v_bfe_u32 v5, v1, 3, 1
    v_mul_u32_u24 v5, 9216, v5
    v_add_u32 v7, v7, v5
    v_xor_b32 v8, 64, v7
    s_lshl_b32 s60, s33, 10
    s_add_u32 s60, s60, 40960
    v_add_u32 v6, s60, v0
    v_and_b32 v5, 15, v1
    v_lshlrev_b32 v5, 4, v5
    v_lshl_add_u32 v2, v2, 10, v5
    s_lshl_b32 s60, s33, 8
    v_add_u32 v2, s60, v2
    v_mul_u32_u24 v3, 1152, v1
    s_lshl_b32 s60, s34, 5
    s_lshl_b32 s61, s33, 3
    s_add_u32 s60, s60, s61
    v_add_u32 v3, s60, v3
    v_mov_b32 v5, 0x40000000
    v_cmp_gt_u32 vcc, 32, v1
    s_nop 1
    v_cndmask_b32 v3, v5, v3, vcc
    s_lshl_b32 s60, s60, 1
    s_add_u32 s60, s60, 80751872
    buffer_load_dwordx4 v[26:29], off, s[4:7], s60 sc1
    s_waitcnt vmcnt(0)
    v_readfirstlane_b32 s46, v26
    v_readfirstlane_b32 s47, v27
    v_readfirstlane_b32 s48, v28
    v_readfirstlane_b32 s49, v29
    s_mov_b32 s36, s35
    s_add_u32 s60, s35, 60
    s_mul_i32 s60, s60, 1327104
    s_mul_i32 s61, s33, 36
    s_add_u32 s61, s61, s34
    s_lshl_b32 s61, s61, 10
    s_add_u32 s60, s60, s61
    s_add_u32 s60, s60, 125829120
    v_mov_b64 v[26:27], -1
    v_mov_b64 v[28:29], -1
    buffer_store_dwordx4 v[26:29], v0, s[4:7], s60 offen sc1
    s_add_u32 s60, s60, 147456
    buffer_store_dwordx4 v[26:29], v0, s[4:7], s60 offen sc1
    s_add_u32 s60, s60, 147456
    buffer_store_dwordx4 v[26:29], v0, s[4:7], s60 offen sc1
    s_add_u32 s60, s60, 147456
    buffer_store_dwordx4 v[26:29], v0, s[4:7], s60 offen sc1
    s_add_u32 s60, s60, 147456
    buffer_store_dwordx4 v[26:29], v0, s[4:7], s60 offen sc1
    s_add_u32 s60, s60, 147456
    buffer_store_dwordx4 v[26:29], v0, s[4:7], s60 offen sc1
    s_add_u32 s60, s60, 147456
    buffer_store_dwordx4 v[26:29], v0, s[4:7], s60 offen sc1
    s_add_u32 s60, s60, 147456
    buffer_store_dwordx4 v[26:29], v0, s[4:7], s60 offen sc1
    s_add_u32 s60, s60, 147456
    buffer_store_dwordx4 v[26:29], v0, s[4:7], s60 offen sc1
    s_add_u32 s60, s60, 147456
    s_mov_b32 s43, -1
L_ctop_98:
    s_lshl_b32 s60, s36, 8
    s_add_u32 s60, s60, 81814528
    s_mul_i32 s38, s36, 36864
    s_add_u32 s38, s38, 74448896
    s_cmp_ge_u32 s36, 56
    s_cbranch_scc1 L_ccan_100
L_wf_103:
    buffer_load_dword v5, off, s[4:7], s60 offset:128 sc1
    s_waitcnt vmcnt(0)
    v_cmp_eq_u32 vcc, 0, v5
    s_cbranch_vccz L_wfok_104
    s_sleep 2
    s_sub_u32 s37, s37, 1
    s_cbranch_scc0 L_wf_103
    s_mov_b32 s37, 0
L_wfok_104:
    s_add_u32 m0, s39, 0
    s_nop 0
    buffer_load_dwordx4 v9, s[4:7], s38 offen offset:0 sc1 lds
    s_add_u32 m0, s39, 896
    s_nop 0
    buffer_load_dwordx4 v9, s[4:7], s38 offen offset:128 sc1 lds
    s_add_u32 m0, s39, 1792
    s_nop 0
    buffer_load_dwordx4 v9, s[4:7], s38 offen offset:256 sc1 lds
    s_add_u32 m0, s39, 2688
    s_nop 0
    buffer_load_dwordx4 v9, s[4:7], s38 offen offset:384 sc1 lds
    s_add_u32 m0, s39, 3584
    s_nop 0
    buffer_load_dwordx4 v9, s[4:7], s38 offen offset:512 sc1 lds
    s_add_u32 m0, s39, 4480
    s_nop 0
    buffer_load_dwordx4 v9, s[4:7], s38 offen offset:640 sc1 lds
    s_add_u32 m0, s39, 5376
    s_nop 0
    buffer_load_dwordx4 v9, s[4:7], s38 offen offset:768 sc1 lds
    s_add_u32 m0, s39, 6272
    s_nop 0
    buffer_load_dwordx4 v9, s[4:7], s38 offen offset:896 sc1 lds
    s_add_u32 m0, s39, 7168
    s_nop 0
    buffer_load_dwordx4 v9, s[4:7], s38 offen offset:1024 sc1 lds
    s_branch L_cj_101
L_ccan_100:
    s_add_u32 s60, s38, 3145728
    buffer_load_dword v5, v9, s[4:7], s60 offen sc1
    s_waitcnt vmcnt(0)
    v_cmp_eq_u32 vcc, -1, v5
    s_cbranch_vccz L_cnow_105
    s_lshl_b32 s41, s43, 8
    s_mul_i32 s44, s43, 36864
    v_and_b32 v5, 1, v1
    v_lshlrev_b32 v5, 4, v5
    v_mov_b32 v10, 0x3f80
    v_lshlrev_b32 v5, v5, v10
    v_cndmask_b32 v10, 0, v5, s[80:81]
    v_cndmask_b32 v11, 0, v5, s[82:83]
    v_cndmask_b32 v12, 0, v5, s[84:85]
    v_cndmask_b32 v13, 0, v5, s[86:87]
    s_add_u32 s41, s41, 81830912
L_wf_106:
    buffer_load_dword v5, off, s[4:7], s41 offset:128 sc1
    s_waitcnt vmcnt(0)
    v_cmp_eq_u32 vcc, 0, v5
    s_cbranch_vccz L_wfok_107
    s_sleep 2
    s_sub_u32 s37, s37, 1
    s_cbranch_scc0 L_wf_106
    s_mov_b32 s37, 0
L_wfok_107:
L_cre_108:
    s_add_u32 s60, s44, 77594624
    buffer_load_dwordx2 v[18:19], v3, s[4:7], s60 offen sc1
    s_mul_i32 s60, s34, 36864
    s_add_u32 s60, s60, s40
    buffer_load_dwordx4 v[26:29], v2, s[4:7], s60 offen sc1
    s_add_u32 s60, s60, 4096
    buffer_load_dwordx4 v[30:33], v2, s[4:7], s60 offen sc1
    s_add_u32 s60, s60, 4096
    buffer_load_dwordx4 v[34:37], v2, s[4:7], s60 offen sc1
    s_add_u32 s60, s60, 4096
    buffer_load_dwordx4 v[38:41], v2, s[4:7], s60 offen sc1
    s_add_u32 s60, s60, 4096
    buffer_load_dwordx4 v[42:45], v2, s[4:7], s60 offen sc1
    s_add_u32 s60, s60, 4096
    buffer_load_dwordx4 v[46:49], v2, s[4:7], s60 offen sc1
    s_add_u32 s60, s60, 4096
    buffer_load_dwordx4 v[50:53], v2, s[4:7], s60 offen sc1
    s_add_u32 s60, s60, 4096
    buffer_load_dwordx4 v[54:57], v2, s[4:7], s60 offen sc1
    s_add_u32 s60, s60, 4096
    buffer_load_dwordx4 v[58:61], v2, s[4:7], s60 offen sc1
    s_waitcnt vmcnt(8)
    v_mfma_f32_16x16x32_bf16 v[14:17], v[10:13], v[26:29], 0
    s_waitcnt vmcnt(7)
    v_mfma_f32_16x16x32_bf16 v[14:17], v[10:13], v[30:33], v[14:17]
    s_waitcnt vmcnt(6)
    v_mfma_f32_16x16x32_bf16 v[14:17], v[10:13], v[34:37], v[14:17]
    s_waitcnt vmcnt(5)
    v_mfma_f32_16x16x32_bf16 v[14:17], v[10:13], v[38:41], v[14:17]
    s_waitcnt vmcnt(4)
    v_mfma_f32_16x16x32_bf16 v[14:17], v[10:13], v[42:45], v[14:17]
    s_waitcnt vmcnt(3)
    v_mfma_f32_16x16x32_bf16 v[14:17], v[10:13], v[46:49], v[14:17]
    s_waitcnt vmcnt(2)
    v_mfma_f32_16x16x32_bf16 v[14:17], v[10:13], v[50:53], v[14:17]
    s_waitcnt vmcnt(1)
    v_mfma_f32_16x16x32_bf16 v[14:17], v[10:13], v[54:57], v[14:17]
    s_waitcnt vmcnt(0)
    v_mfma_f32_16x16x32_bf16 v[14:17], v[10:13], v[58:61], v[14:17]
    v_max_u32 v5, v18, v19
    v_cmp_eq_u32 vcc, -1, v5
    s_cbranch_vccz L_sok_109
    s_sub_u32 s37, s37, 1
    s_cbranch_scc0 L_cre_108
    s_mov_b32 s37, 0
L_sok_109:
    v_and_b32 v21, 0xffff0000, v18
    v_lshlrev_b32 v20, 16, v18
    v_and_b32 v23, 0xffff0000, v19
    v_lshlrev_b32 v22, 16, v19
    s_nop 3
    v_cvt_pk_bf16_f32 v15, v14, v15
    v_lshlrev_b32 v14, 16, v15
    v_and_b32 v15, 0xffff0000, v15
    v_cvt_pk_bf16_f32 v17, v16, v17
    v_lshlrev_b32 v16, 16, v17
    v_and_b32 v17, 0xffff0000, v17
    v_mul_f32 v14, s46, v14
    v_mul_f32 v15, s47, v15
    v_mul_f32 v16, s48, v16
    v_mul_f32 v17, s49, v17
    v_cvt_pk_bf16_f32 v15, v14, v15
    v_lshlrev_b32 v14, 16, v15
    v_and_b32 v15, 0xffff0000, v15
    v_cvt_pk_bf16_f32 v17, v16, v17
    v_lshlrev_b32 v16, 16, v17
    v_and_b32 v17, 0xffff0000, v17
    v_add_f32 v14, v14, v20
    v_add_f32 v15, v15, v21
    v_add_f32 v16, v16, v22
    v_add_f32 v17, v17, v23
    v_cvt_pk_bf16_f32 v14, v14, v15
    v_cvt_pk_bf16_f32 v15, v16, v17
    buffer_store_dwordx2 v[14:15], v3, s[20:23], s44 offen
    s_mov_b32 s43, -1
L_cnow_105:
    s_add_u32 s60, s38, 3145728
L_cn_110:
    buffer_load_dword v5, v9, s[4:7], s60 offen offset:0 sc1
    s_waitcnt vmcnt(0)
    v_cmp_eq_u32 vcc, -1, v5
    s_cbranch_vccz L_cnok_111
    s_sleep 1
    s_sub_u32 s37, s37, 1
    s_cbranch_scc0 L_cn_110
    s_mov_b32 s37, 0
L_cnok_111:
L_cxre_102:
    buffer_load_dwordx4 v[26:29], v9, s[4:7], s38 offen offset:0 sc1
    buffer_load_dwordx4 v[30:33], v9, s[4:7], s38 offen offset:128 sc1
    buffer_load_dwordx4 v[34:37], v9, s[4:7], s38 offen offset:256 sc1
    buffer_load_dwordx4 v[38:41], v9, s[4:7], s38 offen offset:384 sc1
    buffer_load_dwordx4 v[42:45], v9, s[4:7], s38 offen offset:512 sc1
    buffer_load_dwordx4 v[46:49], v9, s[4:7], s38 offen offset:640 sc1
    buffer_load_dwordx4 v[50:53], v9, s[4:7], s38 offen offset:768 sc1
    buffer_load_dwordx4 v[54:57], v9, s[4:7], s38 offen offset:896 sc1
    buffer_load_dwordx4 v[58:61], v9, s[4:7], s38 offen offset:1024 sc1
    v_add_u32 v10, s39, v0
    s_waitcnt vmcnt(8)
    ds_write_b128 v10, v[26:29] offset:0
    v_max_u32 v5, v26, v27
    v_max3_u32 v5, v5, v28, v29
    s_waitcnt vmcnt(7)
    ds_write_b128 v10, v[30:33] offset:1024
    v_max3_u32 v5, v5, v30, v31
    v_max3_u32 v5, v5, v32, v33
    s_waitcnt vmcnt(6)
    ds_write_b128 v10, v[34:37] offset:2048
    v_max3_u32 v5, v5, v34, v35
    v_max3_u32 v5, v5, v36, v37
    s_waitcnt vmcnt(5)
    ds_write_b128 v10, v[38:41] offset:3072
    v_max3_u32 v5, v5, v38, v39
    v_max3_u32 v5, v5, v40, v41
    s_waitcnt vmcnt(4)
    ds_write_b128 v10, v[42:45] offset:4096
    v_max3_u32 v5, v5, v42, v43
    v_max3_u32 v5, v5, v44, v45
    s_waitcnt vmcnt(3)
    ds_write_b128 v10, v[46:49] offset:5120
    v_max3_u32 v5, v5, v46, v47
    v_max3_u32 v5, v5, v48, v49
    s_waitcnt vmcnt(2)
    ds_write_b128 v10, v[50:53] offset:6144
    v_max3_u32 v5, v5, v50, v51
    v_max3_u32 v5, v5, v52, v53
    s_waitcnt vmcnt(1)
    ds_write_b128 v10, v[54:57] offset:7168
    v_max3_u32 v5, v5, v54, v55
    v_max3_u32 v5, v5, v56, v57
    s_waitcnt vmcnt(0)
    ds_write_b128 v10, v[58:61] offset:8192
    v_max3_u32 v5, v5, v58, v59
    v_max3_u32 v5, v5, v60, v61
    v_cmp_eq_u32 vcc, -1, v5
    s_cbranch_vccz L_sok_112
    s_sub_u32 s37, s37, 1
    s_cbranch_scc0 L_cxre_102
    s_mov_b32 s37, 0
L_sok_112:
    s_waitcnt lgkmcnt(0)
L_cj_101:
    s_waitcnt vmcnt(0)
    s_barrier
    ds_read_b128 v[10:13], v7 offset:0
    ds_read_b128 v[14:17], v8 offset:0
    ds_read_b128 v[18:21], v7 offset:1024
    s_waitcnt lgkmcnt(2)
    v_mfma_f32_16x16x32_bf16 v[26:29], v[80:83], v[10:13], 0
    ds_read_b128 v[22:25], v8 offset:1024
    v_mfma_f32_16x16x32_bf16 v[30:33], v[84:87], v[10:13], 0
    v_mfma_f32_16x16x32_bf16 v[34:37], v[88:91], v[10:13], 0
    v_mfma_f32_16x16x32_bf16 v[38:41], v[92:95], v[10:13], 0
    s_waitcnt lgkmcnt(2)
    v_mfma_f32_16x16x32_bf16 v[26:29], v[96:99], v[14:17], v[26:29]
    ds_read_b128 v[10:13], v7 offset:2048
    v_mfma_f32_16x16x32_bf16 v[30:33], v[100:103], v[14:17], v[30:33]
    v_mfma_f32_16x16x32_bf16 v[34:37], v[104:107], v[14:17], v[34:37]
    v_mfma_f32_16x16x32_bf16 v[38:41], v[108:111], v[14:17], v[38:41]
    s_waitcnt lgkmcnt(2)
    v_mfma_f32_16x16x32_bf16 v[26:29], v[112:115], v[18:21], v[26:29]
    ds_read_b128 v[14:17], v8 offset:2048
    v_mfma_f32_16x16x32_bf16 v[30:33], v[116:119], v[18:21], v[30:33]
    v_mfma_f32_16x16x32_bf16 v[34:37], v[120:123], v[18:21], v[34:37]
    v_mfma_f32_16x16x32_bf16 v[38:41], v[124:127], v[18:21], v[38:41]
    s_waitcnt lgkmcnt(2)
    v_mfma_f32_16x16x32_bf16 v[26:29], v[128:131], v[22:25], v[26:29]
    ds_read_b128 v[18:21], v7 offset:3072
    v_mfma_f32_16x16x32_bf16 v[30:33], v[132:135], v[22:25], v[30:33]
    v_mfma_f32_16x16x32_bf16 v[34:37], v[136:139], v[22:25], v[34:37]
    v_mfma_f32_16x16x32_bf16 v[38:41], v[140:143], v[22:25], v[38:41]
    s_waitcnt lgkmcnt(2)
    v_mfma_f32_16x16x32_bf16 v[26:29], v[144:147], v[10:13], v[26:29]
    ds_read_b128 v[22:25], v8 offset:3072
    v_mfma_f32_16x16x32_bf16 v[30:33], v[148:151], v[10:13], v[30:33]
    v_mfma_f32_16x16x32_bf16 v[34:37], v[152:155], v[10:13], v[34:37]
    v_mfma_f32_16x16x32_bf16 v[38:41], v[156:159], v[10:13], v[38:41]
    s_waitcnt lgkmcnt(2)
    v_mfma_f32_16x16x32_bf16 v[26:29], v[160:163], v[14:17], v[26:29]
    ds_read_b128 v[10:13], v7 offset:4096
    v_mfma_f32_16x16x32_bf16 v[30:33], v[164:167], v[14:17], v[30:33]
    v_mfma_f32_16x16x32_bf16 v[34:37], v[168:171], v[14:17], v[34:37]
    v_mfma_f32_16x16x32_bf16 v[38:41], v[172:175], v[14:17], v[38:41]
    s_waitcnt lgkmcnt(2)
    v_mfma_f32_16x16x32_bf16 v[26:29], v[176:179], v[18:21], v[26:29]
    ds_read_b128 v[14:17], v8 offset:4096
    v_mfma_f32_16x16x32_bf16 v[30:33], v[180:183], v[18:21], v[30:33]
    v_mfma_f32_16x16x32_bf16 v[34:37], v[184:187], v[18:21], v[34:37]
    v_mfma_f32_16x16x32_bf16 v[38:41], v[188:191], v[18:21], v[38:41]
    s_waitcnt lgkmcnt(2)
    v_mfma_f32_16x16x32_bf16 v[26:29], v[192:195], v[22:25], v[26:29]
    ds_read_b128 v[18:21], v7 offset:5120
    v_mfma_f32_16x16x32_bf16 v[30:33], v[196:199], v[22:25], v[30:33]
    v_mfma_f32_16x16x32_bf16 v[34:37], v[200:203], v[22:25], v[34:37]
    v_mfma_f32_16x16x32_bf16 v[38:41], v[204:207], v[22:25], v[38:41]
    s_waitcnt lgkmcnt(2)
    v_mfma_f32_16x16x32_bf16 v[26:29], v[208:211], v[10:13], v[26:29]
    ds_read_b128 v[22:25], v8 offset:5120
    v_mfma_f32_16x16x32_bf16 v[30:33], v[212:215], v[10:13], v[30:33]
    v_mfma_f32_16x16x32_bf16 v[34:37], v[216:219], v[10:13], v[34:37]
    v_mfma_f32_16x16x32_bf16 v[38:41], v[220:223], v[10:13], v[38:41]
    s_waitcnt lgkmcnt(2)
    v_mfma_f32_16x16x32_bf16 v[26:29], v[224:227], v[14:17], v[26:29]
    ds_read_b128 v[10:13], v7 offset:6144
    v_mfma_f32_16x16x32_bf16 v[30:33], v[228:231], v[14:17], v[30:33]
    v_mfma_f32_16x16x32_bf16 v[34:37], v[232:235], v[14:17], v[34:37]
    v_mfma_f32_16x16x32_bf16 v[38:41], v[236:239], v[14:17], v[38:41]
    s_waitcnt lgkmcnt(2)
    v_mfma_f32_16x16x32_bf16 v[26:29], v[240:243], v[18:21], v[26:29]
    ds_read_b128 v[14:17], v8 offset:6144
    v_mfma_f32_16x16x32_bf16 v[30:33], v[244:247], v[18:21], v[30:33]
    v_mfma_f32_16x16x32_bf16 v[34:37], v[248:251], v[18:21], v[34:37]
    v_mfma_f32_16x16x32_bf16 v[38:41], v[252:255], v[18:21], v[38:41]
    s_waitcnt lgkmcnt(2)
    v_mfma_f32_16x16x32_bf16 v[26:29], a[0:3], v[22:25], v[26:29]
    ds_read_b128 v[18:21], v7 offset:7168
    v_mfma_f32_16x16x32_bf16 v[30:33], a[4:7], v[22:25], v[30:33]
    v_mfma_f32_16x16x32_bf16 v[34:37], a[8:11], v[22:25], v[34:37]
    v_mfma_f32_16x16x32_bf16 v[38:41], a[12:15], v[22:25], v[38:41]
    s_waitcnt lgkmcnt(2)
    v_mfma_f32_16x16x32_bf16 v[26:29], a[16:19], v[10:13], v[26:29]
    ds_read_b128 v[22:25], v8 offset:7168
    v_mfma_f32_16x16x32_bf16 v[30:33], a[20:23], v[10:13], v[30:33]
    v_mfma_f32_16x16x32_bf16 v[34:37], a[24:27], v[10:13], v[34:37]
    v_mfma_f32_16x16x32_bf16 v[38:41], a[28:31], v[10:13], v[38:41]
    s_waitcnt lgkmcnt(2)
    v_mfma_f32_16x16x32_bf16 v[26:29], a[32:35], v[14:17], v[26:29]
    ds_read_b128 v[10:13], v7 offset:8192
    v_mfma_f32_16x16x32_bf16 v[30:33], a[36:39], v[14:17], v[30:33]
    v_mfma_f32_16x16x32_bf16 v[34:37], a[40:43], v[14:17], v[34:37]
    v_mfma_f32_16x16x32_bf16 v[38:41], a[44:47], v[14:17], v[38:41]
    s_waitcnt lgkmcnt(2)
    v_mfma_f32_16x16x32_bf16 v[26:29], a[48:51], v[18:21], v[26:29]
    ds_read_b128 v[14:17], v8 offset:8192
    v_mfma_f32_16x16x32_bf16 v[30:33], a[52:55], v[18:21], v[30:33]
    v_mfma_f32_16x16x32_bf16 v[34:37], a[56:59], v[18:21], v[34:37]
    v_mfma_f32_16x16x32_bf16 v[38:41], a[60:63], v[18:21], v[38:41]
    s_waitcnt lgkmcnt(2)
    v_mfma_f32_16x16x32_bf16 v[26:29], a[64:67], v[22:25], v[26:29]
    ds_read_b128 v[18:21], v7 offset:18432
    v_mfma_f32_16x16x32_bf16 v[30:33], a[68:71], v[22:25], v[30:33]
    v_mfma_f32_16x16x32_bf16 v[34:37], a[72:75], v[22:25], v[34:37]
    v_mfma_f32_16x16x32_bf16 v[38:41], a[76:79], v[22:25], v[38:41]
    s_waitcnt lgkmcnt(2)
    v_mfma_f32_16x16x32_bf16 v[26:29], a[80:83], v[10:13], v[26:29]
    ds_read_b128 v[22:25], v8 offset:18432
    v_mfma_f32_16x16x32_bf16 v[30:33], a[84:87], v[10:13], v[30:33]
    v_mfma_f32_16x16x32_bf16 v[34:37], a[88:91], v[10:13], v[34:37]
    v_mfma_f32_16x16x32_bf16 v[38:41], a[92:95], v[10:13], v[38:41]
    s_waitcnt lgkmcnt(2)
    v_mfma_f32_16x16x32_bf16 v[26:29], a[96:99], v[14:17], v[26:29]
    ds_read_b128 v[10:13], v7 offset:19456
    v_mfma_f32_16x16x32_bf16 v[30:33], a[100:103], v[14:17], v[30:33]
    v_mfma_f32_16x16x32_bf16 v[34:37], a[104:107], v[14:17], v[34:37]
    v_mfma_f32_16x16x32_bf16 v[38:41], a[108:111], v[14:17], v[38:41]
    s_waitcnt lgkmcnt(2)
    v_mfma_f32_16x16x32_bf16 v[42:45], v[80:83], v[18:21], 0
    ds_read_b128 v[14:17], v8 offset:19456
    v_mfma_f32_16x16x32_bf16 v[46:49], v[84:87], v[18:21], 0
    v_mfma_f32_16x16x32_bf16 v[50:53], v[88:91], v[18:21], 0
    v_mfma_f32_16x16x32_bf16 v[54:57], v[92:95], v[18:21], 0
    s_waitcnt lgkmcnt(2)
    v_mfma_f32_16x16x32_bf16 v[42:45], v[96:99], v[22:25], v[42:45]
    ds_read_b128 v[18:21], v7 offset:20480
    v_mfma_f32_16x16x32_bf16 v[46:49], v[100:103], v[22:25], v[46:49]
    v_mfma_f32_16x16x32_bf16 v[50:53], v[104:107], v[22:25], v[50:53]
    v_mfma_f32_16x16x32_bf16 v[54:57], v[108:111], v[22:25], v[54:57]
    s_waitcnt lgkmcnt(2)
    v_mfma_f32_16x16x32_bf16 v[42:45], v[112:115], v[10:13], v[42:45]
    ds_read_b128 v[22:25], v8 offset:20480
    v_mfma_f32_16x16x32_bf16 v[46:49], v[116:119], v[10:13], v[46:49]
    v_cvt_pk_bf16_f32 v34, v26, v34
    v_lshlrev_b32 v26, 16, v34
    v_mfma_f32_16x16x32_bf16 v[50:53], v[120:123], v[10:13], v[50:53]
    v_and_b32 v34, 0xffff0000, v34
    v_mul_f32 v26, v26, v34
    v_mfma_f32_16x16x32_bf16 v[54:57], v[124:127], v[10:13], v[54:57]
    v_cvt_pk_bf16_f32 v35, v27, v35
    v_lshlrev_b32 v27, 16, v35
    s_waitcnt lgkmcnt(2)
    v_mfma_f32_16x16x32_bf16 v[42:45], v[128:131], v[14:17], v[42:45]
    ds_read_b128 v[10:13], v7 offset:21504
    v_mfma_f32_16x16x32_bf16 v[46:49], v[132:135], v[14:17], v[46:49]
    v_and_b32 v35, 0xffff0000, v35
    v_mul_f32 v27, v27, v35
    v_mfma_f32_16x16x32_bf16 v[50:53], v[136:139], v[14:17], v[50:53]
    v_cvt_pk_bf16_f32 v36, v28, v36
    v_lshlrev_b32 v28, 16, v36
    v_mfma_f32_16x16x32_bf16 v[54:57], v[140:143], v[14:17], v[54:57]
    v_and_b32 v36, 0xffff0000, v36
    v_mul_f32 v28, v28, v36
    s_waitcnt lgkmcnt(2)
    v_mfma_f32_16x16x32_bf16 v[42:45], v[144:147], v[18:21], v[42:45]
    ds_read_b128 v[14:17], v8 offset:21504
    v_mfma_f32_16x16x32_bf16 v[46:49], v[148:151], v[18:21], v[46:49]
    v_cvt_pk_bf16_f32 v37, v29, v37
    v_lshlrev_b32 v29, 16, v37
    v_mfma_f32_16x16x32_bf16 v[50:53], v[152:155], v[18:21], v[50:53]
    v_and_b32 v37, 0xffff0000, v37
    v_mul_f32 v29, v29, v37
    v_mfma_f32_16x16x32_bf16 v[54:57], v[156:159], v[18:21], v[54:57]
    v_cvt_pk_bf16_f32 v58, v26, v27
    v_cvt_pk_bf16_f32 v59, v28, v29
    s_waitcnt lgkmcnt(2)
    v_mfma_f32_16x16x32_bf16 v[42:45], v[160:163], v[22:25], v[42:45]
    ds_read_b128 v[18:21], v7 offset:22528
    v_mfma_f32_16x16x32_bf16 v[46:49], v[164:167], v[22:25], v[46:49]
    v_cvt_pk_bf16_f32 v38, v30, v38
    v_lshlrev_b32 v30, 16, v38
    v_mfma_f32_16x16x32_bf16 v[50:53], v[168:171], v[22:25], v[50:53]
    v_and_b32 v38, 0xffff0000, v38
    v_mul_f32 v30, v30, v38
    v_mfma_f32_16x16x32_bf16 v[54:57], v[172:175], v[22:25], v[54:57]
    v_cvt_pk_bf16_f32 v39, v31, v39
    v_lshlrev_b32 v31, 16, v39
    s_waitcnt lgkmcnt(2)
    v_mfma_f32_16x16x32_bf16 v[42:45], v[176:179], v[10:13], v[42:45]
    ds_read_b128 v[22:25], v8 offset:22528
    v_mfma_f32_16x16x32_bf16 v[46:49], v[180:183], v[10:13], v[46:49]
    v_and_b32 v39, 0xffff0000, v39
    v_mul_f32 v31, v31, v39
    v_mfma_f32_16x16x32_bf16 v[50:53], v[184:187], v[10:13], v[50:53]
    v_cvt_pk_bf16_f32 v40, v32, v40
    v_lshlrev_b32 v32, 16, v40
    v_mfma_f32_16x16x32_bf16 v[54:57], v[188:191], v[10:13], v[54:57]
    v_and_b32 v40, 0xffff0000, v40
    v_mul_f32 v32, v32, v40
    s_waitcnt lgkmcnt(2)
    v_mfma_f32_16x16x32_bf16 v[42:45], v[192:195], v[14:17], v[42:45]
    ds_read_b128 v[10:13], v7 offset:23552
    v_mfma_f32_16x16x32_bf16 v[46:49], v[196:199], v[14:17], v[46:49]
    v_cvt_pk_bf16_f32 v41, v33, v41
    v_lshlrev_b32 v33, 16, v41
    v_mfma_f32_16x16x32_bf16 v[50:53], v[200:203], v[14:17], v[50:53]
    v_and_b32 v41, 0xffff0000, v41
    v_mul_f32 v33, v33, v41
    v_mfma_f32_16x16x32_bf16 v[54:57], v[204:207], v[14:17], v[54:57]
    v_cvt_pk_bf16_f32 v60, v30, v31
    v_cvt_pk_bf16_f32 v61, v32, v33
    s_waitcnt lgkmcnt(2)
    v_mfma_f32_16x16x32_bf16 v[42:45], v[208:211], v[18:21], v[42:45]
    ds_read_b128 v[14:17], v8 offset:23552
    v_mfma_f32_16x16x32_bf16 v[46:49], v[212:215], v[18:21], v[46:49]
    ds_write_b128 v6, v[58:61] offset:0
    v_mfma_f32_16x16x32_bf16 v[50:53], v[216:219], v[18:21], v[50:53]
    v_mfma_f32_16x16x32_bf16 v[54:57], v[220:223], v[18:21], v[54:57]
    s_waitcnt lgkmcnt(3)
    v_mfma_f32_16x16x32_bf16 v[42:45], v[224:227], v[22:25], v[42:45]
    ds_read_b128 v[18:21], v7 offset:24576
    v_mfma_f32_16x16x32_bf16 v[46:49], v[228:231], v[22:25], v[46:49]
    v_mfma_f32_16x16x32_bf16 v[50:53], v[232:235], v[22:25], v[50:53]
    v_mfma_f32_16x16x32_bf16 v[54:57], v[236:239], v[22:25], v[54:57]
    s_waitcnt lgkmcnt(3)
    v_mfma_f32_16x16x32_bf16 v[42:45], v[240:243], v[10:13], v[42:45]
    ds_read_b128 v[22:25], v8 offset:24576
    v_mfma_f32_16x16x32_bf16 v[46:49], v[244:247], v[10:13], v[46:49]
    v_mfma_f32_16x16x32_bf16 v[50:53], v[248:251], v[10:13], v[50:53]
    v_mfma_f32_16x16x32_bf16 v[54:57], v[252:255], v[10:13], v[54:57]
    s_waitcnt lgkmcnt(3)
    v_mfma_f32_16x16x32_bf16 v[42:45], a[0:3], v[14:17], v[42:45]
    ds_read_b128 v[10:13], v7 offset:25600
    v_mfma_f32_16x16x32_bf16 v[46:49], a[4:7], v[14:17], v[46:49]
    v_mfma_f32_16x16x32_bf16 v[50:53], a[8:11], v[14:17], v[50:53]
    v_mfma_f32_16x16x32_bf16 v[54:57], a[12:15], v[14:17], v[54:57]
    s_waitcnt lgkmcnt(2)
    v_mfma_f32_16x16x32_bf16 v[42:45], a[16:19], v[18:21], v[42:45]
    ds_read_b128 v[14:17], v8 offset:25600
    v_mfma_f32_16x16x32_bf16 v[46:49], a[20:23], v[18:21], v[46:49]
    v_mfma_f32_16x16x32_bf16 v[50:53], a[24:27], v[18:21], v[50:53]
    v_mfma_f32_16x16x32_bf16 v[54:57], a[28:31], v[18:21], v[54:57]
    s_waitcnt lgkmcnt(2)
    v_mfma_f32_16x16x32_bf16 v[42:45], a[32:35], v[22:25], v[42:45]
    ds_read_b128 v[18:21], v7 offset:26624
    v_mfma_f32_16x16x32_bf16 v[46:49], a[36:39], v[22:25], v[46:49]
    v_mfma_f32_16x16x32_bf16 v[50:53], a[40:43], v[22:25], v[50:53]
    v_mfma_f32_16x16x32_bf16 v[54:57], a[44:47], v[22:25], v[54:57]
    s_barrier
    s_waitcnt lgkmcnt(2)
    v_mfma_f32_16x16x32_bf16 v[42:45], a[48:51], v[10:13], v[42:45]
    ds_read_b128 v[22:25], v8 offset:26624
    v_mfma_f32_16x16x32_bf16 v[46:49], a[52:55], v[10:13], v[46:49]
    v_mfma_f32_16x16x32_bf16 v[50:53], a[56:59], v[10:13], v[50:53]
    v_mfma_f32_16x16x32_bf16 v[54:57], a[60:63], v[10:13], v[54:57]
    s_waitcnt lgkmcnt(2)
    v_mfma_f32_16x16x32_bf16 v[42:45], a[64:67], v[14:17], v[42:45]
    ds_read_b128 v[10:13], v0 offset:40960
    v_mfma_f32_16x16x32_bf16 v[46:49], a[68:71], v[14:17], v[46:49]
    v_mfma_f32_16x16x32_bf16 v[50:53], a[72:75], v[14:17], v[50:53]
    v_mfma_f32_16x16x32_bf16 v[54:57], a[76:79], v[14:17], v[54:57]
    s_waitcnt lgkmcnt(2)
    v_mfma_f32_16x16x32_bf16 v[42:45], a[80:83], v[18:21], v[42:45]
    ds_read_b128 v[14:17], v0 offset:41984
    v_mfma_f32_16x16x32_bf16 v[46:49], a[84:87], v[18:21], v[46:49]
    v_mfma_f32_16x16x32_bf16 v[50:53], a[88:91], v[18:21], v[50:53]
    v_mfma_f32_16x16x32_bf16 v[54:57], a[92:95], v[18:21], v[54:57]
    s_waitcnt lgkmcnt(2)
    v_mfma_f32_16x16x32_bf16 v[42:45], a[96:99], v[22:25], v[42:45]
    ds_read_b128 v[18:21], v0 offset:43008
    v_mfma_f32_16x16x32_bf16 v[46:49], a[100:103], v[22:25], v[46:49]
    v_mfma_f32_16x16x32_bf16 v[50:53], a[104:107], v[22:25], v[50:53]
    v_mfma_f32_16x16x32_bf16 v[54:57], a[108:111], v[22:25], v[54:57]
    ds_read_b128 v[22:25], v0 offset:44032
    s_mul_i32 s42, s36, 1327104
    s_add_u32 s42, s42, 125829120
    s_mul_i32 s60, s33, 36
    s_add_u32 s60, s60, s34
    s_lshl_b32 s60, s60, 10
    s_add_u32 s60, s60, s42
    s_waitcnt lgkmcnt(3)
    v_mfma_f32_16x16x32_bf16 v[26:29], a[112:115], v[10:13], 0
    v_cvt_pk_bf16_f32 v50, v42, v50
    v_lshlrev_b32 v42, 16, v50
    s_waitcnt lgkmcnt(2)
    v_mfma_f32_16x16x32_bf16 v[26:29], a[116:119], v[14:17], v[26:29]
    v_and_b32 v50, 0xffff0000, v50
    v_mul_f32 v42, v42, v50
    s_waitcnt lgkmcnt(1)
    v_mfma_f32_16x16x32_bf16 v[26:29], a[120:123], v[18:21], v[26:29]
    v_cvt_pk_bf16_f32 v51, v43, v51
    v_lshlrev_b32 v43, 16, v51
    s_waitcnt lgkmcnt(0)
    v_mfma_f32_16x16x32_bf16 v[26:29], a[124:127], v[22:25], v[26:29]
    v_and_b32 v51, 0xffff0000, v51
    v_mul_f32 v43, v43, v51
    v_mfma_f32_16x16x32_bf16 v[30:33], a[128:131], v[10:13], 0
    v_cvt_pk_bf16_f32 v52, v44, v52
    v_lshlrev_b32 v44, 16, v52
    v_mfma_f32_16x16x32_bf16 v[30:33], a[132:135], v[14:17], v[30:33]
    v_and_b32 v52, 0xffff0000, v52
    v_mul_f32 v44, v44, v52
    v_mfma_f32_16x16x32_bf16 v[30:33], a[136:139], v[18:21], v[30:33]
    v_cvt_pk_bf16_f32 v53, v45, v53
    v_lshlrev_b32 v45, 16, v53
    v_mfma_f32_16x16x32_bf16 v[30:33], a[140:143], v[22:25], v[30:33]
    v_and_b32 v53, 0xffff0000, v53
    v_mul_f32 v45, v45, v53
    v_mfma_f32_16x16x32_bf16 v[34:37], a[144:147], v[10:13], 0
    v_cvt_pk_bf16_f32 v58, v42, v43
    v_cvt_pk_bf16_f32 v59, v44, v45
    v_mfma_f32_16x16x32_bf16 v[34:37], a[148:151], v[14:17], v[34:37]
    v_cvt_pk_bf16_f32 v62, v26, v27
    v_cvt_pk_bf16_f32 v63, v28, v29
    v_mfma_f32_16x16x32_bf16 v[34:37], a[152:155], v[18:21], v[34:37]
    v_cvt_pk_bf16_f32 v54, v46, v54
    v_lshlrev_b32 v46, 16, v54
    v_mfma_f32_16x16x32_bf16 v[34:37], a[156:159], v[22:25], v[34:37]
    v_and_b32 v54, 0xffff0000, v54
    v_mul_f32 v46, v46, v54
    v_mfma_f32_16x16x32_bf16 v[38:41], a[160:163], v[10:13], 0
    v_cvt_pk_bf16_f32 v55, v47, v55
    v_lshlrev_b32 v47, 16, v55
    v_mfma_f32_16x16x32_bf16 v[38:41], a[164:167], v[14:17], v[38:41]
    v_cvt_pk_bf16_f32 v64, v30, v31
    v_cvt_pk_bf16_f32 v65, v32, v33
    v_mfma_f32_16x16x32_bf16 v[38:41], a[168:171], v[18:21], v[38:41]
    v_and_b32 v55, 0xffff0000, v55
    v_mul_f32 v47, v47, v55
    v_mfma_f32_16x16x32_bf16 v[38:41], a[172:175], v[22:25], v[38:41]
    v_cvt_pk_bf16_f32 v56, v48, v56
    v_lshlrev_b32 v48, 16, v56
    v_mfma_f32_16x16x32_bf16 v[26:29], a[176:179], v[10:13], 0
    v_and_b32 v56, 0xffff0000, v56
    v_mul_f32 v48, v48, v56
    v_mfma_f32_16x16x32_bf16 v[26:29], a[180:183], v[14:17], v[26:29]
    v_cvt_pk_bf16_f32 v66, v34, v35
    v_cvt_pk_bf16_f32 v67, v36, v37
    v_mfma_f32_16x16x32_bf16 v[26:29], a[184:187], v[18:21], v[26:29]
    v_cvt_pk_bf16_f32 v57, v49, v57
    v_lshlrev_b32 v49, 16, v57
    v_mfma_f32_16x16x32_bf16 v[26:29], a[188:191], v[22:25], v[26:29]
    v_and_b32 v57, 0xffff0000, v57
    v_mul_f32 v49, v49, v57
    v_mfma_f32_16x16x32_bf16 v[30:33], a[192:195], v[10:13], 0
    v_cvt_pk_bf16_f32 v60, v46, v47
    v_cvt_pk_bf16_f32 v61, v48, v49
    v_mfma_f32_16x16x32_bf16 v[30:33], a[196:199], v[14:17], v[30:33]
    v_cvt_pk_bf16_f32 v68, v38, v39
    v_cvt_pk_bf16_f32 v69, v40, v41
    v_mfma_f32_16x16x32_bf16 v[30:33], a[200:203], v[18:21], v[30:33]
    ds_write_b128 v6, v[58:61] offset:4096
    v_mfma_f32_16x16x32_bf16 v[30:33], a[204:207], v[22:25], v[30:33]
    s_nop 0
    v_mfma_f32_16x16x32_bf16 v[34:37], a[208:211], v[10:13], 0
    s_nop 0
    v_mfma_f32_16x16x32_bf16 v[34:37], a[212:215], v[14:17], v[34:37]
    v_cvt_pk_bf16_f32 v70, v26, v27
    v_cvt_pk_bf16_f32 v71, v28, v29
    v_mfma_f32_16x16x32_bf16 v[34:37], a[216:219], v[18:21], v[34:37]
    s_nop 0
    v_mfma_f32_16x16x32_bf16 v[34:37], a[220:223], v[22:25], v[34:37]
    s_nop 0
    s_waitcnt lgkmcnt(0)
    s_barrier
    ds_read_b128 v[42:45], v0 offset:45056
    ds_read_b128 v[46:49], v0 offset:46080
    ds_read_b128 v[50:53], v0 offset:47104
    ds_read_b128 v[54:57], v0 offset:48128
    v_mfma_f32_16x16x32_bf16 v[38:41], a[224:227], v[10:13], 0
    s_nop 0
    v_mfma_f32_16x16x32_bf16 v[38:41], a[228:231], v[14:17], v[38:41]
    v_cvt_pk_bf16_f32 v72, v30, v31
    v_cvt_pk_bf16_f32 v73, v32, v33
    v_mfma_f32_16x16x32_bf16 v[38:41], a[232:235], v[18:21], v[38:41]
    s_nop 0
    v_mfma_f32_16x16x32_bf16 v[38:41], a[236:239], v[22:25], v[38:41]
    s_nop 0
    v_mfma_f32_16x16x32_bf16 v[26:29], a[240:243], v[10:13], 0
    s_nop 0
    v_mfma_f32_16x16x32_bf16 v[26:29], a[244:247], v[14:17], v[26:29]
    v_cvt_pk_bf16_f32 v74, v34, v35
    v_cvt_pk_bf16_f32 v75, v36, v37
    v_mfma_f32_16x16x32_bf16 v[26:29], a[248:251], v[18:21], v[26:29]
    s_nop 0
    v_mfma_f32_16x16x32_bf16 v[26:29], a[252:255], v[22:25], v[26:29]
    s_nop 0
    s_waitcnt lgkmcnt(3)
    v_mfma_f32_16x16x32_bf16 v[30:33], a[112:115], v[42:45], 0
    s_nop 0
    s_waitcnt lgkmcnt(2)
    v_mfma_f32_16x16x32_bf16 v[30:33], a[116:119], v[46:49], v[30:33]
    v_cvt_pk_bf16_f32 v76, v38, v39
    v_cvt_pk_bf16_f32 v77, v40, v41
    s_waitcnt lgkmcnt(1)
    v_mfma_f32_16x16x32_bf16 v[30:33], a[120:123], v[50:53], v[30:33]
    s_nop 0
    s_waitcnt lgkmcnt(0)
    v_mfma_f32_16x16x32_bf16 v[30:33], a[124:127], v[54:57], v[30:33]
    s_nop 0
    v_mfma_f32_16x16x32_bf16 v[34:37], a[128:131], v[42:45], 0
    s_nop 0
    v_mfma_f32_16x16x32_bf16 v[34:37], a[132:135], v[46:49], v[34:37]
    v_cvt_pk_bf16_f32 v78, v26, v27
    v_cvt_pk_bf16_f32 v79, v28, v29
    v_mfma_f32_16x16x32_bf16 v[34:37], a[136:139], v[50:53], v[34:37]
    s_nop 0
    v_mfma_f32_16x16x32_bf16 v[34:37], a[140:143], v[54:57], v[34:37]
    s_nop 0
    v_mfma_f32_16x16x32_bf16 v[38:41], a[144:147], v[42:45], 0
    v_cvt_pk_bf16_f32 v33, v32, v33
    v_cvt_pk_bf16_f32 v32, v30, v31
    v_mfma_f32_16x16x32_bf16 v[38:41], a[148:151], v[46:49], v[38:41]
    v_mov_b64 v[30:31], v[62:63]
    buffer_store_dwordx4 v[30:33], v0, s[4:7], s60 offen sc1
    v_mfma_f32_16x16x32_bf16 v[38:41], a[152:155], v[50:53], v[38:41]
    s_add_u32 s60, s60, 147456
    v_mfma_f32_16x16x32_bf16 v[38:41], a[156:159], v[54:57], v[38:41]
    s_nop 0
    v_mfma_f32_16x16x32_bf16 v[26:29], a[160:163], v[42:45], 0
    v_cvt_pk_bf16_f32 v37, v36, v37
    v_cvt_pk_bf16_f32 v36, v34, v35
    v_mfma_f32_16x16x32_bf16 v[26:29], a[164:167], v[46:49], v[26:29]
    v_mov_b64 v[34:35], v[64:65]
    buffer_store_dwordx4 v[34:37], v0, s[4:7], s60 offen sc1
    v_mfma_f32_16x16x32_bf16 v[26:29], a[168:171], v[50:53], v[26:29]
    s_add_u32 s60, s60, 147456
    v_mfma_f32_16x16x32_bf16 v[26:29], a[172:175], v[54:57], v[26:29]
    s_nop 0
    v_mfma_f32_16x16x32_bf16 v[30:33], a[176:179], v[42:45], 0
    v_cvt_pk_bf16_f32 v41, v40, v41
    v_cvt_pk_bf16_f32 v40, v38, v39
    v_mfma_f32_16x16x32_bf16 v[30:33], a[180:183], v[46:49], v[30:33]
    v_mov_b64 v[38:39], v[66:67]
    buffer_store_dwordx4 v[38:41], v0, s[4:7], s60 offen sc1
    v_mfma_f32_16x16x32_bf16 v[30:33], a[184:187], v[50:53], v[30:33]
    s_add_u32 s60, s60, 147456
    v_mfma_f32_16x16x32_bf16 v[30:33], a[188:191], v[54:57], v[30:33]
    s_nop 0
    v_mfma_f32_16x16x32_bf16 v[34:37], a[192:195], v[42:45], 0
    v_cvt_pk_bf16_f32 v29, v28, v29
    v_cvt_pk_bf16_f32 v28, v26, v27
    v_mfma_f32_16x16x32_bf16 v[34:37], a[196:199], v[46:49], v[34:37]
    v_mov_b64 v[26:27], v[68:69]
    buffer_store_dwordx4 v[26:29], v0, s[4:7], s60 offen sc1
    v_mfma_f32_16x16x32_bf16 v[34:37], a[200:203], v[50:53], v[34:37]
    s_add_u32 s60, s60, 147456
    v_mfma_f32_16x16x32_bf16 v[34:37], a[204:207], v[54:57], v[34:37]
    s_nop 0
    v_mfma_f32_16x16x32_bf16 v[38:41], a[208:211], v[42:45], 0
    v_cvt_pk_bf16_f32 v33, v32, v33
    v_cvt_pk_bf16_f32 v32, v30, v31
    v_mfma_f32_16x16x32_bf16 v[38:41], a[212:215], v[46:49], v[38:41]
    v_mov_b64 v[30:31], v[70:71]
    buffer_store_dwordx4 v[30:33], v0, s[4:7], s60 offen sc1
    v_mfma_f32_16x16x32_bf16 v[38:41], a[216:219], v[50:53], v[38:41]
    s_add_u32 s60, s60, 147456
    v_mfma_f32_16x16x32_bf16 v[38:41], a[220:223], v[54:57], v[38:41]
    s_nop 0
    v_mfma_f32_16x16x32_bf16 v[26:29], a[224:227], v[42:45], 0
    v_cvt_pk_bf16_f32 v37, v36, v37
    v_cvt_pk_bf16_f32 v36, v34, v35
    v_mfma_f32_16x16x32_bf16 v[26:29], a[228:231], v[46:49], v[26:29]
    v_mov_b64 v[34:35], v[72:73]
    buffer_store_dwordx4 v[34:37], v0, s[4:7], s60 offen sc1
    v_mfma_f32_16x16x32_bf16 v[26:29], a[232:235], v[50:53], v[26:29]
    s_add_u32 s60, s60, 147456
    v_mfma_f32_16x16x32_bf16 v[26:29], a[236:239], v[54:57], v[26:29]
    s_nop 0
    v_mfma_f32_16x16x32_bf16 v[30:33], a[240:243], v[42:45], 0
    v_cvt_pk_bf16_f32 v41, v40, v41
    v_cvt_pk_bf16_f32 v40, v38, v39
    v_mfma_f32_16x16x32_bf16 v[30:33], a[244:247], v[46:49], v[30:33]
    v_mov_b64 v[38:39], v[74:75]
    buffer_store_dwordx4 v[38:41], v0, s[4:7], s60 offen sc1
    v_mfma_f32_16x16x32_bf16 v[30:33], a[248:251], v[50:53], v[30:33]
    s_add_u32 s60, s60, 147456
    v_mfma_f32_16x16x32_bf16 v[30:33], a[252:255], v[54:57], v[30:33]
    s_nop 0
    v_cvt_pk_bf16_f32 v29, v28, v29
    v_cvt_pk_bf16_f32 v28, v26, v27
    v_mov_b64 v[26:27], v[76:77]
    buffer_store_dwordx4 v[26:29], v0, s[4:7], s60 offen sc1
    s_add_u32 s60, s60, 147456
    s_nop 1
    v_cvt_pk_bf16_f32 v33, v32, v33
    v_cvt_pk_bf16_f32 v32, v30, v31
    v_mov_b64 v[30:31], v[78:79]
    buffer_store_dwordx4 v[30:33], v0, s[4:7], s60 offen sc1
    s_add_u32 s60, s60, 147456
    s_cmp_ge_u32 s36, 60
    s_cbranch_scc1 L_clast_113
    s_waitcnt vmcnt(0)
    s_barrier
    s_lshl_b32 s60, s36, 8
    s_add_u32 s60, s60, 81830912
    s_cmp_lg_u32 s33, 0
    s_cbranch_scc1 L_ar_114
    s_mov_b64 exec, 1
    v_mov_b32 v5, 1
    buffer_atomic_add v5, off, s[4:7], s60 sc0
    s_waitcnt vmcnt(0)
    v_cmpx_eq_u32 vcc, 35, v5
    s_cbranch_execz L_ar_114_x
    buffer_store_dword v5, off, s[4:7], s60 offset:128 sc1
L_ar_114_x:
    s_mov_b64 exec, -1
L_ar_114:
    s_cmp_eq_u32 s43, -1
    s_cbranch_scc1 L_cfirst_99
    s_lshl_b32 s41, s43, 8
    s_mul_i32 s44, s43, 36864
    v_and_b32 v5, 1, v1
    v_lshlrev_b32 v5, 4, v5
    v_mov_b32 v10, 0x3f80
    v_lshlrev_b32 v5, v5, v10
    v_cndmask_b32 v10, 0, v5, s[80:81]
    v_cndmask_b32 v11, 0, v5, s[82:83]
    v_cndmask_b32 v12, 0, v5, s[84:85]
    v_cndmask_b32 v13, 0, v5, s[86:87]
    s_add_u32 s41, s41, 81830912
L_wf_115:
    buffer_load_dword v5, off, s[4:7], s41 offset:128 sc1
    s_waitcnt vmcnt(0)
    v_cmp_eq_u32 vcc, 0, v5
    s_cbranch_vccz L_wfok_116
    s_sleep 2
    s_sub_u32 s37, s37, 1
    s_cbranch_scc0 L_wf_115
    s_mov_b32 s37, 0
L_wfok_116:
L_cre_117:
    s_add_u32 s60, s44, 77594624
    buffer_load_dwordx2 v[18:19], v3, s[4:7], s60 offen sc1
    s_mul_i32 s60, s34, 36864
    s_add_u32 s60, s60, s40
    buffer_load_dwordx4 v[26:29], v2, s[4:7], s60 offen sc1
    s_add_u32 s60, s60, 4096
    buffer_load_dwordx4 v[30:33], v2, s[4:7], s60 offen sc1
    s_add_u32 s60, s60, 4096
    buffer_load_dwordx4 v[34:37], v2, s[4:7], s60 offen sc1
    s_add_u32 s60, s60, 4096
    buffer_load_dwordx4 v[38:41], v2, s[4:7], s60 offen sc1
    s_add_u32 s60, s60, 4096
    buffer_load_dwordx4 v[42:45], v2, s[4:7], s60 offen sc1
    s_add_u32 s60, s60, 4096
    buffer_load_dwordx4 v[46:49], v2, s[4:7], s60 offen sc1
    s_add_u32 s60, s60, 4096
    buffer_load_dwordx4 v[50:53], v2, s[4:7], s60 offen sc1
    s_add_u32 s60, s60, 4096
    buffer_load_dwordx4 v[54:57], v2, s[4:7], s60 offen sc1
    s_add_u32 s60, s60, 4096
    buffer_load_dwordx4 v[58:61], v2, s[4:7], s60 offen sc1
    s_waitcnt vmcnt(8)
    v_mfma_f32_16x16x32_bf16 v[14:17], v[10:13], v[26:29], 0
    s_waitcnt vmcnt(7)
    v_mfma_f32_16x16x32_bf16 v[14:17], v[10:13], v[30:33], v[14:17]
    s_waitcnt vmcnt(6)
    v_mfma_f32_16x16x32_bf16 v[14:17], v[10:13], v[34:37], v[14:17]
    s_waitcnt vmcnt(5)
    v_mfma_f32_16x16x32_bf16 v[14:17], v[10:13], v[38:41], v[14:17]
    s_waitcnt vmcnt(4)
    v_mfma_f32_16x16x32_bf16 v[14:17], v[10:13], v[42:45], v[14:17]
    s_waitcnt vmcnt(3)
    v_mfma_f32_16x16x32_bf16 v[14:17], v[10:13], v[46:49], v[14:17]
    s_waitcnt vmcnt(2)
    v_mfma_f32_16x16x32_bf16 v[14:17], v[10:13], v[50:53], v[14:17]
    s_waitcnt vmcnt(1)
    v_mfma_f32_16x16x32_bf16 v[14:17], v[10:13], v[54:57], v[14:17]
    s_waitcnt vmcnt(0)
    v_mfma_f32_16x16x32_bf16 v[14:17], v[10:13], v[58:61], v[14:17]
    v_max_u32 v5, v18, v19
    v_cmp_eq_u32 vcc, -1, v5
    s_cbranch_vccz L_sok_118
    s_sub_u32 s37, s37, 1
    s_cbranch_scc0 L_cre_117
    s_mov_b32 s37, 0
L_sok_118:
    v_and_b32 v21, 0xffff0000, v18
    v_lshlrev_b32 v20, 16, v18
    v_and_b32 v23, 0xffff0000, v19
    v_lshlrev_b32 v22, 16, v19
    s_nop 3
    v_cvt_pk_bf16_f32 v15, v14, v15
    v_lshlrev_b32 v14, 16, v15
    v_and_b32 v15, 0xffff0000, v15
    v_cvt_pk_bf16_f32 v17, v16, v17
    v_lshlrev_b32 v16, 16, v17
    v_and_b32 v17, 0xffff0000, v17
    v_mul_f32 v14, s46, v14
    v_mul_f32 v15, s47, v15
    v_mul_f32 v16, s48, v16
    v_mul_f32 v17, s49, v17
    v_cvt_pk_bf16_f32 v15, v14, v15
    v_lshlrev_b32 v14, 16, v15
    v_and_b32 v15, 0xffff0000, v15
    v_cvt_pk_bf16_f32 v17, v16, v17
    v_lshlrev_b32 v16, 16, v17
    v_and_b32 v17, 0xffff0000, v17
    v_add_f32 v14, v14, v20
    v_add_f32 v15, v15, v21
    v_add_f32 v16, v16, v22
    v_add_f32 v17, v17, v23
    v_cvt_pk_bf16_f32 v14, v14, v15
    v_cvt_pk_bf16_f32 v15, v16, v17
    buffer_store_dwordx2 v[14:15], v3, s[20:23], s44 offen
L_cfirst_99:
    s_mov_b32 s43, s36
    s_mov_b32 s40, s42
    s_add_u32 s36, s36, 4
    s_branch L_ctop_98
L_clast_113:
    s_cmp_eq_u32 s43, -1
    s_cbranch_scc1 L_cdn_119
    s_lshl_b32 s41, s43, 8
    s_mul_i32 s44, s43, 36864
    v_and_b32 v5, 1, v1
    v_lshlrev_b32 v5, 4, v5
    v_mov_b32 v10, 0x3f80
    v_lshlrev_b32 v5, v5, v10
    v_cndmask_b32 v10, 0, v5, s[80:81]
    v_cndmask_b32 v11, 0, v5, s[82:83]
    v_cndmask_b32 v12, 0, v5, s[84:85]
    v_cndmask_b32 v13, 0, v5, s[86:87]
    s_add_u32 s41, s41, 81830912
L_wf_120:
    buffer_load_dword v5, off, s[4:7], s41 offset:128 sc1
    s_waitcnt vmcnt(0)
    v_cmp_eq_u32 vcc, 0, v5
    s_cbranch_vccz L_wfok_121
    s_sleep 2
    s_sub_u32 s37, s37, 1
    s_cbranch_scc0 L_wf_120
    s_mov_b32 s37, 0
L_wfok_121:
L_cre_122:
    s_add_u32 s60, s44, 77594624
    buffer_load_dwordx2 v[18:19], v3, s[4:7], s60 offen sc1
    s_mul_i32 s60, s34, 36864
    s_add_u32 s60, s60, s40
    buffer_load_dwordx4 v[26:29], v2, s[4:7], s60 offen sc1
    s_add_u32 s60, s60, 4096
    buffer_load_dwordx4 v[30:33], v2, s[4:7], s60 offen sc1
    s_add_u32 s60, s60, 4096
    buffer_load_dwordx4 v[34:37], v2, s[4:7], s60 offen sc1
    s_add_u32 s60, s60, 4096
    buffer_load_dwordx4 v[38:41], v2, s[4:7], s60 offen sc1
    s_add_u32 s60, s60, 4096
    buffer_load_dwordx4 v[42:45], v2, s[4:7], s60 offen sc1
    s_add_u32 s60, s60, 4096
    buffer_load_dwordx4 v[46:49], v2, s[4:7], s60 offen sc1
    s_add_u32 s60, s60, 4096
    buffer_load_dwordx4 v[50:53], v2, s[4:7], s60 offen sc1
    s_add_u32 s60, s60, 4096
    buffer_load_dwordx4 v[54:57], v2, s[4:7], s60 offen sc1
    s_add_u32 s60, s60, 4096
    buffer_load_dwordx4 v[58:61], v2, s[4:7], s60 offen sc1
    s_waitcnt vmcnt(8)
    v_mfma_f32_16x16x32_bf16 v[14:17], v[10:13], v[26:29], 0
    s_waitcnt vmcnt(7)
    v_mfma_f32_16x16x32_bf16 v[14:17], v[10:13], v[30:33], v[14:17]
    s_waitcnt vmcnt(6)
    v_mfma_f32_16x16x32_bf16 v[14:17], v[10:13], v[34:37], v[14:17]
    s_waitcnt vmcnt(5)
    v_mfma_f32_16x16x32_bf16 v[14:17], v[10:13], v[38:41], v[14:17]
    s_waitcnt vmcnt(4)
    v_mfma_f32_16x16x32_bf16 v[14:17], v[10:13], v[42:45], v[14:17]
    s_waitcnt vmcnt(3)
    v_mfma_f32_16x16x32_bf16 v[14:17], v[10:13], v[46:49], v[14:17]
    s_waitcnt vmcnt(2)
    v_mfma_f32_16x16x32_bf16 v[14:17], v[10:13], v[50:53], v[14:17]
    s_waitcnt vmcnt(1)
    v_mfma_f32_16x16x32_bf16 v[14:17], v[10:13], v[54:57], v[14:17]
    s_waitcnt vmcnt(0)
    v_mfma_f32_16x16x32_bf16 v[14:17], v[10:13], v[58:61], v[14:17]
    v_max_u32 v5, v18, v19
    v_cmp_eq_u32 vcc, -1, v5
    s_cbranch_vccz L_sok_123
    s_sub_u32 s37, s37, 1
    s_cbranch_scc0 L_cre_122
    s_mov_b32 s37, 0
L_sok_123:
    v_and_b32 v21, 0xffff0000, v18
    v_lshlrev_b32 v20, 16, v18
    v_and_b32 v23, 0xffff0000, v19
    v_lshlrev_b32 v22, 16, v19
    s_nop 3
    v_cvt_pk_bf16_f32 v15, v14, v15
    v_lshlrev_b32 v14, 16, v15
    v_and_b32 v15, 0xffff0000, v15
    v_cvt_pk_bf16_f32 v17, v16, v17
    v_lshlrev_b32 v16, 16, v17
    v_and_b32 v17, 0xffff0000, v17
    v_mul_f32 v14, s46, v14
    v_mul_f32 v15, s47, v15
    v_mul_f32 v16, s48, v16
    v_mul_f32 v17, s49, v17
    v_cvt_pk_bf16_f32 v15, v14, v15
    v_lshlrev_b32 v14, 16, v15
    v_and_b32 v15, 0xffff0000, v15
    v_cvt_pk_bf16_f32 v17, v16, v17
    v_lshlrev_b32 v16, 16, v17
    v_and_b32 v17, 0xffff0000, v17
    v_add_f32 v14, v14, v20
    v_add_f32 v15, v15, v21
    v_add_f32 v16, v16, v22
    v_add_f32 v17, v17, v23
    v_cvt_pk_bf16_f32 v14, v14, v15
    v_cvt_pk_bf16_f32 v15, v16, v17
    buffer_store_dwordx2 v[14:15], v3, s[20:23], s44 offen
L_cdn_119:
    s_mov_b32 s43, s36
    s_mov_b32 s40, s42
    s_lshl_b32 s41, s43, 8
    s_mul_i32 s44, s43, 36864
    v_and_b32 v5, 1, v1
    v_lshlrev_b32 v5, 4, v5
    v_mov_b32 v10, 0x3f80
    v_lshlrev_b32 v5, v5, v10
    v_cndmask_b32 v10, 0, v5, s[80:81]
    v_cndmask_b32 v11, 0, v5, s[82:83]
    v_cndmask_b32 v12, 0, v5, s[84:85]
    v_cndmask_b32 v13, 0, v5, s[86:87]
L_cre_124:
    s_add_u32 s60, s44, 77594624
    buffer_load_dwordx2 v[18:19], v3, s[4:7], s60 offen sc1
    s_mul_i32 s60, s34, 36864
    s_add_u32 s60, s60, s40
    buffer_load_dwordx4 v[26:29], v2, s[4:7], s60 offen sc1
    s_add_u32 s60, s60, 4096
    buffer_load_dwordx4 v[30:33], v2, s[4:7], s60 offen sc1
    s_add_u32 s60, s60, 4096
    buffer_load_dwordx4 v[34:37], v2, s[4:7], s60 offen sc1
    s_add_u32 s60, s60, 4096
    buffer_load_dwordx4 v[38:41], v2, s[4:7], s60 offen sc1
    s_add_u32 s60, s60, 4096
    buffer_load_dwordx4 v[42:45], v2, s[4:7], s60 offen sc1
    s_add_u32 s60, s60, 4096
    buffer_load_dwordx4 v[46:49], v2, s[4:7], s60 offen sc1
    s_add_u32 s60, s60, 4096
    buffer_load_dwordx4 v[50:53], v2, s[4:7], s60 offen sc1
    s_add_u32 s60, s60, 4096
    buffer_load_dwordx4 v[54:57], v2, s[4:7], s60 offen sc1
    s_add_u32 s60, s60, 4096
    buffer_load_dwordx4 v[58:61], v2, s[4:7], s60 offen sc1
    s_waitcnt vmcnt(8)
    v_mfma_f32_16x16x32_bf16 v[14:17], v[10:13], v[26:29], 0
    v_max_u32 v5, v26, v27
    v_max3_u32 v5, v5, v28, v29
    s_waitcnt vmcnt(7)
    v_mfma_f32_16x16x32_bf16 v[14:17], v[10:13], v[30:33], v[14:17]
    v_max3_u32 v5, v5, v30, v31
    v_max3_u32 v5, v5, v32, v33
    s_waitcnt vmcnt(6)
    v_mfma_f32_16x16x32_bf16 v[14:17], v[10:13], v[34:37], v[14:17]
    v_max3_u32 v5, v5, v34, v35
    v_max3_u32 v5, v5, v36, v37
    s_waitcnt vmcnt(5)
    v_mfma_f32_16x16x32_bf16 v[14:17], v[10:13], v[38:41], v[14:17]
    v_max3_u32 v5, v5, v38, v39
    v_max3_u32 v5, v5, v40, v41
    s_waitcnt vmcnt(4)
    v_mfma_f32_16x16x32_bf16 v[14:17], v[10:13], v[42:45], v[14:17]
    v_max3_u32 v5, v5, v42, v43
    v_max3_u32 v5, v5, v44, v45
    s_waitcnt vmcnt(3)
    v_mfma_f32_16x16x32_bf16 v[14:17], v[10:13], v[46:49], v[14:17]
    v_max3_u32 v5, v5, v46, v47
    v_max3_u32 v5, v5, v48, v49
    s_waitcnt vmcnt(2)
    v_mfma_f32_16x16x32_bf16 v[14:17], v[10:13], v[50:53], v[14:17]
    v_max3_u32 v5, v5, v50, v51
    v_max3_u32 v5, v5, v52, v53
    s_waitcnt vmcnt(1)
    v_mfma_f32_16x16x32_bf16 v[14:17], v[10:13], v[54:57], v[14:17]
    v_max3_u32 v5, v5, v54, v55
    v_max3_u32 v5, v5, v56, v57
    s_waitcnt vmcnt(0)
    v_mfma_f32_16x16x32_bf16 v[14:17], v[10:13], v[58:61], v[14:17]
    v_max3_u32 v5, v5, v58, v59
    v_max3_u32 v5, v5, v60, v61
    v_max3_u32 v5, v5, v18, v19
    v_cmp_eq_u32 vcc, -1, v5
    s_cbranch_vccz L_sok_125
    s_sub_u32 s37, s37, 1
    s_cbranch_scc0 L_cre_124
    s_mov_b32 s37, 0
L_sok_125:
    v_and_b32 v21, 0xffff0000, v18
    v_lshlrev_b32 v20, 16, v18
    v_and_b32 v23, 0xffff0000, v19
    v_lshlrev_b32 v22, 16, v19
    s_nop 3
    v_cvt_pk_bf16_f32 v15, v14, v15
    v_lshlrev_b32 v14, 16, v15
    v_and_b32 v15, 0xffff0000, v15
    v_cvt_pk_bf16_f32 v17, v16, v17
    v_lshlrev_b32 v16, 16, v17
    v_and_b32 v17, 0xffff0000, v17
    v_mul_f32 v14, s46, v14
    v_mul_f32 v15, s47, v15
    v_mul_f32 v16, s48, v16
    v_mul_f32 v17, s49, v17
    v_cvt_pk_bf16_f32 v15, v14, v15
    v_lshlrev_b32 v14, 16, v15
    v_and_b32 v15, 0xffff0000, v15
    v_cvt_pk_bf16_f32 v17, v16, v17
    v_lshlrev_b32 v16, 16, v17
    v_and_b32 v17, 0xffff0000, v17
    v_add_f32 v14, v14, v20
    v_add_f32 v15, v15, v21
    v_add_f32 v16, v16, v22
    v_add_f32 v17, v17, v23
    v_cvt_pk_bf16_f32 v14, v14, v15
    v_cvt_pk_bf16_f32 v15, v16, v17
    buffer_store_dwordx2 v[14:15], v3, s[20:23], s44 offen
L_end:
    s_endpgm
.section .rodata,"a"
.p2align 6
.amdhsa_kernel adaLN_cond__memory_aug_recurrent_mem_tr__glu_gated_bilinear__prompt_kernel
  .amdhsa_next_free_vgpr 512
  .amdhsa_next_free_sgpr 102
  .amdhsa_accum_offset 256
  .amdhsa_group_segment_fixed_size 0
  .amdhsa_kernarg_size 128
  .amdhsa_user_sgpr_count 2
  .amdhsa_user_sgpr_kernarg_segment_ptr 1
  .amdhsa_system_sgpr_workgroup_id_x 1
  .amdhsa_float_denorm_mode_32 3
.end_amdhsa_kernel
.text
```
